```python
import torch

def _softmax(x, axis=-1):
    return torch.softmax(x, dim=axis)
def _gelu(x):
    return torch.nn.functional.gelu(x, approximate="tanh")
def _silu(x):
    return torch.nn.functional.silu(x)
def _sigmoid(x):
    return torch.sigmoid(x)
def _layernorm(x, axis=-1, eps=1e-5):
    m = x.mean(dim=axis, keepdim=True)
    v = x.var(dim=axis, keepdim=True, unbiased=False)
    return (x - m) / torch.sqrt(v + eps)
def _scatter_add(tgt, idx, src, axis=0):
    return tgt.clone().index_add_(axis, idx, src)
def _segment_sum(src, seg, n):
    out = torch.zeros((n,) + src.shape[1:], dtype=src.dtype)
    return out.index_add_(0, seg, src)
def _pad(x, pw):
    flat = tuple(v for pair in reversed(pw) for v in pair)
    return torch.nn.functional.pad(x, flat)

kernel_name = 'standalone__gqa_softmax__near_ridge'

def setup_inputs():

    _w = (lambda a: (lambda t: t.to(torch.bfloat16) if t.is_floating_point() else t)(torch.as_tensor(a)))
    B, Hq, Hkv, Sq, Sk, D = 8, 16, 8, 288, 1024, 256
    return {
        "q": _w((lambda *s: torch.randn(*s, dtype=torch.bfloat16) * 0.8)(B, Hq, Sq, D)),
        "k": _w((lambda *s: torch.randn(*s, dtype=torch.bfloat16) * 0.8)(B, Hkv, Sk, D)),
        "v": _w((lambda *s: torch.randn(*s, dtype=torch.bfloat16) * 0.05)(B, Hkv, Sk, D)),
    }

def reference(q, k, v):
    B, Hq, Sq, D = q.shape
    Hkv = k.shape[1]
    rep = Hq // Hkv
    k = (lambda x, n, axis: torch.repeat_interleave(x, n, dim=axis))(k, rep, axis=1)
    v = (lambda x, n, axis: torch.repeat_interleave(x, n, dim=axis))(v, rep, axis=1)
    scale = D ** -0.5
    scores = torch.einsum("bhqd,bhkd->bhqk", q, k) * scale
    p = _softmax(scores, axis=-1)
    return torch.einsum("bhqk,bhkd->bhqd", p, v)
```

```asm
; @launch grid=(256,1,1) block=(256,1,1) lds=163840
.amdgcn_target "amdgcn-amd-amdhsa--gfx950"
.text
.globl standalone__gqa_softmax__near_ridge_kernel
.p2align 8
.type standalone__gqa_softmax__near_ridge_kernel,@function
standalone__gqa_softmax__near_ridge_kernel:
    s_cmp_ge_u32 s2, 256
    s_cbranch_scc1 L_end
    s_load_dwordx8 s[4:11], s[0:1], 0
    s_getpc_b64 s[44:45]
L_pc:
    s_lshr_b32 s54, s2, 3
    s_lshl_b32 s46, s54, 7
    v_lshl_add_u32 v18, v0, 12, s46
    v_min_u32 v18, L_end-L_pc, v18
    v_mov_b32 v19, 0
    v_lshl_add_u64 v[18:19], v[18:19], 0, s[44:45]
    global_load_dword v15, v[18:19], off
    v_lshrrev_b32 v17, 6, v0
    s_mov_b64 s[42:43], 0
    v_readfirstlane_b32 s28, v17
    s_mov_b32 s52, 0x43000000
    s_and_b32 s53, s2, 7
    s_lshl_b32 s53, s53, 3
    s_lshr_b32 s55, s2, 5
    s_add_u32 s53, s53, s55
    s_and_b32 s54, s54, 3
    s_lshl_b32 s55, s53, 2
    s_add_u32 s55, s55, s54
    s_mul_i32 s37, s55, 73728
    s_lshl_b32 s53, s53, 19
    s_lshr_b32 s29, s28, 1
    s_and_b32 s30, s28, 1
    s_add_u32 s54, s28, 1
    s_and_b32 s55, s54, 1
    s_lshl_b32 s55, s55, 3
    s_lshr_b32 s54, s54, 1
    s_and_b32 s54, s54, 1
    s_add_u32 s54, s54, s55
    s_mul_i32 s54, s54, 1040
    s_add_u32 s34, s54, 30720
    s_mov_b32 s48, 8192
    s_mov_b32 s49, 16384
    s_mov_b32 s50, 24576
    s_mov_b32 s38, 65536
    s_mov_b32 s18, 524288
    s_mov_b32 s19, 0x20000
    s_mov_b32 s14, 73728
    s_mov_b32 s15, 0x20000
    s_mov_b32 s22, 524288
    s_mov_b32 s23, 0x20000
    s_mov_b32 s26, 73728
    s_mov_b32 s27, 0x20000
    v_and_b32 v16, 31, v0
    v_lshlrev_b32 v16, 4, v16
    v_bfe_u32 v18, v0, 5, 1
    s_lshl_b32 s54, s28, 11
    v_add_u32 v17, s54, v16
    v_lshl_add_u32 v4, v18, 13, v17
    v_lshl_add_u32 v96, v18, 15, v17
    v_lshl_add_u32 v20, v18, 9, v17
    s_mov_b32 s32, 0
    s_mov_b32 s33, 0
    s_waitcnt lgkmcnt(0)
    s_add_u32 s16, s6, s53
    s_addc_u32 s17, s7, 0
    s_and_b32 s17, s17, 0xffff
    s_add_u32 s12, s4, s37
    s_addc_u32 s13, s5, 0
    s_and_b32 s13, s13, 0xffff
    s_add_u32 s20, s8, s53
    s_addc_u32 s21, s9, 0
    s_and_b32 s21, s21, 0xffff
    s_add_u32 s24, s10, s37
    s_addc_u32 s25, s11, 0
    s_and_b32 s25, s25, 0xffff
L_restart:
    buffer_load_dwordx4 v[112:115], v20, s[12:15], s38 offen
    buffer_load_dwordx4 v[116:119], v20, s[12:15], s38 offen offset:1024
    buffer_load_dwordx4 v[128:131], v96, s[12:15], 0 offen
    buffer_load_dwordx4 v[132:135], v96, s[12:15], 0 offen offset:512
    buffer_load_dwordx4 v[136:139], v96, s[12:15], 0 offen offset:1024
    buffer_load_dwordx4 v[140:143], v96, s[12:15], 0 offen offset:1536
    s_add_u32 m0, s34, 0
    s_nop 0
    buffer_load_dwordx4 v4, s[16:19], s32 offen lds
    s_add_u32 m0, s34, 1568
    s_nop 0
    buffer_load_dwordx4 v4, s[16:19], s32 offen offset:512 lds
    s_add_u32 m0, s34, 3136
    s_nop 0
    buffer_load_dwordx4 v4, s[16:19], s32 offen offset:1024 lds
    s_add_u32 m0, s34, 4704
    s_nop 0
    buffer_load_dwordx4 v4, s[16:19], s32 offen offset:1536 lds
    s_add_u32 s32, s32, s49
    s_lshl_b32 s54, s30, 11
    s_lshl_b32 s55, s29, 13
    s_add_u32 s54, s54, s55
    v_lshl_add_u32 v5, v18, 12, v16
    v_add_u32 v5, s54, v5
    s_add_u32 s54, s34, 49920
    v_lshl_add_u32 v97, v18, 9, v16
    v_add_u32 v97, s54, v97
    v_add_u32 v98, 66560, v97
    s_sub_u32 s54, s34, 20480
    v_mul_u32_u24 v99, 2080, v18
    v_add3_u32 v99, v99, v16, s54
    s_mul_i32 s54, s30, 8320
    s_lshl_b32 s55, s29, 10
    s_add_u32 s54, s54, s55
    s_add_u32 s35, s54, 97280
    s_mul_i32 s36, s28, 2560
    v_and_b32 v16, 15, v0
    v_bfe_u32 v17, v0, 4, 1
    v_lshlrev_b32 v19, 5, v17
    v_lshl_add_u32 v19, v18, 4, v19
    v_add_u32 v20, 4, v16
    v_bfe_u32 v103, v20, 3, 1
    v_and_b32 v20, 7, v20
    v_lshl_add_u32 v103, v20, 1, v103
    v_mul_u32_u24 v103, 1040, v103
    v_add_u32 v103, v103, v19
    v_add_u32 v102, 10240, v103
    v_add_u32 v103, 30720, v103
    s_lshl_b32 s54, s30, 9
    v_add_u32 v1, s54, v103
    s_lshl_b32 s54, s29, 9
    s_add_u32 s54, s54, 49920
    v_add_u32 v100, s54, v103
    v_add_u32 v101, 66560, v100
    s_lshl_b32 s54, s30, 9
    s_sub_u32 s54, 512, s54
    v_add_u32 v103, s54, v103
    v_bfe_u32 v20, v0, 2, 2
    v_mul_u32_u24 v2, 2064, v20
    v_mul_u32_u24 v20, 8320, v17
    v_add_u32 v2, v2, v20
    v_lshl_add_u32 v2, v18, 9, v2
    v_bfe_u32 v20, v0, 1, 1
    v_lshl_add_u32 v2, v20, 6, v2
    v_and_b32 v20, 1, v0
    v_lshl_add_u32 v2, v20, 3, v2
    s_mul_i32 s54, s30, 1280
    s_add_u32 s54, s54, 97280
    s_mul_i32 s55, s30, 768
    s_sub_u32 s55, 98304, s55
    v_add_u32 v3, s55, v2
    v_add_u32 v2, s54, v2
    v_and_b32 v20, 63, v0
    v_lshlrev_b32 v20, 2, v20
    s_mul_i32 s54, s30, 2560
    s_sub_u32 s55, 2560, s54
    v_add_u32 v7, s54, v20
    v_add_u32 v6, s55, v20
    s_mul_i32 s55, s28, 2304
    s_add_u32 s55, s55, 47360
    v_bfe_u32 v20, v0, 4, 2
    v_mul_u32_u24 v22, 576, v20
    v_lshl_add_u32 v22, v16, 3, v22
    v_add_u32 v22, s55, v22
    v_lshl_add_u32 v21, v20, 4, s36
    v_bfe_u32 v17, v0, 1, 1
    v_lshl_add_u32 v20, v20, 1, v17
    v_mul_u32_u24 v23, 144, v20
    v_and_b32 v17, 1, v0
    v_lshl_add_u32 v23, v17, 6, v23
    v_bfe_u32 v17, v0, 2, 2
    v_lshl_add_u32 v23, v17, 3, v23
    v_add_u32 v23, s55, v23
    v_bfe_u32 v20, v0, 3, 3
    v_and_b32 v17, 7, v0
    v_lshlrev_b32 v17, 4, v17
    s_lshl_b32 s54, s29, 15
    s_lshl_b32 s55, s30, 8
    s_add_u32 s55, s55, s54
    s_sub_u32 s51, 65536, s54
    v_lshl_add_u32 v13, v20, 9, v17
    v_add_u32 v13, s55, v13
    s_mov_b32 s4, 4096
    s_add_u32 s5, s48, 4096
    s_add_u32 s6, s49, 4096
    s_add_u32 s7, s50, 4096
    s_add_u32 s8, s51, 4096
    s_mov_b32 s40, 0x3db8aa3b
    s_mov_b32 s41, 0x3db8aa3b
    s_mov_b32 s39, 0xffff0000
    v_mov_b32 v8, 0
    v_mov_b32 v9, 0
    v_mov_b32 v10, 0
    v_mov_b32 v11, 0
    v_mov_b32 v12, 0
    v_mov_b64 v[144:145], 0
    v_mov_b64 v[146:147], 0
    v_mov_b64 v[148:149], 0
    v_mov_b64 v[150:151], 0
    v_mov_b64 v[152:153], 0
    v_mov_b64 v[154:155], 0
    v_mov_b64 v[156:157], 0
    v_mov_b64 v[158:159], 0
    v_mov_b64 v[176:177], 0
    v_mov_b64 v[178:179], 0
    v_mov_b64 v[180:181], 0
    v_mov_b64 v[182:183], 0
    v_mov_b64 v[184:185], 0
    v_mov_b64 v[186:187], 0
    v_mov_b64 v[188:189], 0
    v_mov_b64 v[190:191], 0
    v_mov_b64 v[208:209], 0
    v_mov_b64 v[210:211], 0
    v_mov_b64 v[212:213], 0
    v_mov_b64 v[214:215], 0
    v_mov_b64 v[216:217], 0
    v_mov_b64 v[218:219], 0
    v_mov_b64 v[220:221], 0
    v_mov_b64 v[222:223], 0
    v_mov_b64 v[240:241], 0
    v_mov_b64 v[242:243], 0
    v_mov_b64 v[244:245], 0
    v_mov_b64 v[246:247], 0
    v_mov_b64 v[248:249], 0
    v_mov_b64 v[250:251], 0
    v_mov_b64 v[252:253], 0
    v_mov_b64 v[254:255], 0
    v_accvgpr_write_b32 a144, 0
    v_accvgpr_write_b32 a145, 0
    v_accvgpr_write_b32 a146, 0
    v_accvgpr_write_b32 a147, 0
    v_accvgpr_write_b32 a148, 0
    v_accvgpr_write_b32 a149, 0
    v_accvgpr_write_b32 a150, 0
    v_accvgpr_write_b32 a151, 0
    v_accvgpr_write_b32 a152, 0
    v_accvgpr_write_b32 a153, 0
    v_accvgpr_write_b32 a154, 0
    v_accvgpr_write_b32 a155, 0
    v_accvgpr_write_b32 a156, 0
    v_accvgpr_write_b32 a157, 0
    v_accvgpr_write_b32 a158, 0
    v_accvgpr_write_b32 a159, 0
    s_cmp_eq_u32 s29, 1
    s_cbranch_scc1 L_role1
    s_branch L_role0
L_fallback0:
    s_waitcnt vmcnt(0) lgkmcnt(0)
    s_nop 7
    s_mov_b32 s18, 524288
    v_and_b32 v72, 15, v0
    v_lshlrev_b32 v72, 9, v72
    v_bfe_u32 v73, v0, 4, 1
    v_lshl_add_u32 v72, v73, 5, v72
    v_bfe_u32 v73, v0, 5, 1
    v_lshl_add_u32 v72, v73, 4, v72
    v_mov_b32 v64, 0xff800000
    v_mov_b32 v65, 0xff800000
    v_mov_b32 v66, 0xff800000
    v_mov_b32 v67, 0xff800000
    v_mov_b32 v68, 0xff800000
    s_mov_b32 s54, 0
L_fbloop0:
    buffer_load_dwordx4 a[160:163], v72, s[16:19], s54 offen
    buffer_load_dwordx4 a[164:167], v72, s[16:19], s54 offen offset:64
    buffer_load_dwordx4 a[168:171], v72, s[16:19], s54 offen offset:128
    buffer_load_dwordx4 a[172:175], v72, s[16:19], s54 offen offset:192
    buffer_load_dwordx4 a[176:179], v72, s[16:19], s54 offen offset:256
    buffer_load_dwordx4 a[180:183], v72, s[16:19], s54 offen offset:320
    buffer_load_dwordx4 a[184:187], v72, s[16:19], s54 offen offset:384
    buffer_load_dwordx4 a[188:191], v72, s[16:19], s54 offen offset:448
    s_waitcnt vmcnt(7)
    v_mfma_f32_16x16x32_bf16 v[44:47], a[160:163], a[0:3], 0
    s_waitcnt vmcnt(6)
    v_mfma_f32_16x16x32_bf16 v[44:47], a[164:167], a[4:7], v[44:47]
    s_waitcnt vmcnt(5)
    v_mfma_f32_16x16x32_bf16 v[44:47], a[168:171], a[8:11], v[44:47]
    s_waitcnt vmcnt(4)
    v_mfma_f32_16x16x32_bf16 v[44:47], a[172:175], a[12:15], v[44:47]
    s_waitcnt vmcnt(3)
    v_mfma_f32_16x16x32_bf16 v[44:47], a[176:179], a[16:19], v[44:47]
    s_waitcnt vmcnt(2)
    v_mfma_f32_16x16x32_bf16 v[44:47], a[180:183], a[20:23], v[44:47]
    s_waitcnt vmcnt(1)
    v_mfma_f32_16x16x32_bf16 v[44:47], a[184:187], a[24:27], v[44:47]
    s_waitcnt vmcnt(0)
    v_mfma_f32_16x16x32_bf16 v[44:47], a[188:191], a[28:31], v[44:47]
    v_mfma_f32_16x16x32_bf16 v[48:51], a[160:163], a[32:35], 0
    v_mfma_f32_16x16x32_bf16 v[48:51], a[164:167], a[36:39], v[48:51]
    v_mfma_f32_16x16x32_bf16 v[48:51], a[168:171], a[40:43], v[48:51]
    v_mfma_f32_16x16x32_bf16 v[48:51], a[172:175], a[44:47], v[48:51]
    v_mfma_f32_16x16x32_bf16 v[48:51], a[176:179], a[48:51], v[48:51]
    v_mfma_f32_16x16x32_bf16 v[48:51], a[180:183], a[52:55], v[48:51]
    v_mfma_f32_16x16x32_bf16 v[48:51], a[184:187], a[56:59], v[48:51]
    v_mfma_f32_16x16x32_bf16 v[48:51], a[188:191], a[60:63], v[48:51]
    v_mfma_f32_16x16x32_bf16 v[52:55], a[160:163], a[64:67], 0
    v_mfma_f32_16x16x32_bf16 v[52:55], a[164:167], a[68:71], v[52:55]
    v_mfma_f32_16x16x32_bf16 v[52:55], a[168:171], a[72:75], v[52:55]
    v_mfma_f32_16x16x32_bf16 v[52:55], a[172:175], a[76:79], v[52:55]
    v_mfma_f32_16x16x32_bf16 v[52:55], a[176:179], a[80:83], v[52:55]
    v_mfma_f32_16x16x32_bf16 v[52:55], a[180:183], a[84:87], v[52:55]
    v_mfma_f32_16x16x32_bf16 v[52:55], a[184:187], a[88:91], v[52:55]
    v_mfma_f32_16x16x32_bf16 v[52:55], a[188:191], a[92:95], v[52:55]
    v_mfma_f32_16x16x32_bf16 v[56:59], a[160:163], a[96:99], 0
    v_mfma_f32_16x16x32_bf16 v[56:59], a[164:167], a[100:103], v[56:59]
    v_mfma_f32_16x16x32_bf16 v[56:59], a[168:171], a[104:107], v[56:59]
    v_mfma_f32_16x16x32_bf16 v[56:59], a[172:175], a[108:111], v[56:59]
    v_mfma_f32_16x16x32_bf16 v[56:59], a[176:179], a[112:115], v[56:59]
    v_mfma_f32_16x16x32_bf16 v[56:59], a[180:183], a[116:119], v[56:59]
    v_mfma_f32_16x16x32_bf16 v[56:59], a[184:187], a[120:123], v[56:59]
    v_mfma_f32_16x16x32_bf16 v[56:59], a[188:191], a[124:127], v[56:59]
    v_mfma_f32_16x16x32_bf16 v[60:63], a[160:163], a[128:131], 0
    v_mfma_f32_16x16x32_bf16 v[60:63], a[164:167], a[132:135], v[60:63]
    v_mfma_f32_16x16x32_bf16 v[60:63], a[168:171], a[136:139], v[60:63]
    v_mfma_f32_16x16x32_bf16 v[60:63], a[172:175], a[140:143], v[60:63]
    v_mfma_f32_16x16x32_bf16 v[60:63], a[176:179], a[144:147], v[60:63]
    v_mfma_f32_16x16x32_bf16 v[60:63], a[180:183], a[148:151], v[60:63]
    v_mfma_f32_16x16x32_bf16 v[60:63], a[184:187], a[152:155], v[60:63]
    v_mfma_f32_16x16x32_bf16 v[60:63], a[188:191], a[156:159], v[60:63]
    v_max3_f32 v64, v44, v45, v64
    v_max3_f32 v64, v46, v47, v64
    v_max3_f32 v65, v48, v49, v65
    v_max3_f32 v65, v50, v51, v65
    v_max3_f32 v66, v52, v53, v66
    v_max3_f32 v66, v54, v55, v66
    v_max3_f32 v67, v56, v57, v67
    v_max3_f32 v67, v58, v59, v67
    v_max3_f32 v68, v60, v61, v68
    v_max3_f32 v68, v62, v63, v68
    s_add_u32 s54, s54, 8192
    s_cmp_lt_u32 s54, 524288
    s_cbranch_scc1 L_fbloop0
    v_mov_b32 v73, v64
    s_nop 1
    v_permlane32_swap_b32 v73, v64
    v_max_f32 v64, v73, v64
    v_mov_b32 v73, v64
    s_nop 1
    v_permlane16_swap_b32 v73, v64
    v_max_f32 v64, v73, v64
    v_sub_f32 v24, 0, v64
    v_sub_f32 v25, 0, v64
    v_sub_f32 v26, 0, v64
    v_sub_f32 v27, 0, v64
    v_mov_b32 v73, v65
    s_nop 1
    v_permlane32_swap_b32 v73, v65
    v_max_f32 v65, v73, v65
    v_mov_b32 v73, v65
    s_nop 1
    v_permlane16_swap_b32 v73, v65
    v_max_f32 v65, v73, v65
    v_sub_f32 v28, 0, v65
    v_sub_f32 v29, 0, v65
    v_sub_f32 v30, 0, v65
    v_sub_f32 v31, 0, v65
    v_mov_b32 v73, v66
    s_nop 1
    v_permlane32_swap_b32 v73, v66
    v_max_f32 v66, v73, v66
    v_mov_b32 v73, v66
    s_nop 1
    v_permlane16_swap_b32 v73, v66
    v_max_f32 v66, v73, v66
    v_sub_f32 v32, 0, v66
    v_sub_f32 v33, 0, v66
    v_sub_f32 v34, 0, v66
    v_sub_f32 v35, 0, v66
    v_mov_b32 v73, v67
    s_nop 1
    v_permlane32_swap_b32 v73, v67
    v_max_f32 v67, v73, v67
    v_mov_b32 v73, v67
    s_nop 1
    v_permlane16_swap_b32 v73, v67
    v_max_f32 v67, v73, v67
    v_sub_f32 v36, 0, v67
    v_sub_f32 v37, 0, v67
    v_sub_f32 v38, 0, v67
    v_sub_f32 v39, 0, v67
    v_mov_b32 v73, v68
    s_nop 1
    v_permlane32_swap_b32 v73, v68
    v_max_f32 v68, v73, v68
    v_mov_b32 v73, v68
    s_nop 1
    v_permlane16_swap_b32 v73, v68
    v_max_f32 v68, v73, v68
    v_sub_f32 v40, 0, v68
    v_sub_f32 v41, 0, v68
    v_sub_f32 v42, 0, v68
    v_sub_f32 v43, 0, v68
    s_mov_b64 s[42:43], -1
    s_mov_b32 s52, -1
    v_and_b32 v16, 31, v0
    v_lshlrev_b32 v16, 4, v16
    v_bfe_u32 v18, v0, 5, 1
    s_lshl_b32 s54, s28, 11
    v_add_u32 v17, s54, v16
    v_lshl_add_u32 v4, v18, 13, v17
    v_lshl_add_u32 v96, v18, 15, v17
    v_lshl_add_u32 v20, v18, 9, v17
    s_mov_b32 s32, 0
    s_mov_b32 s33, 0
    s_barrier
    s_branch L_restart
L_fallback1:
    s_waitcnt vmcnt(0) lgkmcnt(0)
    s_nop 7
    s_mov_b32 s18, 524288
    v_and_b32 v72, 15, v0
    v_lshlrev_b32 v72, 9, v72
    v_bfe_u32 v73, v0, 4, 1
    v_lshl_add_u32 v72, v73, 5, v72
    v_bfe_u32 v73, v0, 5, 1
    v_lshl_add_u32 v72, v73, 4, v72
    v_mov_b32 v64, 0xff800000
    v_mov_b32 v65, 0xff800000
    v_mov_b32 v66, 0xff800000
    v_mov_b32 v67, 0xff800000
    s_mov_b32 s54, 0
L_fbloop1:
    buffer_load_dwordx4 a[160:163], v72, s[16:19], s54 offen
    buffer_load_dwordx4 a[164:167], v72, s[16:19], s54 offen offset:64
    buffer_load_dwordx4 a[168:171], v72, s[16:19], s54 offen offset:128
    buffer_load_dwordx4 a[172:175], v72, s[16:19], s54 offen offset:192
    buffer_load_dwordx4 a[176:179], v72, s[16:19], s54 offen offset:256
    buffer_load_dwordx4 a[180:183], v72, s[16:19], s54 offen offset:320
    buffer_load_dwordx4 a[184:187], v72, s[16:19], s54 offen offset:384
    buffer_load_dwordx4 a[188:191], v72, s[16:19], s54 offen offset:448
    s_waitcnt vmcnt(7)
    v_mfma_f32_16x16x32_bf16 v[44:47], a[160:163], a[0:3], 0
    s_waitcnt vmcnt(6)
    v_mfma_f32_16x16x32_bf16 v[44:47], a[164:167], a[4:7], v[44:47]
    s_waitcnt vmcnt(5)
    v_mfma_f32_16x16x32_bf16 v[44:47], a[168:171], a[8:11], v[44:47]
    s_waitcnt vmcnt(4)
    v_mfma_f32_16x16x32_bf16 v[44:47], a[172:175], a[12:15], v[44:47]
    s_waitcnt vmcnt(3)
    v_mfma_f32_16x16x32_bf16 v[44:47], a[176:179], a[16:19], v[44:47]
    s_waitcnt vmcnt(2)
    v_mfma_f32_16x16x32_bf16 v[44:47], a[180:183], a[20:23], v[44:47]
    s_waitcnt vmcnt(1)
    v_mfma_f32_16x16x32_bf16 v[44:47], a[184:187], a[24:27], v[44:47]
    s_waitcnt vmcnt(0)
    v_mfma_f32_16x16x32_bf16 v[44:47], a[188:191], a[28:31], v[44:47]
    v_mfma_f32_16x16x32_bf16 v[48:51], a[160:163], a[32:35], 0
    v_mfma_f32_16x16x32_bf16 v[48:51], a[164:167], a[36:39], v[48:51]
    v_mfma_f32_16x16x32_bf16 v[48:51], a[168:171], a[40:43], v[48:51]
    v_mfma_f32_16x16x32_bf16 v[48:51], a[172:175], a[44:47], v[48:51]
    v_mfma_f32_16x16x32_bf16 v[48:51], a[176:179], a[48:51], v[48:51]
    v_mfma_f32_16x16x32_bf16 v[48:51], a[180:183], a[52:55], v[48:51]
    v_mfma_f32_16x16x32_bf16 v[48:51], a[184:187], a[56:59], v[48:51]
    v_mfma_f32_16x16x32_bf16 v[48:51], a[188:191], a[60:63], v[48:51]
    v_mfma_f32_16x16x32_bf16 v[52:55], a[160:163], a[64:67], 0
    v_mfma_f32_16x16x32_bf16 v[52:55], a[164:167], a[68:71], v[52:55]
    v_mfma_f32_16x16x32_bf16 v[52:55], a[168:171], a[72:75], v[52:55]
    v_mfma_f32_16x16x32_bf16 v[52:55], a[172:175], a[76:79], v[52:55]
    v_mfma_f32_16x16x32_bf16 v[52:55], a[176:179], a[80:83], v[52:55]
    v_mfma_f32_16x16x32_bf16 v[52:55], a[180:183], a[84:87], v[52:55]
    v_mfma_f32_16x16x32_bf16 v[52:55], a[184:187], a[88:91], v[52:55]
    v_mfma_f32_16x16x32_bf16 v[52:55], a[188:191], a[92:95], v[52:55]
    v_mfma_f32_16x16x32_bf16 v[56:59], a[160:163], a[96:99], 0
    v_mfma_f32_16x16x32_bf16 v[56:59], a[164:167], a[100:103], v[56:59]
    v_mfma_f32_16x16x32_bf16 v[56:59], a[168:171], a[104:107], v[56:59]
    v_mfma_f32_16x16x32_bf16 v[56:59], a[172:175], a[108:111], v[56:59]
    v_mfma_f32_16x16x32_bf16 v[56:59], a[176:179], a[112:115], v[56:59]
    v_mfma_f32_16x16x32_bf16 v[56:59], a[180:183], a[116:119], v[56:59]
    v_mfma_f32_16x16x32_bf16 v[56:59], a[184:187], a[120:123], v[56:59]
    v_mfma_f32_16x16x32_bf16 v[56:59], a[188:191], a[124:127], v[56:59]
    v_max3_f32 v64, v44, v45, v64
    v_max3_f32 v64, v46, v47, v64
    v_max3_f32 v65, v48, v49, v65
    v_max3_f32 v65, v50, v51, v65
    v_max3_f32 v66, v52, v53, v66
    v_max3_f32 v66, v54, v55, v66
    s_nop 1
    v_max3_f32 v67, v56, v57, v67
    v_max3_f32 v67, v58, v59, v67
    s_add_u32 s54, s54, 8192
    s_cmp_lt_u32 s54, 524288
    s_cbranch_scc1 L_fbloop1
    v_mov_b32 v73, v64
    s_nop 1
    v_permlane32_swap_b32 v73, v64
    v_max_f32 v64, v73, v64
    v_mov_b32 v73, v64
    s_nop 1
    v_permlane16_swap_b32 v73, v64
    v_max_f32 v64, v73, v64
    v_sub_f32 v24, 0, v64
    v_sub_f32 v25, 0, v64
    v_sub_f32 v26, 0, v64
    v_sub_f32 v27, 0, v64
    v_mov_b32 v73, v65
    s_nop 1
    v_permlane32_swap_b32 v73, v65
    v_max_f32 v65, v73, v65
    v_mov_b32 v73, v65
    s_nop 1
    v_permlane16_swap_b32 v73, v65
    v_max_f32 v65, v73, v65
    v_sub_f32 v28, 0, v65
    v_sub_f32 v29, 0, v65
    v_sub_f32 v30, 0, v65
    v_sub_f32 v31, 0, v65
    v_mov_b32 v73, v66
    s_nop 1
    v_permlane32_swap_b32 v73, v66
    v_max_f32 v66, v73, v66
    v_mov_b32 v73, v66
    s_nop 1
    v_permlane16_swap_b32 v73, v66
    v_max_f32 v66, v73, v66
    v_sub_f32 v32, 0, v66
    v_sub_f32 v33, 0, v66
    v_sub_f32 v34, 0, v66
    v_sub_f32 v35, 0, v66
    v_mov_b32 v73, v67
    s_nop 1
    v_permlane32_swap_b32 v73, v67
    v_max_f32 v67, v73, v67
    v_mov_b32 v73, v67
    s_nop 1
    v_permlane16_swap_b32 v73, v67
    v_max_f32 v67, v73, v67
    v_sub_f32 v36, 0, v67
    v_sub_f32 v37, 0, v67
    v_sub_f32 v38, 0, v67
    v_sub_f32 v39, 0, v67
    s_mov_b64 s[42:43], -1
    s_mov_b32 s52, -1
    v_and_b32 v16, 31, v0
    v_lshlrev_b32 v16, 4, v16
    v_bfe_u32 v18, v0, 5, 1
    s_lshl_b32 s54, s28, 11
    v_add_u32 v17, s54, v16
    v_lshl_add_u32 v4, v18, 13, v17
    v_lshl_add_u32 v96, v18, 15, v17
    v_lshl_add_u32 v20, v18, 9, v17
    s_mov_b32 s32, 0
    s_mov_b32 s33, 0
    s_barrier
    s_branch L_restart
.p2alignl 12, 0xbf810000
.fill 746, 4, 0xbf810000
L_role0:
    s_lshr_b32 s54, s2, 3
    s_and_b32 s54, s54, 3
    s_lshl_b32 s54, s54, 2
    s_add_u32 s54, s54, s28
    s_mul_i32 s54, s54, 3072
    s_add_u32 s54, s54, 0xfb074000
    v_and_b32 v19, 63, v0
    v_min_u32 v19, 23, v19
    v_lshl_add_u32 v19, v19, 7, s54
    s_mov_b32 s31, 6
    s_mov_b64 vcc, -1
    s_cmp_eq_u32 s30, 0
    s_cbranch_scc1 L_pad0_0
    s_branch L_pad0_1
L_walked0:
    s_mov_b64 vcc, 0
    s_waitcnt vmcnt(9)
    buffer_load_dwordx4 v[160:163], v96, s[12:15], s48 offen
    buffer_load_dwordx4 v[164:167], v96, s[12:15], s48 offen offset:512
    v_lshlrev_b32 v104, 16, v112
    v_and_b32 v105, s39, v112
    v_lshlrev_b32 v106, 16, v113
    v_and_b32 v107, s39, v113
    v_lshlrev_b32 v108, 16, v114
    v_and_b32 v109, s39, v114
    v_lshlrev_b32 v110, 16, v115
    v_and_b32 v111, s39, v115
    v_pk_mul_f32 v[104:105], v[104:105], s[40:41]
    v_pk_mul_f32 v[106:107], v[106:107], s[40:41]
    v_pk_mul_f32 v[108:109], v[108:109], s[40:41]
    v_pk_mul_f32 v[110:111], v[110:111], s[40:41]
    v_cvt_pk_bf16_f32 v112, v104, v105
    v_cvt_pk_bf16_f32 v113, v106, v107
    v_cvt_pk_bf16_f32 v114, v108, v109
    v_cvt_pk_bf16_f32 v115, v110, v111
    ds_write_b128 v99, v[112:115] offset:0
    s_waitcnt vmcnt(10)
    buffer_load_dwordx4 v[168:171], v96, s[12:15], s48 offen offset:1024
    v_lshlrev_b32 v104, 16, v116
    v_and_b32 v105, s39, v116
    v_lshlrev_b32 v106, 16, v117
    v_and_b32 v107, s39, v117
    v_lshlrev_b32 v108, 16, v118
    v_and_b32 v109, s39, v118
    v_lshlrev_b32 v110, 16, v119
    v_and_b32 v111, s39, v119
    v_pk_mul_f32 v[104:105], v[104:105], s[40:41]
    v_pk_mul_f32 v[106:107], v[106:107], s[40:41]
    v_pk_mul_f32 v[108:109], v[108:109], s[40:41]
    v_pk_mul_f32 v[110:111], v[110:111], s[40:41]
    v_cvt_pk_bf16_f32 v116, v104, v105
    v_cvt_pk_bf16_f32 v117, v106, v107
    v_cvt_pk_bf16_f32 v118, v108, v109
    v_cvt_pk_bf16_f32 v119, v110, v111
    ds_write_b128 v99, v[116:119] offset:4160
    s_waitcnt vmcnt(10)
    buffer_load_dwordx4 v[172:175], v96, s[12:15], s48 offen offset:1536
    v_lshlrev_b32 v104, 16, v128
    v_and_b32 v105, s39, v128
    v_lshlrev_b32 v106, 16, v129
    v_and_b32 v107, s39, v129
    v_lshlrev_b32 v108, 16, v130
    v_and_b32 v109, s39, v130
    v_lshlrev_b32 v110, 16, v131
    v_and_b32 v111, s39, v131
    v_pk_mul_f32 v[104:105], v[104:105], s[40:41]
    v_pk_mul_f32 v[106:107], v[106:107], s[40:41]
    v_pk_mul_f32 v[108:109], v[108:109], s[40:41]
    v_pk_mul_f32 v[110:111], v[110:111], s[40:41]
    v_cvt_pk_bf16_f32 v128, v104, v105
    v_cvt_pk_bf16_f32 v129, v106, v107
    v_cvt_pk_bf16_f32 v130, v108, v109
    v_cvt_pk_bf16_f32 v131, v110, v111
    ds_write_b128 v97, v[128:131] offset:33280
    s_waitcnt vmcnt(10)
    s_add_u32 m0, s34, 16640
    s_nop 0
    buffer_load_dwordx4 v4, s[16:19], s32 offen lds
    v_lshlrev_b32 v104, 16, v132
    v_and_b32 v105, s39, v132
    v_lshlrev_b32 v106, 16, v133
    v_and_b32 v107, s39, v133
    v_lshlrev_b32 v108, 16, v134
    v_and_b32 v109, s39, v134
    v_lshlrev_b32 v110, 16, v135
    v_and_b32 v111, s39, v135
    v_pk_mul_f32 v[104:105], v[104:105], s[40:41]
    v_pk_mul_f32 v[106:107], v[106:107], s[40:41]
    v_pk_mul_f32 v[108:109], v[108:109], s[40:41]
    v_pk_mul_f32 v[110:111], v[110:111], s[40:41]
    v_cvt_pk_bf16_f32 v132, v104, v105
    v_cvt_pk_bf16_f32 v133, v106, v107
    v_cvt_pk_bf16_f32 v134, v108, v109
    v_cvt_pk_bf16_f32 v135, v110, v111
    ds_write_b128 v97, v[132:135] offset:35360
    s_waitcnt vmcnt(10)
    s_add_u32 m0, s34, 18208
    s_nop 0
    buffer_load_dwordx4 v4, s[16:19], s32 offen offset:512 lds
    v_lshlrev_b32 v104, 16, v136
    v_and_b32 v105, s39, v136
    v_lshlrev_b32 v106, 16, v137
    v_and_b32 v107, s39, v137
    v_lshlrev_b32 v108, 16, v138
    v_and_b32 v109, s39, v138
    v_lshlrev_b32 v110, 16, v139
    v_and_b32 v111, s39, v139
    v_pk_mul_f32 v[104:105], v[104:105], s[40:41]
    v_pk_mul_f32 v[106:107], v[106:107], s[40:41]
    v_pk_mul_f32 v[108:109], v[108:109], s[40:41]
    v_pk_mul_f32 v[110:111], v[110:111], s[40:41]
    v_cvt_pk_bf16_f32 v136, v104, v105
    v_cvt_pk_bf16_f32 v137, v106, v107
    v_cvt_pk_bf16_f32 v138, v108, v109
    v_cvt_pk_bf16_f32 v139, v110, v111
    ds_write_b128 v97, v[136:139] offset:37440
    s_waitcnt vmcnt(10)
    s_add_u32 m0, s34, 19776
    s_nop 0
    buffer_load_dwordx4 v4, s[16:19], s32 offen offset:1024 lds
    v_lshlrev_b32 v104, 16, v140
    v_and_b32 v105, s39, v140
    v_lshlrev_b32 v106, 16, v141
    v_and_b32 v107, s39, v141
    v_lshlrev_b32 v108, 16, v142
    v_and_b32 v109, s39, v142
    v_lshlrev_b32 v110, 16, v143
    v_and_b32 v111, s39, v143
    v_pk_mul_f32 v[104:105], v[104:105], s[40:41]
    v_pk_mul_f32 v[106:107], v[106:107], s[40:41]
    v_pk_mul_f32 v[108:109], v[108:109], s[40:41]
    v_pk_mul_f32 v[110:111], v[110:111], s[40:41]
    v_cvt_pk_bf16_f32 v140, v104, v105
    v_cvt_pk_bf16_f32 v141, v106, v107
    v_cvt_pk_bf16_f32 v142, v108, v109
    v_cvt_pk_bf16_f32 v143, v110, v111
    ds_write_b128 v97, v[140:143] offset:39520
    s_waitcnt vmcnt(7)
    s_add_u32 m0, s34, 21344
    s_nop 0
    buffer_load_dwordx4 v4, s[16:19], s32 offen offset:1536 lds
    s_add_u32 s32, s32, s49
    buffer_load_dwordx4 v[192:195], v96, s[12:15], s49 offen
    buffer_load_dwordx4 v[196:199], v96, s[12:15], s49 offen offset:512
    buffer_load_dwordx4 v[200:203], v96, s[12:15], s49 offen offset:1024
    s_waitcnt lgkmcnt(0)
    s_barrier
    ds_read_b128 a[192:195], v1 offset:0
    ds_read_b128 a[196:199], v1 offset:64
    ds_read_b128 a[200:203], v1 offset:128
    ds_read_b128 a[204:207], v1 offset:192
    ds_read_b128 a[208:211], v1 offset:256
    ds_read_b128 a[212:215], v1 offset:320
    ds_read_b128 a[216:219], v1 offset:384
    ds_read_b128 a[220:223], v1 offset:448
    ds_read_b128 a[128:131], v102 offset:0
    ds_read_b128 a[132:135], v102 offset:64
    ds_read_b128 a[136:139], v102 offset:128
    ds_read_b128 a[140:143], v102 offset:192
    ds_read_b128 a[144:147], v102 offset:256
    ds_read_b128 a[148:151], v102 offset:320
    ds_read_b128 a[152:155], v102 offset:384
    ds_read_b128 a[156:159], v102 offset:448
    ds_read_b128 a[224:227], v103 offset:0
    ds_read_b128 a[228:231], v103 offset:64
    ds_read_b128 a[232:235], v103 offset:128
    ds_read_b128 a[236:239], v103 offset:192
    ds_read_b128 a[240:243], v103 offset:256
    ds_read_b128 a[244:247], v103 offset:320
    ds_read_b128 a[248:251], v103 offset:384
    ds_read_b128 a[252:255], v103 offset:448
    ds_read_b128 a[0:3], v100 offset:33280
    ds_read_b128 a[4:7], v100 offset:33344
    ds_read_b128 a[8:11], v100 offset:33408
    ds_read_b128 a[12:15], v100 offset:33472
    ds_read_b128 a[16:19], v100 offset:33536
    ds_read_b128 a[20:23], v100 offset:33600
    ds_read_b128 a[24:27], v100 offset:33664
    ds_read_b128 a[28:31], v100 offset:33728
    s_waitcnt lgkmcnt(14)
    v_mfma_f32_16x16x32_bf16 v[112:115], a[192:195], a[128:131], 0
    v_mfma_f32_16x16x32_bf16 v[112:115], a[196:199], a[132:135], v[112:115]
    v_mfma_f32_16x16x32_bf16 v[112:115], a[200:203], a[136:139], v[112:115]
    v_mfma_f32_16x16x32_bf16 v[112:115], a[204:207], a[140:143], v[112:115]
    v_mfma_f32_16x16x32_bf16 v[112:115], a[208:211], a[144:147], v[112:115]
    v_mfma_f32_16x16x32_bf16 v[112:115], a[212:215], a[148:151], v[112:115]
    v_mfma_f32_16x16x32_bf16 v[112:115], a[216:219], a[152:155], v[112:115]
    v_mfma_f32_16x16x32_bf16 v[112:115], a[220:223], a[156:159], v[112:115]
    v_mfma_f32_16x16x32_bf16 v[116:119], a[224:227], a[128:131], 0
    v_mfma_f32_16x16x32_bf16 v[116:119], a[228:231], a[132:135], v[116:119]
    s_waitcnt lgkmcnt(13)
    v_mfma_f32_16x16x32_bf16 v[116:119], a[232:235], a[136:139], v[116:119]
    s_waitcnt lgkmcnt(12)
    v_mfma_f32_16x16x32_bf16 v[116:119], a[236:239], a[140:143], v[116:119]
    s_waitcnt lgkmcnt(11)
    v_mfma_f32_16x16x32_bf16 v[116:119], a[240:243], a[144:147], v[116:119]
    v_max3_f32 v20, v112, v113, v114
    v_max_f32 v20, v20, v115
    s_waitcnt lgkmcnt(10)
    v_mfma_f32_16x16x32_bf16 v[116:119], a[244:247], a[148:151], v[116:119]
    s_waitcnt lgkmcnt(9)
    v_mfma_f32_16x16x32_bf16 v[116:119], a[248:251], a[152:155], v[116:119]
    s_waitcnt lgkmcnt(8)
    v_mfma_f32_16x16x32_bf16 v[116:119], a[252:255], a[156:159], v[116:119]
    s_waitcnt lgkmcnt(0)
    v_mfma_f32_16x16x32_bf16 v[120:123], a[192:195], a[0:3], 0
    v_mfma_f32_16x16x32_bf16 v[120:123], a[196:199], a[4:7], v[120:123]
    v_mfma_f32_16x16x32_bf16 v[120:123], a[200:203], a[8:11], v[120:123]
    v_mfma_f32_16x16x32_bf16 v[120:123], a[204:207], a[12:15], v[120:123]
    v_mfma_f32_16x16x32_bf16 v[120:123], a[208:211], a[16:19], v[120:123]
    s_nop 1
    v_max3_f32 v20, v20, v116, v117
    v_max3_f32 v16, v20, v118, v119
    v_mfma_f32_16x16x32_bf16 v[120:123], a[212:215], a[20:23], v[120:123]
    v_max3_f32 v17, v20, v118, v119
    v_mfma_f32_16x16x32_bf16 v[120:123], a[216:219], a[24:27], v[120:123]
    s_nop 0
    v_permlane32_swap_b32 v16, v17
    v_max_f32 v20, v16, v17
    v_mfma_f32_16x16x32_bf16 v[120:123], a[220:223], a[28:31], v[120:123]
    v_max_f32 v17, v16, v17
    v_mfma_f32_16x16x32_bf16 v[124:127], a[224:227], a[0:3], 0
    s_nop 0
    v_permlane16_swap_b32 v20, v17
    v_max_f32 v16, v20, v17
    v_mfma_f32_16x16x32_bf16 v[124:127], a[228:231], a[4:7], v[124:127]
    v_add_f32 v16, 0x420c0000, v16
    v_cndmask_b32 v40, -v16, v40, s[42:43]
    v_mfma_f32_16x16x32_bf16 v[124:127], a[232:235], a[8:11], v[124:127]
    v_cndmask_b32 v41, -v16, v41, s[42:43]
    v_cndmask_b32 v42, -v16, v42, s[42:43]
    v_mfma_f32_16x16x32_bf16 v[124:127], a[236:239], a[12:15], v[124:127]
    v_cndmask_b32 v43, -v16, v43, s[42:43]
    v_add_f32 v112, v112, v40
    v_mfma_f32_16x16x32_bf16 v[124:127], a[240:243], a[16:19], v[124:127]
    v_max3_f32 v20, v120, v121, v122
    v_max_f32 v20, v20, v123
    v_mfma_f32_16x16x32_bf16 v[124:127], a[244:247], a[20:23], v[124:127]
    v_add_f32 v113, v113, v40
    v_add_f32 v114, v114, v40
    v_mfma_f32_16x16x32_bf16 v[124:127], a[248:251], a[24:27], v[124:127]
    v_exp_f32 v112, v112
    v_mfma_f32_16x16x32_bf16 v[124:127], a[252:255], a[28:31], v[124:127]
    v_add_f32 v115, v115, v40
    v_add_f32 v12, v112, v12
    s_waitcnt vmcnt(10)
    buffer_load_dwordx4 v[204:207], v96, s[12:15], s49 offen offset:1536
    s_nop 3
    v_max3_f32 v20, v20, v124, v125
    v_lshlrev_b32 v104, 16, v160
    v_max3_f32 v16, v20, v126, v127
    v_and_b32 v105, s39, v160
    v_max3_f32 v17, v20, v126, v127
    v_lshlrev_b32 v106, 16, v161
    s_nop 0
    v_permlane32_swap_b32 v16, v17
    v_and_b32 v107, s39, v161
    v_max_f32 v20, v16, v17
    v_lshlrev_b32 v108, 16, v162
    v_max_f32 v17, v16, v17
    v_and_b32 v109, s39, v162
    s_nop 0
    v_permlane16_swap_b32 v20, v17
    v_lshlrev_b32 v110, 16, v163
    v_max_f32 v16, v20, v17
    v_and_b32 v111, s39, v163
    v_add_f32 v16, 0x420c0000, v16
    v_pk_mul_f32 v[104:105], v[104:105], s[40:41]
    v_cndmask_b32 v24, -v16, v24, s[42:43]
    v_pk_mul_f32 v[106:107], v[106:107], s[40:41]
    v_add_f32 v120, v120, v24
    v_pk_mul_f32 v[108:109], v[108:109], s[40:41]
    v_add_f32 v121, v121, v24
    v_pk_mul_f32 v[110:111], v[110:111], s[40:41]
    v_add_f32 v122, v122, v24
    v_cvt_pk_bf16_f32 v160, v104, v105
    v_add_f32 v123, v123, v24
    v_cvt_pk_bf16_f32 v161, v106, v107
    v_add_f32 v124, v124, v24
    v_cvt_pk_bf16_f32 v162, v108, v109
    v_add_f32 v125, v125, v24
    v_cvt_pk_bf16_f32 v163, v110, v111
    v_add_f32 v126, v126, v24
    ds_write_b128 v97, v[160:163] offset:0
    v_add_f32 v127, v127, v24
    v_exp_f32 v120, v120
    v_exp_f32 v113, v113
    s_nop 0
    v_cvt_pk_bf16_f32 v14, v112, v113
    v_exp_f32 v121, v121
    s_nop 0
    v_cvt_pk_bf16_f32 v64, v120, v121
    v_exp_f32 v114, v114
    v_exp_f32 v122, v122
    v_exp_f32 v115, v115
    s_nop 0
    v_cvt_pk_bf16_f32 v15, v114, v115
    v_exp_f32 v123, v123
    s_nop 0
    v_cvt_pk_bf16_f32 v65, v122, v123
    v_exp_f32 v124, v124
    v_exp_f32 v125, v125
    s_nop 0
    v_cvt_pk_bf16_f32 v66, v124, v125
    v_exp_f32 v126, v126
    v_exp_f32 v127, v127
    s_nop 0
    v_cvt_pk_bf16_f32 v67, v126, v127
    s_mov_b32 m0, s36
    s_nop 0
    ds_write_addtid_b32 v14 offset:2048
    ds_write_addtid_b32 v15 offset:2304
    v_cndmask_b32 v25, -v16, v25, s[42:43]
    v_cndmask_b32 v26, -v16, v26, s[42:43]
    v_cndmask_b32 v27, -v16, v27, s[42:43]
    v_add_f32 v8, v120, v8
    v_add_f32 v12, v113, v12
    v_add_f32 v8, v121, v8
    v_add_f32 v12, v114, v12
    v_add_f32 v8, v122, v8
    v_add_f32 v12, v115, v12
    v_add_f32 v8, v123, v8
    s_waitcnt vmcnt(10)
    s_add_u32 m0, s35, 0
    s_nop 0
    buffer_load_dwordx4 v5, s[20:23], s33 offen lds
    v_lshlrev_b32 v104, 16, v164
    v_and_b32 v105, s39, v164
    v_lshlrev_b32 v106, 16, v165
    v_and_b32 v107, s39, v165
    v_lshlrev_b32 v108, 16, v166
    v_and_b32 v109, s39, v166
    v_lshlrev_b32 v110, 16, v167
    v_and_b32 v111, s39, v167
    v_pk_mul_f32 v[104:105], v[104:105], s[40:41]
    v_pk_mul_f32 v[106:107], v[106:107], s[40:41]
    v_pk_mul_f32 v[108:109], v[108:109], s[40:41]
    v_pk_mul_f32 v[110:111], v[110:111], s[40:41]
    v_cvt_pk_bf16_f32 v164, v104, v105
    v_cvt_pk_bf16_f32 v165, v106, v107
    v_cvt_pk_bf16_f32 v166, v108, v109
    v_cvt_pk_bf16_f32 v167, v110, v111
    ds_write_b128 v97, v[164:167] offset:2080
    s_waitcnt vmcnt(10)
    s_add_u32 m0, s35, 1552
    s_nop 0
    buffer_load_dwordx4 v5, s[20:23], s33 offen offset:512 lds
    v_lshlrev_b32 v104, 16, v168
    v_and_b32 v105, s39, v168
    v_lshlrev_b32 v106, 16, v169
    v_and_b32 v107, s39, v169
    v_lshlrev_b32 v108, 16, v170
    v_and_b32 v109, s39, v170
    v_lshlrev_b32 v110, 16, v171
    v_and_b32 v111, s39, v171
    v_pk_mul_f32 v[104:105], v[104:105], s[40:41]
    v_pk_mul_f32 v[106:107], v[106:107], s[40:41]
    v_pk_mul_f32 v[108:109], v[108:109], s[40:41]
    v_pk_mul_f32 v[110:111], v[110:111], s[40:41]
    v_cvt_pk_bf16_f32 v168, v104, v105
    v_cvt_pk_bf16_f32 v169, v106, v107
    v_cvt_pk_bf16_f32 v170, v108, v109
    v_cvt_pk_bf16_f32 v171, v110, v111
    ds_write_b128 v97, v[168:171] offset:4160
    s_waitcnt vmcnt(10)
    s_add_u32 m0, s35, 3104
    s_nop 0
    buffer_load_dwordx4 v5, s[20:23], s33 offen offset:1024 lds
    v_lshlrev_b32 v104, 16, v172
    v_and_b32 v105, s39, v172
    v_lshlrev_b32 v106, 16, v173
    v_and_b32 v107, s39, v173
    v_lshlrev_b32 v108, 16, v174
    v_and_b32 v109, s39, v174
    v_lshlrev_b32 v110, 16, v175
    v_and_b32 v111, s39, v175
    v_pk_mul_f32 v[104:105], v[104:105], s[40:41]
    v_pk_mul_f32 v[106:107], v[106:107], s[40:41]
    v_pk_mul_f32 v[108:109], v[108:109], s[40:41]
    v_pk_mul_f32 v[110:111], v[110:111], s[40:41]
    v_cvt_pk_bf16_f32 v172, v104, v105
    v_cvt_pk_bf16_f32 v173, v106, v107
    v_cvt_pk_bf16_f32 v174, v108, v109
    v_cvt_pk_bf16_f32 v175, v110, v111
    ds_write_b128 v97, v[172:175] offset:6240
    s_waitcnt lgkmcnt(0)
    s_barrier
    ds_read_b128 a[32:35], v100 offset:0
    ds_read_b128 a[36:39], v100 offset:64
    ds_read_b128 a[40:43], v100 offset:128
    ds_read_b128 a[44:47], v100 offset:192
    ds_read_b128 a[48:51], v100 offset:256
    ds_read_b128 a[52:55], v100 offset:320
    ds_read_b128 a[56:59], v100 offset:384
    ds_read_b128 a[60:63], v100 offset:448
    s_waitcnt lgkmcnt(7)
    v_mfma_f32_16x16x32_bf16 v[120:123], a[192:195], a[32:35], 0
    s_waitcnt lgkmcnt(6)
    v_mfma_f32_16x16x32_bf16 v[120:123], a[196:199], a[36:39], v[120:123]
    s_waitcnt lgkmcnt(5)
    v_mfma_f32_16x16x32_bf16 v[120:123], a[200:203], a[40:43], v[120:123]
    s_waitcnt lgkmcnt(4)
    v_mfma_f32_16x16x32_bf16 v[120:123], a[204:207], a[44:47], v[120:123]
    s_waitcnt lgkmcnt(3)
    v_mfma_f32_16x16x32_bf16 v[120:123], a[208:211], a[48:51], v[120:123]
    s_waitcnt lgkmcnt(2)
    v_mfma_f32_16x16x32_bf16 v[120:123], a[212:215], a[52:55], v[120:123]
    s_waitcnt lgkmcnt(1)
    v_mfma_f32_16x16x32_bf16 v[120:123], a[216:219], a[56:59], v[120:123]
    s_waitcnt lgkmcnt(0)
    v_mfma_f32_16x16x32_bf16 v[120:123], a[220:223], a[60:63], v[120:123]
    v_mfma_f32_16x16x32_bf16 v[124:127], a[224:227], a[32:35], 0
    v_mfma_f32_16x16x32_bf16 v[124:127], a[228:231], a[36:39], v[124:127]
    v_mfma_f32_16x16x32_bf16 v[124:127], a[232:235], a[40:43], v[124:127]
    v_mfma_f32_16x16x32_bf16 v[124:127], a[236:239], a[44:47], v[124:127]
    v_mfma_f32_16x16x32_bf16 v[124:127], a[240:243], a[48:51], v[124:127]
    s_nop 2
    v_max3_f32 v20, v120, v121, v122
    v_max_f32 v20, v20, v123
    v_mfma_f32_16x16x32_bf16 v[124:127], a[244:247], a[52:55], v[124:127]
    v_mfma_f32_16x16x32_bf16 v[124:127], a[248:251], a[56:59], v[124:127]
    v_mfma_f32_16x16x32_bf16 v[124:127], a[252:255], a[60:63], v[124:127]
    s_waitcnt vmcnt(6)
    s_add_u32 m0, s35, 4656
    s_nop 0
    buffer_load_dwordx4 v5, s[20:23], s33 offen offset:1536 lds
    s_add_u32 s33, s33, s49
    buffer_load_dwordx4 v[224:227], v96, s[12:15], s50 offen
    buffer_load_dwordx4 v[228:231], v96, s[12:15], s50 offen offset:512
    buffer_load_dwordx4 v[232:235], v96, s[12:15], s50 offen offset:1024
    buffer_load_dwordx4 v[236:239], v96, s[12:15], s50 offen offset:1536
    v_max3_f32 v20, v20, v124, v125
    v_lshlrev_b32 v104, 16, v192
    v_max3_f32 v16, v20, v126, v127
    v_and_b32 v105, s39, v192
    v_max3_f32 v17, v20, v126, v127
    v_lshlrev_b32 v106, 16, v193
    s_nop 0
    v_permlane32_swap_b32 v16, v17
    v_and_b32 v107, s39, v193
    v_max_f32 v20, v16, v17
    v_lshlrev_b32 v108, 16, v194
    v_max_f32 v17, v16, v17
    v_and_b32 v109, s39, v194
    s_nop 0
    v_permlane16_swap_b32 v20, v17
    v_lshlrev_b32 v110, 16, v195
    v_max_f32 v16, v20, v17
    v_and_b32 v111, s39, v195
    v_add_f32 v16, 0x420c0000, v16
    v_pk_mul_f32 v[104:105], v[104:105], s[40:41]
    v_cndmask_b32 v28, -v16, v28, s[42:43]
    v_pk_mul_f32 v[106:107], v[106:107], s[40:41]
    v_add_f32 v120, v120, v28
    v_pk_mul_f32 v[108:109], v[108:109], s[40:41]
    v_add_f32 v121, v121, v28
    v_pk_mul_f32 v[110:111], v[110:111], s[40:41]
    v_add_f32 v122, v122, v28
    v_cvt_pk_bf16_f32 v192, v104, v105
    v_add_f32 v123, v123, v28
    v_cvt_pk_bf16_f32 v193, v106, v107
    v_add_f32 v124, v124, v28
    v_cvt_pk_bf16_f32 v194, v108, v109
    v_add_f32 v125, v125, v28
    v_cvt_pk_bf16_f32 v195, v110, v111
    v_add_f32 v126, v126, v28
    ds_write_b128 v97, v[192:195] offset:49920
    v_add_f32 v127, v127, v28
    v_exp_f32 v120, v120
    v_exp_f32 v121, v121
    s_nop 0
    v_cvt_pk_bf16_f32 v68, v120, v121
    v_exp_f32 v122, v122
    v_exp_f32 v123, v123
    s_nop 0
    v_cvt_pk_bf16_f32 v69, v122, v123
    v_exp_f32 v124, v124
    v_exp_f32 v125, v125
    s_nop 0
    v_cvt_pk_bf16_f32 v70, v124, v125
    v_exp_f32 v126, v126
    v_exp_f32 v127, v127
    s_nop 0
    v_cvt_pk_bf16_f32 v71, v126, v127
    v_cndmask_b32 v29, -v16, v29, s[42:43]
    v_cndmask_b32 v30, -v16, v30, s[42:43]
    v_cndmask_b32 v31, -v16, v31, s[42:43]
    v_add_f32 v9, v120, v9
    v_add_f32 v9, v121, v9
    v_add_f32 v9, v122, v9
    v_add_f32 v9, v123, v9
    s_waitcnt vmcnt(10)
    s_add_u32 m0, s34, 33280
    s_nop 0
    buffer_load_dwordx4 v4, s[16:19], s32 offen lds
    v_lshlrev_b32 v104, 16, v196
    v_and_b32 v105, s39, v196
    v_lshlrev_b32 v106, 16, v197
    v_and_b32 v107, s39, v197
    v_lshlrev_b32 v108, 16, v198
    v_and_b32 v109, s39, v198
    v_lshlrev_b32 v110, 16, v199
    v_and_b32 v111, s39, v199
    v_pk_mul_f32 v[104:105], v[104:105], s[40:41]
    v_pk_mul_f32 v[106:107], v[106:107], s[40:41]
    v_pk_mul_f32 v[108:109], v[108:109], s[40:41]
    v_pk_mul_f32 v[110:111], v[110:111], s[40:41]
    v_cvt_pk_bf16_f32 v196, v104, v105
    v_cvt_pk_bf16_f32 v197, v106, v107
    v_cvt_pk_bf16_f32 v198, v108, v109
    v_cvt_pk_bf16_f32 v199, v110, v111
    ds_write_b128 v97, v[196:199] offset:52000
    s_waitcnt vmcnt(10)
    s_add_u32 m0, s34, 34848
    s_nop 0
    buffer_load_dwordx4 v4, s[16:19], s32 offen offset:512 lds
    v_lshlrev_b32 v104, 16, v200
    v_and_b32 v105, s39, v200
    v_lshlrev_b32 v106, 16, v201
    v_and_b32 v107, s39, v201
    v_lshlrev_b32 v108, 16, v202
    v_and_b32 v109, s39, v202
    v_lshlrev_b32 v110, 16, v203
    v_and_b32 v111, s39, v203
    v_pk_mul_f32 v[104:105], v[104:105], s[40:41]
    v_pk_mul_f32 v[106:107], v[106:107], s[40:41]
    v_pk_mul_f32 v[108:109], v[108:109], s[40:41]
    v_pk_mul_f32 v[110:111], v[110:111], s[40:41]
    v_cvt_pk_bf16_f32 v200, v104, v105
    v_cvt_pk_bf16_f32 v201, v106, v107
    v_cvt_pk_bf16_f32 v202, v108, v109
    v_cvt_pk_bf16_f32 v203, v110, v111
    ds_write_b128 v97, v[200:203] offset:54080
    s_waitcnt vmcnt(10)
    s_add_u32 m0, s34, 36416
    s_nop 0
    buffer_load_dwordx4 v4, s[16:19], s32 offen offset:1024 lds
    v_lshlrev_b32 v104, 16, v204
    v_and_b32 v105, s39, v204
    v_lshlrev_b32 v106, 16, v205
    v_and_b32 v107, s39, v205
    v_lshlrev_b32 v108, 16, v206
    v_and_b32 v109, s39, v206
    v_lshlrev_b32 v110, 16, v207
    v_and_b32 v111, s39, v207
    v_pk_mul_f32 v[104:105], v[104:105], s[40:41]
    v_pk_mul_f32 v[106:107], v[106:107], s[40:41]
    v_pk_mul_f32 v[108:109], v[108:109], s[40:41]
    v_pk_mul_f32 v[110:111], v[110:111], s[40:41]
    v_cvt_pk_bf16_f32 v204, v104, v105
    v_cvt_pk_bf16_f32 v205, v106, v107
    v_cvt_pk_bf16_f32 v206, v108, v109
    v_cvt_pk_bf16_f32 v207, v110, v111
    ds_write_b128 v97, v[204:207] offset:56160
    s_waitcnt lgkmcnt(0)
    s_barrier
    ds_read_b128 a[160:163], v1 offset:16640
    ds_read_b128 a[164:167], v1 offset:16704
    ds_read_b128 a[168:171], v1 offset:16768
    ds_read_b128 a[172:175], v1 offset:16832
    ds_read_b128 a[176:179], v1 offset:16896
    ds_read_b128 a[180:183], v1 offset:16960
    ds_read_b128 a[184:187], v1 offset:17024
    ds_read_b128 a[188:191], v1 offset:17088
    ds_read_b128 a[64:67], v100 offset:49920
    ds_read_b128 a[68:71], v100 offset:49984
    ds_read_b128 a[72:75], v100 offset:50048
    ds_read_b128 a[76:79], v100 offset:50112
    ds_read_b128 a[80:83], v100 offset:50176
    ds_read_b128 a[84:87], v100 offset:50240
    ds_read_b128 a[88:91], v100 offset:50304
    ds_read_b128 a[92:95], v100 offset:50368
    s_waitcnt lgkmcnt(14)
    v_mfma_f32_16x16x32_bf16 v[44:47], a[160:163], a[0:3], v[24:27]
    s_waitcnt lgkmcnt(7)
    v_mfma_f32_16x16x32_bf16 v[44:47], a[164:167], a[4:7], v[44:47]
    v_mfma_f32_16x16x32_bf16 v[44:47], a[168:171], a[8:11], v[44:47]
    v_mfma_f32_16x16x32_bf16 v[44:47], a[172:175], a[12:15], v[44:47]
    v_mfma_f32_16x16x32_bf16 v[44:47], a[176:179], a[16:19], v[44:47]
    v_mfma_f32_16x16x32_bf16 v[44:47], a[180:183], a[20:23], v[44:47]
    v_mfma_f32_16x16x32_bf16 v[44:47], a[184:187], a[24:27], v[44:47]
    v_mfma_f32_16x16x32_bf16 v[44:47], a[188:191], a[28:31], v[44:47]
    v_mfma_f32_16x16x32_bf16 v[120:123], a[192:195], a[64:67], 0
    s_waitcnt lgkmcnt(0)
    v_mfma_f32_16x16x32_bf16 v[120:123], a[196:199], a[68:71], v[120:123]
    v_mfma_f32_16x16x32_bf16 v[120:123], a[200:203], a[72:75], v[120:123]
    v_mfma_f32_16x16x32_bf16 v[120:123], a[204:207], a[76:79], v[120:123]
    s_nop 2
    v_exp_f32 v44, v44
    v_mfma_f32_16x16x32_bf16 v[120:123], a[208:211], a[80:83], v[120:123]
    v_exp_f32 v45, v45
    v_mfma_f32_16x16x32_bf16 v[120:123], a[212:215], a[84:87], v[120:123]
    v_exp_f32 v46, v46
    v_mfma_f32_16x16x32_bf16 v[120:123], a[216:219], a[88:91], v[120:123]
    v_exp_f32 v47, v47
    v_mfma_f32_16x16x32_bf16 v[120:123], a[220:223], a[92:95], v[120:123]
    s_mov_b32 m0, s36
    v_cvt_pk_bf16_f32 v80, v44, v45
    v_cvt_pk_bf16_f32 v81, v46, v47
    v_mfma_f32_16x16x32_bf16 v[124:127], a[224:227], a[64:67], 0
    ds_write_addtid_b32 v80 offset:10240
    v_add_f32 v8, v44, v8
    v_mfma_f32_16x16x32_bf16 v[124:127], a[228:231], a[68:71], v[124:127]
    ds_write_addtid_b32 v81 offset:10496
    v_add_f32 v8, v45, v8
    v_mfma_f32_16x16x32_bf16 v[124:127], a[232:235], a[72:75], v[124:127]
    v_add_f32 v8, v46, v8
    v_add_f32 v8, v47, v8
    v_mfma_f32_16x16x32_bf16 v[124:127], a[236:239], a[76:79], v[124:127]
    v_mfma_f32_16x16x32_bf16 v[124:127], a[240:243], a[80:83], v[124:127]
    v_max3_f32 v20, v120, v121, v122
    v_max_f32 v20, v20, v123
    v_mfma_f32_16x16x32_bf16 v[124:127], a[244:247], a[84:87], v[124:127]
    v_mfma_f32_16x16x32_bf16 v[124:127], a[248:251], a[88:91], v[124:127]
    v_mfma_f32_16x16x32_bf16 v[124:127], a[252:255], a[92:95], v[124:127]
    v_mfma_f32_16x16x32_bf16 v[48:51], a[160:163], a[32:35], v[28:31]
    v_mfma_f32_16x16x32_bf16 v[48:51], a[164:167], a[36:39], v[48:51]
    v_mfma_f32_16x16x32_bf16 v[48:51], a[168:171], a[40:43], v[48:51]
    v_mfma_f32_16x16x32_bf16 v[48:51], a[172:175], a[44:47], v[48:51]
    v_mfma_f32_16x16x32_bf16 v[48:51], a[176:179], a[48:51], v[48:51]
    s_nop 2
    v_max3_f32 v20, v20, v124, v125
    v_max3_f32 v16, v20, v126, v127
    v_mfma_f32_16x16x32_bf16 v[48:51], a[180:183], a[52:55], v[48:51]
    v_max3_f32 v17, v20, v126, v127
    v_mfma_f32_16x16x32_bf16 v[48:51], a[184:187], a[56:59], v[48:51]
    s_nop 0
    v_permlane32_swap_b32 v16, v17
    v_max_f32 v20, v16, v17
    v_mfma_f32_16x16x32_bf16 v[48:51], a[188:191], a[60:63], v[48:51]
    v_max_f32 v17, v16, v17
    v_mfma_f32_16x16x32_bf16 v[60:63], a[160:163], a[128:131], v[40:43]
    s_nop 0
    v_permlane16_swap_b32 v20, v17
    v_max_f32 v16, v20, v17
    v_mfma_f32_16x16x32_bf16 v[60:63], a[164:167], a[132:135], v[60:63]
    v_add_f32 v16, 0x420c0000, v16
    v_cndmask_b32 v32, -v16, v32, s[42:43]
    v_mfma_f32_16x16x32_bf16 v[60:63], a[168:171], a[136:139], v[60:63]
    v_add_f32 v120, v120, v32
    v_add_f32 v121, v121, v32
    v_mfma_f32_16x16x32_bf16 v[60:63], a[172:175], a[140:143], v[60:63]
    v_add_f32 v122, v122, v32
    v_add_f32 v123, v123, v32
    v_mfma_f32_16x16x32_bf16 v[60:63], a[176:179], a[144:147], v[60:63]
    v_add_f32 v124, v124, v32
    v_add_f32 v125, v125, v32
    v_mfma_f32_16x16x32_bf16 v[60:63], a[180:183], a[148:151], v[60:63]
    v_add_f32 v126, v126, v32
    v_add_f32 v127, v127, v32
    v_mfma_f32_16x16x32_bf16 v[60:63], a[184:187], a[152:155], v[60:63]
    v_exp_f32 v120, v120
    v_mfma_f32_16x16x32_bf16 v[60:63], a[188:191], a[156:159], v[60:63]
    v_exp_f32 v121, v121
    s_waitcnt vmcnt(6)
    s_add_u32 m0, s34, 37984
    s_nop 0
    buffer_load_dwordx4 v4, s[16:19], s32 offen offset:1536 lds
    s_add_u32 s32, s32, s49
    s_add_u32 m0, s35, 16640
    s_nop 0
    buffer_load_dwordx4 v5, s[20:23], s33 offen lds
    s_add_u32 m0, s35, 18192
    s_nop 0
    buffer_load_dwordx4 v5, s[20:23], s33 offen offset:512 lds
    s_add_u32 m0, s35, 19744
    s_nop 0
    buffer_load_dwordx4 v5, s[20:23], s33 offen offset:1024 lds
    s_add_u32 m0, s35, 21296
    s_nop 0
    buffer_load_dwordx4 v5, s[20:23], s33 offen offset:1536 lds
    s_add_u32 s33, s33, s49
    v_cvt_pk_bf16_f32 v72, v120, v121
    v_lshlrev_b32 v104, 16, v224
    v_exp_f32 v122, v122
    v_and_b32 v105, s39, v224
    v_exp_f32 v123, v123
    v_lshlrev_b32 v106, 16, v225
    v_cvt_pk_bf16_f32 v73, v122, v123
    v_and_b32 v107, s39, v225
    v_exp_f32 v124, v124
    v_lshlrev_b32 v108, 16, v226
    v_exp_f32 v125, v125
    v_and_b32 v109, s39, v226
    v_cvt_pk_bf16_f32 v74, v124, v125
    v_lshlrev_b32 v110, 16, v227
    v_exp_f32 v126, v126
    v_and_b32 v111, s39, v227
    v_exp_f32 v127, v127
    v_pk_mul_f32 v[104:105], v[104:105], s[40:41]
    v_cvt_pk_bf16_f32 v75, v126, v127
    v_pk_mul_f32 v[106:107], v[106:107], s[40:41]
    v_exp_f32 v48, v48
    v_pk_mul_f32 v[108:109], v[108:109], s[40:41]
    v_exp_f32 v49, v49
    v_pk_mul_f32 v[110:111], v[110:111], s[40:41]
    v_exp_f32 v50, v50
    v_cvt_pk_bf16_f32 v224, v104, v105
    v_exp_f32 v51, v51
    v_cvt_pk_bf16_f32 v225, v106, v107
    v_cvt_pk_bf16_f32 v84, v48, v49
    v_cvt_pk_bf16_f32 v226, v108, v109
    v_exp_f32 v60, v60
    v_cvt_pk_bf16_f32 v227, v110, v111
    v_cvt_pk_bf16_f32 v85, v50, v51
    ds_write_b128 v98, v[224:227] offset:0
    v_exp_f32 v61, v61
    s_mov_b32 m0, s36
    s_nop 0
    ds_write_addtid_b32 v84 offset:10752
    v_exp_f32 v62, v62
    ds_write_addtid_b32 v85 offset:11008
    v_exp_f32 v63, v63
    v_cvt_pk_bf16_f32 v14, v60, v61
    v_cvt_pk_bf16_f32 v15, v62, v63
    ds_write_addtid_b32 v14 offset:12288
    ds_write_addtid_b32 v15 offset:12544
    v_add_f32 v9, v48, v9
    v_add_f32 v12, v60, v12
    v_add_f32 v9, v49, v9
    v_add_f32 v12, v61, v12
    v_add_f32 v9, v50, v9
    v_add_f32 v12, v62, v12
    v_add_f32 v9, v51, v9
    v_add_f32 v12, v63, v12
    v_cndmask_b32 v33, -v16, v33, s[42:43]
    v_cndmask_b32 v34, -v16, v34, s[42:43]
    v_cndmask_b32 v35, -v16, v35, s[42:43]
    v_add_f32 v10, v120, v10
    v_add_f32 v10, v121, v10
    v_add_f32 v10, v122, v10
    v_add_f32 v10, v123, v10
    s_waitcnt vmcnt(10)
    s_add_u32 m0, s34, 49920
    s_nop 0
    buffer_load_dwordx4 v4, s[16:19], s32 offen lds
    v_lshlrev_b32 v104, 16, v228
    v_and_b32 v105, s39, v228
    v_lshlrev_b32 v106, 16, v229
    v_and_b32 v107, s39, v229
    v_lshlrev_b32 v108, 16, v230
    v_and_b32 v109, s39, v230
    v_lshlrev_b32 v110, 16, v231
    v_and_b32 v111, s39, v231
    v_pk_mul_f32 v[104:105], v[104:105], s[40:41]
    v_pk_mul_f32 v[106:107], v[106:107], s[40:41]
    v_pk_mul_f32 v[108:109], v[108:109], s[40:41]
    v_pk_mul_f32 v[110:111], v[110:111], s[40:41]
    v_cvt_pk_bf16_f32 v228, v104, v105
    v_cvt_pk_bf16_f32 v229, v106, v107
    v_cvt_pk_bf16_f32 v230, v108, v109
    v_cvt_pk_bf16_f32 v231, v110, v111
    ds_write_b128 v98, v[228:231] offset:2080
    s_waitcnt vmcnt(10)
    s_add_u32 m0, s34, 51488
    s_nop 0
    buffer_load_dwordx4 v4, s[16:19], s32 offen offset:512 lds
    v_lshlrev_b32 v104, 16, v232
    v_and_b32 v105, s39, v232
    v_lshlrev_b32 v106, 16, v233
    v_and_b32 v107, s39, v233
    v_lshlrev_b32 v108, 16, v234
    v_and_b32 v109, s39, v234
    v_lshlrev_b32 v110, 16, v235
    v_and_b32 v111, s39, v235
    v_pk_mul_f32 v[104:105], v[104:105], s[40:41]
    v_pk_mul_f32 v[106:107], v[106:107], s[40:41]
    v_pk_mul_f32 v[108:109], v[108:109], s[40:41]
    v_pk_mul_f32 v[110:111], v[110:111], s[40:41]
    v_cvt_pk_bf16_f32 v232, v104, v105
    v_cvt_pk_bf16_f32 v233, v106, v107
    v_cvt_pk_bf16_f32 v234, v108, v109
    v_cvt_pk_bf16_f32 v235, v110, v111
    ds_write_b128 v98, v[232:235] offset:4160
    s_waitcnt vmcnt(10)
    v_lshlrev_b32 v104, 16, v236
    v_and_b32 v105, s39, v236
    v_lshlrev_b32 v106, 16, v237
    v_and_b32 v107, s39, v237
    v_lshlrev_b32 v108, 16, v238
    v_and_b32 v109, s39, v238
    v_lshlrev_b32 v110, 16, v239
    v_and_b32 v111, s39, v239
    v_pk_mul_f32 v[104:105], v[104:105], s[40:41]
    v_pk_mul_f32 v[106:107], v[106:107], s[40:41]
    v_pk_mul_f32 v[108:109], v[108:109], s[40:41]
    v_pk_mul_f32 v[110:111], v[110:111], s[40:41]
    v_cvt_pk_bf16_f32 v236, v104, v105
    v_cvt_pk_bf16_f32 v237, v106, v107
    v_cvt_pk_bf16_f32 v238, v108, v109
    v_cvt_pk_bf16_f32 v239, v110, v111
    ds_write_b128 v98, v[236:239] offset:6240
    s_waitcnt lgkmcnt(0)
    s_barrier
    ds_read_b128 a[96:99], v101 offset:0
    ds_read_b128 a[100:103], v101 offset:64
    ds_read_b128 a[104:107], v101 offset:128
    ds_read_b128 a[108:111], v101 offset:192
    ds_read_b128 a[112:115], v101 offset:256
    ds_read_b128 a[116:119], v101 offset:320
    ds_read_b128 a[120:123], v101 offset:384
    ds_read_b128 a[124:127], v101 offset:448
    v_mfma_f32_16x16x32_bf16 v[52:55], a[160:163], a[64:67], v[32:35]
    s_add_u32 m0, s34, 53056
    v_mfma_f32_16x16x32_bf16 v[52:55], a[164:167], a[68:71], v[52:55]
    buffer_load_dwordx4 v4, s[16:19], s32 offen offset:1024 lds
    v_mfma_f32_16x16x32_bf16 v[52:55], a[168:171], a[72:75], v[52:55]
    s_waitcnt lgkmcnt(5)
    v_mfma_f32_16x16x32_bf16 v[52:55], a[172:175], a[76:79], v[52:55]
    s_add_u32 m0, s34, 54624
    v_mfma_f32_16x16x32_bf16 v[52:55], a[176:179], a[80:83], v[52:55]
    buffer_load_dwordx4 v4, s[16:19], s32 offen offset:1536 lds
    v_mfma_f32_16x16x32_bf16 v[52:55], a[180:183], a[84:87], v[52:55]
    s_add_u32 s32, s32, s49
    v_mfma_f32_16x16x32_bf16 v[52:55], a[184:187], a[88:91], v[52:55]
    s_add_u32 m0, s35, 33280
    v_mfma_f32_16x16x32_bf16 v[52:55], a[188:191], a[92:95], v[52:55]
    buffer_load_dwordx4 v5, s[20:23], s33 offen lds
    v_mfma_f32_16x16x32_bf16 v[120:123], a[192:195], a[96:99], 0
    s_waitcnt lgkmcnt(0)
    ds_read_b64_tr_b16 a[192:193], v2 offset:128
    v_mfma_f32_16x16x32_bf16 v[120:123], a[196:199], a[100:103], v[120:123]
    s_add_u32 m0, s35, 34832
    ds_read_b64_tr_b16 a[196:197], v2 offset:0
    v_mfma_f32_16x16x32_bf16 v[120:123], a[200:203], a[104:107], v[120:123]
    buffer_load_dwordx4 v5, s[20:23], s33 offen offset:512 lds
    v_mfma_f32_16x16x32_bf16 v[120:123], a[204:207], a[108:111], v[120:123]
    v_exp_f32 v52, v52
    v_mfma_f32_16x16x32_bf16 v[120:123], a[208:211], a[112:115], v[120:123]
    s_add_u32 m0, s35, 36384
    v_exp_f32 v53, v53
    v_mfma_f32_16x16x32_bf16 v[120:123], a[212:215], a[116:119], v[120:123]
    buffer_load_dwordx4 v5, s[20:23], s33 offen offset:1024 lds
    v_mfma_f32_16x16x32_bf16 v[120:123], a[216:219], a[120:123], v[120:123]
    ds_read_b64_tr_b16 a[198:199], v3 offset:0
    v_cvt_pk_bf16_f32 v88, v52, v53
    v_mfma_f32_16x16x32_bf16 v[120:123], a[220:223], a[124:127], v[120:123]
    s_add_u32 m0, s35, 37936
    ds_read_b64_tr_b16 a[204:205], v2 offset:16
    v_add_f32 v10, v52, v10
    v_mfma_f32_16x16x32_bf16 v[124:127], a[224:227], a[96:99], 0
    buffer_load_dwordx4 v5, s[20:23], s33 offen offset:1536 lds
    v_mfma_f32_16x16x32_bf16 v[124:127], a[228:231], a[100:103], v[124:127]
    s_add_u32 s33, s33, s49
    v_exp_f32 v54, v54
    v_mfma_f32_16x16x32_bf16 v[124:127], a[232:235], a[104:107], v[124:127]
    s_add_u32 m0, s34, 0
    ds_read_b64_tr_b16 a[206:207], v3 offset:16
    v_add_f32 v10, v53, v10
L_pad0_0:
    s_cbranch_vccnz L_pad0_2
    v_mfma_f32_16x16x32_bf16 v[124:127], a[236:239], a[108:111], v[124:127]
    buffer_load_dwordx4 v4, s[16:19], s32 offen lds
    v_mfma_f32_16x16x32_bf16 v[124:127], a[240:243], a[112:115], v[124:127]
    v_max3_f32 v20, v120, v121, v122
    v_max_f32 v20, v20, v123
    v_mfma_f32_16x16x32_bf16 v[124:127], a[244:247], a[116:119], v[124:127]
    s_add_u32 m0, s34, 1568
    ds_read_b64_tr_b16 a[212:213], v2 offset:32
    v_add_f32 v10, v54, v10
    v_mfma_f32_16x16x32_bf16 v[124:127], a[248:251], a[120:123], v[124:127]
    buffer_load_dwordx4 v4, s[16:19], s32 offen offset:512 lds
    v_mfma_f32_16x16x32_bf16 v[124:127], a[252:255], a[124:127], v[124:127]
    v_exp_f32 v55, v55
    v_mfma_f32_16x16x32_bf16 v[56:59], a[160:163], a[96:99], 0
    ds_read_b64_tr_b16 a[214:215], v3 offset:32
    v_cvt_pk_bf16_f32 v89, v54, v55
    v_mfma_f32_16x16x32_bf16 v[56:59], a[164:167], a[100:103], v[56:59]
    s_waitcnt vmcnt(14)
    ds_read_b64_tr_b16 a[220:221], v2 offset:48
    v_add_f32 v10, v55, v10
    v_mfma_f32_16x16x32_bf16 v[56:59], a[168:171], a[104:107], v[56:59]
    s_barrier
    ds_read_b64_tr_b16 a[222:223], v3 offset:48
    v_mfma_f32_16x16x32_bf16 v[56:59], a[172:175], a[108:111], v[56:59]
    ds_read_b128 a[160:163], v1 offset:33280
    v_mfma_f32_16x16x32_bf16 v[56:59], a[176:179], a[112:115], v[56:59]
    v_max3_f32 v20, v20, v124, v125
    v_max3_f32 v16, v20, v126, v127
    v_mfma_f32_16x16x32_bf16 v[56:59], a[180:183], a[116:119], v[56:59]
    ds_read_b128 a[164:167], v1 offset:33344
    v_max3_f32 v17, v20, v126, v127
    v_mfma_f32_16x16x32_bf16 v[56:59], a[184:187], a[120:123], v[56:59]
    s_nop 0
    v_permlane32_swap_b32 v16, v17
    v_max_f32 v20, v16, v17
    v_mfma_f32_16x16x32_bf16 v[56:59], a[188:191], a[124:127], v[56:59]
    s_waitcnt lgkmcnt(5)
    ds_read_b128 a[168:171], v1 offset:33408
    v_max_f32 v17, v16, v17
    v_mfma_f32_16x16x32_bf16 v[128:131], v[64:67], a[196:199], 0
    s_nop 0
    v_permlane16_swap_b32 v20, v17
    v_max_f32 v16, v20, v17
    v_mfma_f32_16x16x32_bf16 v[132:135], v[64:67], a[204:207], 0
    s_waitcnt lgkmcnt(5)
    v_add_f32 v16, 0x420c0000, v16
    v_cndmask_b32 v36, -v16, v36, s[42:43]
    v_mfma_f32_16x16x32_bf16 v[136:139], v[64:67], a[212:215], 0
    s_waitcnt lgkmcnt(3)
    v_add_f32 v120, v120, v36
    v_add_f32 v121, v121, v36
    v_mfma_f32_16x16x32_bf16 v[140:143], v[64:67], a[220:223], 0
    v_add_f32 v122, v122, v36
    v_add_f32 v123, v123, v36
    v_mfma_f32_16x16x32_bf16 v[160:163], v[68:71], a[196:199], 0
    v_add_f32 v124, v124, v36
    v_add_f32 v125, v125, v36
    v_mfma_f32_16x16x32_bf16 v[164:167], v[68:71], a[204:207], 0
    v_add_f32 v126, v126, v36
    v_add_f32 v127, v127, v36
    v_mfma_f32_16x16x32_bf16 v[168:171], v[68:71], a[212:215], 0
    v_exp_f32 v120, v120
    v_mfma_f32_16x16x32_bf16 v[172:175], v[68:71], a[220:223], 0
    v_exp_f32 v121, v121
    v_mfma_f32_16x16x32_bf16 v[192:195], v[72:75], a[196:199], 0
    ds_read_b128 a[172:175], v1 offset:33472
    v_cvt_pk_bf16_f32 v76, v120, v121
    v_mfma_f32_16x16x32_bf16 v[196:199], v[72:75], a[204:207], 0
    v_exp_f32 v122, v122
    v_mfma_f32_16x16x32_bf16 v[200:203], v[72:75], a[212:215], 0
    v_exp_f32 v123, v123
    v_mfma_f32_16x16x32_bf16 v[204:207], v[72:75], a[220:223], 0
    ds_read_b128 a[176:179], v1 offset:33536
    v_cvt_pk_bf16_f32 v77, v122, v123
    v_exp_f32 v124, v124
    v_exp_f32 v125, v125
    s_nop 0
    v_cvt_pk_bf16_f32 v78, v124, v125
    v_exp_f32 v126, v126
    v_exp_f32 v127, v127
    s_nop 0
    v_cvt_pk_bf16_f32 v79, v126, v127
    s_nop 1
    v_mfma_f32_16x16x32_bf16 v[224:227], v[76:79], a[196:199], 0
    ds_read_b128 a[180:183], v1 offset:33600
    v_add_f32 v56, v56, v36
    v_mfma_f32_16x16x32_bf16 v[228:231], v[76:79], a[204:207], 0
    ds_read_b128 a[184:187], v1 offset:33664
    v_add_f32 v57, v57, v36
    v_mfma_f32_16x16x32_bf16 v[232:235], v[76:79], a[212:215], 0
    ds_read_b128 a[188:191], v1 offset:33728
    v_add_f32 v58, v58, v36
    v_mfma_f32_16x16x32_bf16 v[236:239], v[76:79], a[220:223], 0
    v_exp_f32 v56, v56
    v_exp_f32 v57, v57
    v_add_f32 v59, v59, v36
    s_mov_b32 m0, s36
    s_nop 0
    ds_write_addtid_b32 v88 offset:11264
    v_exp_f32 v58, v58
    ds_write_addtid_b32 v89 offset:11520
    v_exp_f32 v59, v59
    v_cvt_pk_bf16_f32 v92, v56, v57
    v_cvt_pk_bf16_f32 v93, v58, v59
    ds_write_addtid_b32 v92 offset:11776
    ds_write_addtid_b32 v93 offset:12032
    v_add_f32 v11, v56, v11
    v_add_f32 v11, v57, v11
    v_add_f32 v11, v58, v11
    v_add_f32 v11, v59, v11
    ds_read_b64_tr_b16 a[194:195], v3 offset:128
    ds_read_b64_tr_b16 a[200:201], v2 offset:144
    ds_read_b64_tr_b16 a[202:203], v3 offset:144
    ds_read_b64_tr_b16 a[208:209], v2 offset:160
    ds_read_b64_tr_b16 a[210:211], v3 offset:160
    ds_read_b64_tr_b16 a[216:217], v2 offset:176
    ds_read_b64_tr_b16 a[218:219], v3 offset:176
    v_cndmask_b32 v37, -v16, v37, s[42:43]
    v_cndmask_b32 v38, -v16, v38, s[42:43]
    v_cndmask_b32 v39, -v16, v39, s[42:43]
    v_add_f32 v11, v120, v11
    v_add_f32 v11, v121, v11
    v_add_f32 v11, v122, v11
    v_add_f32 v11, v123, v11
    s_add_u32 m0, s34, 3136
    s_nop 0
    buffer_load_dwordx4 v4, s[16:19], s32 offen offset:1024 lds
    s_add_u32 m0, s34, 4704
    s_nop 0
    buffer_load_dwordx4 v4, s[16:19], s32 offen offset:1536 lds
    s_add_u32 s32, s32, s49
    s_waitcnt vmcnt(12) lgkmcnt(7)
    s_barrier
    v_mfma_f32_16x16x32_bf16 v[44:47], a[160:163], a[0:3], v[24:27]
    s_add_u32 m0, s35, 49920
    ds_read_b64_tr_b16 a[196:197], v2 offset:16768
    v_mfma_f32_16x16x32_bf16 v[44:47], a[164:167], a[4:7], v[44:47]
    buffer_load_dwordx4 v5, s[20:23], s33 offen lds
    v_mfma_f32_16x16x32_bf16 v[44:47], a[168:171], a[8:11], v[44:47]
    ds_read2st64_b32 v[82:83], v6 offset0:40 offset1:41
    v_mfma_f32_16x16x32_bf16 v[44:47], a[172:175], a[12:15], v[44:47]
    ds_read_b64_tr_b16 a[198:199], v3 offset:16768
    v_mfma_f32_16x16x32_bf16 v[44:47], a[176:179], a[16:19], v[44:47]
    ds_read2st64_b32 v[86:87], v6 offset0:42 offset1:43
    v_mfma_f32_16x16x32_bf16 v[44:47], a[180:183], a[20:23], v[44:47]
    ds_read2st64_b32 v[90:91], v6 offset0:44 offset1:45
    v_mfma_f32_16x16x32_bf16 v[44:47], a[184:187], a[24:27], v[44:47]
    ds_read2st64_b32 v[94:95], v6 offset0:46 offset1:47
    v_mfma_f32_16x16x32_bf16 v[44:47], a[188:191], a[28:31], v[44:47]
    ds_read_b64_tr_b16 a[204:205], v2 offset:16784
    v_mfma_f32_16x16x32_bf16 v[48:51], a[188:191], a[60:63], v[28:31]
    ds_read_b64_tr_b16 a[206:207], v3 offset:16784
    v_mfma_f32_16x16x32_bf16 v[48:51], a[184:187], a[56:59], v[48:51]
    s_add_u32 m0, s35, 51472
    ds_read_b64_tr_b16 a[212:213], v2 offset:16800
    v_mfma_f32_16x16x32_bf16 v[48:51], a[180:183], a[52:55], v[48:51]
    buffer_load_dwordx4 v5, s[20:23], s33 offen offset:512 lds
    v_mfma_f32_16x16x32_bf16 v[48:51], a[176:179], a[48:51], v[48:51]
    ds_read_b64_tr_b16 a[214:215], v3 offset:16800
    v_mfma_f32_16x16x32_bf16 v[48:51], a[172:175], a[44:47], v[48:51]
    ds_read_b64_tr_b16 a[220:221], v2 offset:16816
    v_mfma_f32_16x16x32_bf16 v[48:51], a[168:171], a[40:43], v[48:51]
    s_add_u32 m0, s35, 53024
    ds_read_b64_tr_b16 a[222:223], v3 offset:16816
    v_mfma_f32_16x16x32_bf16 v[48:51], a[164:167], a[36:39], v[48:51]
    buffer_load_dwordx4 v5, s[20:23], s33 offen offset:1024 lds
    v_mfma_f32_16x16x32_bf16 v[48:51], a[160:163], a[32:35], v[48:51]
    v_exp_f32 v44, v44
    v_mfma_f32_16x16x32_bf16 v[52:55], a[160:163], a[64:67], v[32:35]
    v_exp_f32 v45, v45
    v_mfma_f32_16x16x32_bf16 v[52:55], a[164:167], a[68:71], v[52:55]
    v_cvt_pk_bf16_f32 v96, v44, v45
    v_add_f32 v8, v44, v8
    v_mfma_f32_16x16x32_bf16 v[52:55], a[168:171], a[72:75], v[52:55]
    s_add_u32 m0, s35, 54576
    v_exp_f32 v46, v46
    v_mfma_f32_16x16x32_bf16 v[52:55], a[172:175], a[76:79], v[52:55]
    buffer_load_dwordx4 v5, s[20:23], s33 offen offset:1536 lds
    v_mfma_f32_16x16x32_bf16 v[52:55], a[176:179], a[80:83], v[52:55]
    s_mov_b32 m0, s36
    v_exp_f32 v47, v47
    v_mfma_f32_16x16x32_bf16 v[52:55], a[180:183], a[84:87], v[52:55]
    s_add_u32 s33, s33, s49
    ds_write_addtid_b32 v96 offset:0
    v_cvt_pk_bf16_f32 v97, v46, v47
    v_mfma_f32_16x16x32_bf16 v[52:55], a[184:187], a[88:91], v[52:55]
    v_exp_f32 v48, v48
    v_mfma_f32_16x16x32_bf16 v[52:55], a[188:191], a[92:95], v[52:55]
    v_exp_f32 v49, v49
    v_mfma_f32_16x16x32_bf16 v[56:59], a[188:191], a[124:127], v[36:39]
    ds_write_addtid_b32 v97 offset:256
    v_cvt_pk_bf16_f32 v100, v48, v49
    v_mfma_f32_16x16x32_bf16 v[56:59], a[184:187], a[120:123], v[56:59]
    v_exp_f32 v50, v50
    v_mfma_f32_16x16x32_bf16 v[56:59], a[180:183], a[116:119], v[56:59]
    s_add_u32 m0, s34, 16640
    v_exp_f32 v51, v51
    v_mfma_f32_16x16x32_bf16 v[56:59], a[176:179], a[112:115], v[56:59]
    buffer_load_dwordx4 v4, s[16:19], s32 offen lds
    v_mfma_f32_16x16x32_bf16 v[56:59], a[172:175], a[108:111], v[56:59]
    s_mov_b32 m0, s36
    v_exp_f32 v52, v52
    v_mfma_f32_16x16x32_bf16 v[56:59], a[168:171], a[104:107], v[56:59]
    ds_write_addtid_b32 v100 offset:512
    v_cvt_pk_bf16_f32 v101, v50, v51
    v_mfma_f32_16x16x32_bf16 v[56:59], a[164:167], a[100:103], v[56:59]
    v_exp_f32 v53, v53
    v_mfma_f32_16x16x32_bf16 v[56:59], a[160:163], a[96:99], v[56:59]
    ds_write_addtid_b32 v101 offset:768
    v_cvt_pk_bf16_f32 v104, v52, v53
    v_mfma_f32_16x16x32_bf16 v[60:63], a[160:163], a[128:131], v[40:43]
    v_exp_f32 v54, v54
    v_mfma_f32_16x16x32_bf16 v[60:63], a[164:167], a[132:135], v[60:63]
    v_exp_f32 v55, v55
    v_mfma_f32_16x16x32_bf16 v[60:63], a[168:171], a[136:139], v[60:63]
    ds_write_addtid_b32 v104 offset:1024
    v_cvt_pk_bf16_f32 v105, v54, v55
    v_mfma_f32_16x16x32_bf16 v[60:63], a[172:175], a[140:143], v[60:63]
    s_add_u32 m0, s34, 18208
    v_exp_f32 v56, v56
    v_mfma_f32_16x16x32_bf16 v[60:63], a[176:179], a[144:147], v[60:63]
    buffer_load_dwordx4 v4, s[16:19], s32 offen offset:512 lds
    v_mfma_f32_16x16x32_bf16 v[60:63], a[180:183], a[148:151], v[60:63]
    s_mov_b32 m0, s36
    v_exp_f32 v57, v57
    v_mfma_f32_16x16x32_bf16 v[60:63], a[184:187], a[152:155], v[60:63]
    ds_write_addtid_b32 v105 offset:1280
    v_cvt_pk_bf16_f32 v108, v56, v57
    v_mfma_f32_16x16x32_bf16 v[60:63], a[188:191], a[156:159], v[60:63]
    s_waitcnt lgkmcnt(6)
    v_exp_f32 v58, v58
    v_mfma_f32_16x16x32_bf16 v[144:147], v[64:67], a[192:195], v[144:147]
    v_exp_f32 v59, v59
    v_mfma_f32_16x16x32_bf16 v[144:147], v[80:83], a[196:199], v[144:147]
    ds_write_addtid_b32 v108 offset:1536
    v_cvt_pk_bf16_f32 v109, v58, v59
    v_mfma_f32_16x16x32_bf16 v[176:179], v[68:71], a[192:195], v[176:179]
    ds_write_addtid_b32 v109 offset:1792
    v_add_f32 v9, v48, v9
    v_mfma_f32_16x16x32_bf16 v[176:179], v[84:87], a[196:199], v[176:179]
    v_exp_f32 v60, v60
    v_mfma_f32_16x16x32_bf16 v[208:211], v[72:75], a[192:195], v[208:211]
    s_add_u32 m0, s34, 19776
    v_exp_f32 v61, v61
    v_mfma_f32_16x16x32_bf16 v[208:211], v[88:91], a[196:199], v[208:211]
    buffer_load_dwordx4 v4, s[16:19], s32 offen offset:1024 lds
    v_mfma_f32_16x16x32_bf16 v[240:243], v[76:79], a[192:195], v[240:243]
    v_cvt_pk_bf16_f32 v14, v60, v61
    v_add_f32 v10, v52, v10
    v_mfma_f32_16x16x32_bf16 v[240:243], v[92:95], a[196:199], v[240:243]
    v_exp_f32 v62, v62
    v_mfma_f32_16x16x32_bf16 v[244:247], v[76:79], a[200:203], v[244:247]
    s_mov_b32 m0, s36
    v_exp_f32 v63, v63
    v_mfma_f32_16x16x32_bf16 v[244:247], v[92:95], a[204:207], v[244:247]
    ds_write_addtid_b32 v14 offset:2048
    v_cvt_pk_bf16_f32 v15, v62, v63
    v_mfma_f32_16x16x32_bf16 v[212:215], v[72:75], a[200:203], v[212:215]
    ds_write_addtid_b32 v15 offset:2304
    v_add_f32 v11, v56, v11
    v_mfma_f32_16x16x32_bf16 v[212:215], v[88:91], a[204:207], v[212:215]
    s_waitcnt vmcnt(15)
    v_add_f32 v12, v60, v12
    v_add_f32 v8, v45, v8
    v_mfma_f32_16x16x32_bf16 v[180:183], v[68:71], a[200:203], v[180:183]
    s_barrier
    v_add_f32 v9, v49, v9
    v_add_f32 v10, v53, v10
    v_mfma_f32_16x16x32_bf16 v[180:183], v[84:87], a[204:207], v[180:183]
    s_add_u32 m0, s34, 21344
    ds_read_b128 a[160:163], v1 offset:49920
    v_add_f32 v11, v57, v11
    v_mfma_f32_16x16x32_bf16 v[148:151], v[64:67], a[200:203], v[148:151]
    buffer_load_dwordx4 v4, s[16:19], s32 offen offset:1536 lds
    v_mfma_f32_16x16x32_bf16 v[148:151], v[80:83], a[204:207], v[148:151]
    s_add_u32 s32, s32, s49
    ds_read_b128 a[164:167], v1 offset:49984
    v_add_f32 v12, v61, v12
    v_mfma_f32_16x16x32_bf16 v[152:155], v[64:67], a[208:211], v[152:155]
    ds_read_b128 a[168:171], v1 offset:50048
    v_add_f32 v8, v46, v8
    v_mfma_f32_16x16x32_bf16 v[152:155], v[80:83], a[212:215], v[152:155]
    ds_read_b128 a[172:175], v1 offset:50112
    v_add_f32 v9, v50, v9
    v_mfma_f32_16x16x32_bf16 v[184:187], v[68:71], a[208:211], v[184:187]
    ds_read_b128 a[176:179], v1 offset:50176
    v_add_f32 v10, v54, v10
    v_mfma_f32_16x16x32_bf16 v[184:187], v[84:87], a[212:215], v[184:187]
    ds_read_b128 a[180:183], v1 offset:50240
    v_add_f32 v11, v58, v11
    v_mfma_f32_16x16x32_bf16 v[216:219], v[72:75], a[208:211], v[216:219]
    ds_read_b128 a[184:187], v1 offset:50304
    v_add_f32 v12, v62, v12
    v_mfma_f32_16x16x32_bf16 v[216:219], v[88:91], a[212:215], v[216:219]
    ds_read_b128 a[188:191], v1 offset:50368
    v_add_f32 v8, v47, v8
    v_mfma_f32_16x16x32_bf16 v[248:251], v[76:79], a[208:211], v[248:251]
    s_add_u32 m0, s34, 33280
    ds_read_b64_tr_b16 a[192:193], v2 offset:16640
    v_add_f32 v9, v51, v9
    v_mfma_f32_16x16x32_bf16 v[248:251], v[92:95], a[212:215], v[248:251]
    buffer_load_dwordx4 v4, s[16:19], s32 offen lds
    v_mfma_f32_16x16x32_bf16 v[252:255], v[76:79], a[216:219], v[252:255]
    ds_read_b64_tr_b16 a[194:195], v3 offset:16640
    v_add_f32 v10, v55, v10
    v_mfma_f32_16x16x32_bf16 v[252:255], v[92:95], a[220:223], v[252:255]
    ds_read_b64_tr_b16 a[200:201], v2 offset:16656
    v_add_f32 v11, v59, v11
    v_mfma_f32_16x16x32_bf16 v[220:223], v[72:75], a[216:219], v[220:223]
    ds_read_b64_tr_b16 a[202:203], v3 offset:16656
    v_add_f32 v12, v63, v12
    v_mfma_f32_16x16x32_bf16 v[220:223], v[88:91], a[220:223], v[220:223]
    ds_read_b64_tr_b16 a[208:209], v2 offset:16672
    v_mfma_f32_16x16x32_bf16 v[188:191], v[68:71], a[216:219], v[188:191]
    v_mfma_f32_16x16x32_bf16 v[188:191], v[84:87], a[220:223], v[188:191]
    ds_read_b64_tr_b16 a[210:211], v3 offset:16672
    v_mfma_f32_16x16x32_bf16 v[156:159], v[64:67], a[216:219], v[156:159]
    s_waitcnt vmcnt(13) lgkmcnt(6)
    ds_read_b64_tr_b16 a[216:217], v2 offset:16688
    v_mfma_f32_16x16x32_bf16 v[156:159], v[80:83], a[220:223], v[156:159]
    s_barrier
    ds_read_b64_tr_b16 a[218:219], v3 offset:16688
    v_mfma_f32_16x16x32_bf16 v[44:47], a[160:163], a[0:3], v[24:27]
    s_add_u32 m0, s35, 0
    ds_read_b64_tr_b16 a[196:197], v2 offset:33280
    v_mfma_f32_16x16x32_bf16 v[44:47], a[164:167], a[4:7], v[44:47]
    buffer_load_dwordx4 v5, s[20:23], s33 offen lds
    v_mfma_f32_16x16x32_bf16 v[44:47], a[168:171], a[8:11], v[44:47]
    ds_read2st64_b32 v[98:99], v6 offset0:0 offset1:1
    v_mfma_f32_16x16x32_bf16 v[44:47], a[172:175], a[12:15], v[44:47]
    ds_read_b64_tr_b16 a[198:199], v3 offset:33280
    v_mfma_f32_16x16x32_bf16 v[44:47], a[176:179], a[16:19], v[44:47]
    ds_read2st64_b32 v[102:103], v6 offset0:2 offset1:3
    v_mfma_f32_16x16x32_bf16 v[44:47], a[180:183], a[20:23], v[44:47]
    ds_read2st64_b32 v[106:107], v6 offset0:4 offset1:5
    v_mfma_f32_16x16x32_bf16 v[44:47], a[184:187], a[24:27], v[44:47]
    ds_read2st64_b32 v[110:111], v6 offset0:6 offset1:7
    v_mfma_f32_16x16x32_bf16 v[44:47], a[188:191], a[28:31], v[44:47]
    ds_read_b64_tr_b16 a[204:205], v2 offset:33296
    v_mfma_f32_16x16x32_bf16 v[48:51], a[188:191], a[60:63], v[28:31]
    ds_read_b64_tr_b16 a[206:207], v3 offset:33296
    v_mfma_f32_16x16x32_bf16 v[48:51], a[184:187], a[56:59], v[48:51]
    s_add_u32 m0, s35, 1552
    ds_read_b64_tr_b16 a[212:213], v2 offset:33312
    v_mfma_f32_16x16x32_bf16 v[48:51], a[180:183], a[52:55], v[48:51]
    buffer_load_dwordx4 v5, s[20:23], s33 offen offset:512 lds
    v_mfma_f32_16x16x32_bf16 v[48:51], a[176:179], a[48:51], v[48:51]
    ds_read_b64_tr_b16 a[214:215], v3 offset:33312
    v_mfma_f32_16x16x32_bf16 v[48:51], a[172:175], a[44:47], v[48:51]
    ds_read_b64_tr_b16 a[220:221], v2 offset:33328
    v_mfma_f32_16x16x32_bf16 v[48:51], a[168:171], a[40:43], v[48:51]
    s_add_u32 m0, s35, 3104
    ds_read_b64_tr_b16 a[222:223], v3 offset:33328
    v_mfma_f32_16x16x32_bf16 v[48:51], a[164:167], a[36:39], v[48:51]
    buffer_load_dwordx4 v5, s[20:23], s33 offen offset:1024 lds
    v_mfma_f32_16x16x32_bf16 v[48:51], a[160:163], a[32:35], v[48:51]
    v_exp_f32 v44, v44
    v_mfma_f32_16x16x32_bf16 v[52:55], a[160:163], a[64:67], v[32:35]
    v_exp_f32 v45, v45
    v_mfma_f32_16x16x32_bf16 v[52:55], a[164:167], a[68:71], v[52:55]
    v_cvt_pk_bf16_f32 v112, v44, v45
    v_add_f32 v8, v44, v8
    v_mfma_f32_16x16x32_bf16 v[52:55], a[168:171], a[72:75], v[52:55]
    s_add_u32 m0, s35, 4656
    v_exp_f32 v46, v46
    v_mfma_f32_16x16x32_bf16 v[52:55], a[172:175], a[76:79], v[52:55]
    buffer_load_dwordx4 v5, s[20:23], s33 offen offset:1536 lds
    v_mfma_f32_16x16x32_bf16 v[52:55], a[176:179], a[80:83], v[52:55]
    s_mov_b32 m0, s36
    v_exp_f32 v47, v47
    v_mfma_f32_16x16x32_bf16 v[52:55], a[180:183], a[84:87], v[52:55]
    s_add_u32 s33, s33, s49
    ds_write_addtid_b32 v112 offset:10240
    v_cvt_pk_bf16_f32 v113, v46, v47
    v_mfma_f32_16x16x32_bf16 v[52:55], a[184:187], a[88:91], v[52:55]
    v_exp_f32 v48, v48
    v_mfma_f32_16x16x32_bf16 v[52:55], a[188:191], a[92:95], v[52:55]
    v_exp_f32 v49, v49
    v_mfma_f32_16x16x32_bf16 v[56:59], a[188:191], a[124:127], v[36:39]
    ds_write_addtid_b32 v113 offset:10496
    v_cvt_pk_bf16_f32 v116, v48, v49
    v_mfma_f32_16x16x32_bf16 v[56:59], a[184:187], a[120:123], v[56:59]
    v_exp_f32 v50, v50
    v_mfma_f32_16x16x32_bf16 v[56:59], a[180:183], a[116:119], v[56:59]
    s_add_u32 m0, s34, 34848
    v_exp_f32 v51, v51
    v_mfma_f32_16x16x32_bf16 v[56:59], a[176:179], a[112:115], v[56:59]
    buffer_load_dwordx4 v4, s[16:19], s32 offen offset:512 lds
    v_mfma_f32_16x16x32_bf16 v[56:59], a[172:175], a[108:111], v[56:59]
    s_mov_b32 m0, s36
    v_exp_f32 v52, v52
    v_mfma_f32_16x16x32_bf16 v[56:59], a[168:171], a[104:107], v[56:59]
    ds_write_addtid_b32 v116 offset:10752
    v_cvt_pk_bf16_f32 v117, v50, v51
    v_mfma_f32_16x16x32_bf16 v[56:59], a[164:167], a[100:103], v[56:59]
    v_exp_f32 v53, v53
    v_mfma_f32_16x16x32_bf16 v[56:59], a[160:163], a[96:99], v[56:59]
    ds_write_addtid_b32 v117 offset:11008
    v_cvt_pk_bf16_f32 v120, v52, v53
    v_mfma_f32_16x16x32_bf16 v[60:63], a[160:163], a[128:131], v[40:43]
    v_exp_f32 v54, v54
    v_mfma_f32_16x16x32_bf16 v[60:63], a[164:167], a[132:135], v[60:63]
    v_exp_f32 v55, v55
    v_mfma_f32_16x16x32_bf16 v[60:63], a[168:171], a[136:139], v[60:63]
    ds_write_addtid_b32 v120 offset:11264
    v_cvt_pk_bf16_f32 v121, v54, v55
    v_mfma_f32_16x16x32_bf16 v[60:63], a[172:175], a[140:143], v[60:63]
    s_add_u32 m0, s34, 36416
    v_exp_f32 v56, v56
    v_mfma_f32_16x16x32_bf16 v[60:63], a[176:179], a[144:147], v[60:63]
    buffer_load_dwordx4 v4, s[16:19], s32 offen offset:1024 lds
    v_mfma_f32_16x16x32_bf16 v[60:63], a[180:183], a[148:151], v[60:63]
    s_mov_b32 m0, s36
    v_exp_f32 v57, v57
    v_mfma_f32_16x16x32_bf16 v[60:63], a[184:187], a[152:155], v[60:63]
    ds_write_addtid_b32 v121 offset:11520
    v_cvt_pk_bf16_f32 v124, v56, v57
    v_mfma_f32_16x16x32_bf16 v[60:63], a[188:191], a[156:159], v[60:63]
    s_waitcnt lgkmcnt(6)
    v_exp_f32 v58, v58
    v_mfma_f32_16x16x32_bf16 v[128:131], v[80:83], a[192:195], v[128:131]
    v_exp_f32 v59, v59
    v_mfma_f32_16x16x32_bf16 v[128:131], v[96:99], a[196:199], v[128:131]
    ds_write_addtid_b32 v124 offset:11776
    v_cvt_pk_bf16_f32 v125, v58, v59
    v_mfma_f32_16x16x32_bf16 v[160:163], v[84:87], a[192:195], v[160:163]
    ds_write_addtid_b32 v125 offset:12032
    v_add_f32 v9, v48, v9
    v_mfma_f32_16x16x32_bf16 v[160:163], v[100:103], a[196:199], v[160:163]
    v_exp_f32 v60, v60
    v_mfma_f32_16x16x32_bf16 v[192:195], v[88:91], a[192:195], v[192:195]
    s_add_u32 m0, s34, 37984
    v_exp_f32 v61, v61
    v_mfma_f32_16x16x32_bf16 v[192:195], v[104:107], a[196:199], v[192:195]
    buffer_load_dwordx4 v4, s[16:19], s32 offen offset:1536 lds
    v_mfma_f32_16x16x32_bf16 v[224:227], v[92:95], a[192:195], v[224:227]
    s_add_u32 s32, s32, s49
    v_cvt_pk_bf16_f32 v14, v60, v61
    v_add_f32 v10, v52, v10
    v_mfma_f32_16x16x32_bf16 v[224:227], v[108:111], a[196:199], v[224:227]
    v_exp_f32 v62, v62
    v_mfma_f32_16x16x32_bf16 v[228:231], v[92:95], a[200:203], v[228:231]
    s_mov_b32 m0, s36
    v_exp_f32 v63, v63
    v_mfma_f32_16x16x32_bf16 v[228:231], v[108:111], a[204:207], v[228:231]
    ds_write_addtid_b32 v14 offset:12288
    v_cvt_pk_bf16_f32 v15, v62, v63
    v_mfma_f32_16x16x32_bf16 v[196:199], v[88:91], a[200:203], v[196:199]
    ds_write_addtid_b32 v15 offset:12544
    v_add_f32 v11, v56, v11
    v_mfma_f32_16x16x32_bf16 v[196:199], v[104:107], a[204:207], v[196:199]
    s_waitcnt vmcnt(16)
    v_add_f32 v12, v60, v12
    v_add_f32 v8, v45, v8
    v_mfma_f32_16x16x32_bf16 v[164:167], v[84:87], a[200:203], v[164:167]
    s_barrier
    v_add_f32 v9, v49, v9
    v_add_f32 v10, v53, v10
    v_mfma_f32_16x16x32_bf16 v[164:167], v[100:103], a[204:207], v[164:167]
    s_add_u32 m0, s34, 49920
    ds_read_b128 a[160:163], v1 offset:0
    v_add_f32 v11, v57, v11
    v_mfma_f32_16x16x32_bf16 v[132:135], v[80:83], a[200:203], v[132:135]
    buffer_load_dwordx4 v4, s[16:19], s32 offen lds
    v_mfma_f32_16x16x32_bf16 v[132:135], v[96:99], a[204:207], v[132:135]
    ds_read_b128 a[164:167], v1 offset:64
    v_add_f32 v12, v61, v12
    v_mfma_f32_16x16x32_bf16 v[136:139], v[80:83], a[208:211], v[136:139]
    ds_read_b128 a[168:171], v1 offset:128
    v_add_f32 v8, v46, v8
    v_mfma_f32_16x16x32_bf16 v[136:139], v[96:99], a[212:215], v[136:139]
    ds_read_b128 a[172:175], v1 offset:192
    v_add_f32 v9, v50, v9
    v_mfma_f32_16x16x32_bf16 v[168:171], v[84:87], a[208:211], v[168:171]
    ds_read_b128 a[176:179], v1 offset:256
    v_add_f32 v10, v54, v10
    v_mfma_f32_16x16x32_bf16 v[168:171], v[100:103], a[212:215], v[168:171]
    ds_read_b128 a[180:183], v1 offset:320
    v_add_f32 v11, v58, v11
    v_mfma_f32_16x16x32_bf16 v[200:203], v[88:91], a[208:211], v[200:203]
    ds_read_b128 a[184:187], v1 offset:384
    v_add_f32 v12, v62, v12
    v_mfma_f32_16x16x32_bf16 v[200:203], v[104:107], a[212:215], v[200:203]
    ds_read_b128 a[188:191], v1 offset:448
    v_add_f32 v8, v47, v8
    v_mfma_f32_16x16x32_bf16 v[232:235], v[92:95], a[208:211], v[232:235]
    s_add_u32 m0, s34, 51488
    ds_read_b64_tr_b16 a[192:193], v2 offset:33408
    v_add_f32 v9, v51, v9
    v_mfma_f32_16x16x32_bf16 v[232:235], v[108:111], a[212:215], v[232:235]
    buffer_load_dwordx4 v4, s[16:19], s32 offen offset:512 lds
    v_mfma_f32_16x16x32_bf16 v[236:239], v[92:95], a[216:219], v[236:239]
    ds_read_b64_tr_b16 a[194:195], v3 offset:33408
    v_add_f32 v10, v55, v10
    v_mfma_f32_16x16x32_bf16 v[236:239], v[108:111], a[220:223], v[236:239]
    ds_read_b64_tr_b16 a[200:201], v2 offset:33424
    v_add_f32 v11, v59, v11
    v_mfma_f32_16x16x32_bf16 v[204:207], v[88:91], a[216:219], v[204:207]
    ds_read_b64_tr_b16 a[202:203], v3 offset:33424
    v_add_f32 v12, v63, v12
    v_mfma_f32_16x16x32_bf16 v[204:207], v[104:107], a[220:223], v[204:207]
    ds_read_b64_tr_b16 a[208:209], v2 offset:33440
    v_mfma_f32_16x16x32_bf16 v[172:175], v[84:87], a[216:219], v[172:175]
    v_mfma_f32_16x16x32_bf16 v[172:175], v[100:103], a[220:223], v[172:175]
    ds_read_b64_tr_b16 a[210:211], v3 offset:33440
    v_mfma_f32_16x16x32_bf16 v[140:143], v[80:83], a[216:219], v[140:143]
    s_waitcnt vmcnt(10) lgkmcnt(6)
    ds_read_b64_tr_b16 a[216:217], v2 offset:33456
    v_mfma_f32_16x16x32_bf16 v[140:143], v[96:99], a[220:223], v[140:143]
    s_barrier
    ds_read_b64_tr_b16 a[218:219], v3 offset:33456
    v_mfma_f32_16x16x32_bf16 v[44:47], a[160:163], a[0:3], v[24:27]
    s_add_u32 m0, s35, 16640
    ds_read_b64_tr_b16 a[196:197], v2 offset:50048
    v_mfma_f32_16x16x32_bf16 v[44:47], a[164:167], a[4:7], v[44:47]
    buffer_load_dwordx4 v5, s[20:23], s33 offen lds
    v_mfma_f32_16x16x32_bf16 v[44:47], a[168:171], a[8:11], v[44:47]
    ds_read2st64_b32 v[114:115], v6 offset0:40 offset1:41
    v_mfma_f32_16x16x32_bf16 v[44:47], a[172:175], a[12:15], v[44:47]
    ds_read_b64_tr_b16 a[198:199], v3 offset:50048
    v_mfma_f32_16x16x32_bf16 v[44:47], a[176:179], a[16:19], v[44:47]
    ds_read2st64_b32 v[118:119], v6 offset0:42 offset1:43
    v_mfma_f32_16x16x32_bf16 v[44:47], a[180:183], a[20:23], v[44:47]
    ds_read2st64_b32 v[122:123], v6 offset0:44 offset1:45
    v_mfma_f32_16x16x32_bf16 v[44:47], a[184:187], a[24:27], v[44:47]
    ds_read2st64_b32 v[126:127], v6 offset0:46 offset1:47
    v_mfma_f32_16x16x32_bf16 v[44:47], a[188:191], a[28:31], v[44:47]
    ds_read_b64_tr_b16 a[204:205], v2 offset:50064
    v_mfma_f32_16x16x32_bf16 v[48:51], a[188:191], a[60:63], v[28:31]
    ds_read_b64_tr_b16 a[206:207], v3 offset:50064
    v_mfma_f32_16x16x32_bf16 v[48:51], a[184:187], a[56:59], v[48:51]
    s_add_u32 m0, s35, 18192
    ds_read_b64_tr_b16 a[212:213], v2 offset:50080
    v_mfma_f32_16x16x32_bf16 v[48:51], a[180:183], a[52:55], v[48:51]
    buffer_load_dwordx4 v5, s[20:23], s33 offen offset:512 lds
    v_mfma_f32_16x16x32_bf16 v[48:51], a[176:179], a[48:51], v[48:51]
    ds_read_b64_tr_b16 a[214:215], v3 offset:50080
    v_mfma_f32_16x16x32_bf16 v[48:51], a[172:175], a[44:47], v[48:51]
    ds_read_b64_tr_b16 a[220:221], v2 offset:50096
    v_mfma_f32_16x16x32_bf16 v[48:51], a[168:171], a[40:43], v[48:51]
    s_add_u32 m0, s35, 19744
    ds_read_b64_tr_b16 a[222:223], v3 offset:50096
    v_mfma_f32_16x16x32_bf16 v[48:51], a[164:167], a[36:39], v[48:51]
    buffer_load_dwordx4 v5, s[20:23], s33 offen offset:1024 lds
    v_mfma_f32_16x16x32_bf16 v[48:51], a[160:163], a[32:35], v[48:51]
    s_cmp_eq_u32 s31, 1
    s_cselect_b32 s18, 0, s18
    v_exp_f32 v44, v44
    v_mfma_f32_16x16x32_bf16 v[52:55], a[160:163], a[64:67], v[32:35]
    v_exp_f32 v45, v45
    v_mfma_f32_16x16x32_bf16 v[52:55], a[164:167], a[68:71], v[52:55]
    v_cvt_pk_bf16_f32 v64, v44, v45
    v_add_f32 v8, v44, v8
    v_mfma_f32_16x16x32_bf16 v[52:55], a[168:171], a[72:75], v[52:55]
    s_add_u32 m0, s35, 21296
    v_exp_f32 v46, v46
    v_mfma_f32_16x16x32_bf16 v[52:55], a[172:175], a[76:79], v[52:55]
    buffer_load_dwordx4 v5, s[20:23], s33 offen offset:1536 lds
    v_mfma_f32_16x16x32_bf16 v[52:55], a[176:179], a[80:83], v[52:55]
    s_mov_b32 m0, s36
    v_exp_f32 v47, v47
    v_mfma_f32_16x16x32_bf16 v[52:55], a[180:183], a[84:87], v[52:55]
    s_add_u32 s33, s33, s49
    ds_write_addtid_b32 v64 offset:0
    v_cvt_pk_bf16_f32 v65, v46, v47
    v_mfma_f32_16x16x32_bf16 v[52:55], a[184:187], a[88:91], v[52:55]
    v_exp_f32 v48, v48
    v_mfma_f32_16x16x32_bf16 v[52:55], a[188:191], a[92:95], v[52:55]
    v_exp_f32 v49, v49
    v_mfma_f32_16x16x32_bf16 v[56:59], a[188:191], a[124:127], v[36:39]
    ds_write_addtid_b32 v65 offset:256
    v_cvt_pk_bf16_f32 v68, v48, v49
    v_mfma_f32_16x16x32_bf16 v[56:59], a[184:187], a[120:123], v[56:59]
    v_exp_f32 v50, v50
    v_mfma_f32_16x16x32_bf16 v[56:59], a[180:183], a[116:119], v[56:59]
    s_add_u32 m0, s34, 53056
    v_exp_f32 v51, v51
    v_mfma_f32_16x16x32_bf16 v[56:59], a[176:179], a[112:115], v[56:59]
    buffer_load_dwordx4 v4, s[16:19], s32 offen offset:1024 lds
    v_mfma_f32_16x16x32_bf16 v[56:59], a[172:175], a[108:111], v[56:59]
    s_mov_b32 m0, s36
    v_exp_f32 v52, v52
    v_mfma_f32_16x16x32_bf16 v[56:59], a[168:171], a[104:107], v[56:59]
    ds_write_addtid_b32 v68 offset:512
    v_cvt_pk_bf16_f32 v69, v50, v51
    v_mfma_f32_16x16x32_bf16 v[56:59], a[164:167], a[100:103], v[56:59]
    v_exp_f32 v53, v53
    v_mfma_f32_16x16x32_bf16 v[56:59], a[160:163], a[96:99], v[56:59]
    ds_write_addtid_b32 v69 offset:768
    v_cvt_pk_bf16_f32 v72, v52, v53
    v_mfma_f32_16x16x32_bf16 v[60:63], a[160:163], a[128:131], v[40:43]
    v_exp_f32 v54, v54
    v_mfma_f32_16x16x32_bf16 v[60:63], a[164:167], a[132:135], v[60:63]
    v_exp_f32 v55, v55
    v_mfma_f32_16x16x32_bf16 v[60:63], a[168:171], a[136:139], v[60:63]
    ds_write_addtid_b32 v72 offset:1024
    v_cvt_pk_bf16_f32 v73, v54, v55
    v_mfma_f32_16x16x32_bf16 v[60:63], a[172:175], a[140:143], v[60:63]
    s_add_u32 m0, s34, 54624
    v_exp_f32 v56, v56
    v_mfma_f32_16x16x32_bf16 v[60:63], a[176:179], a[144:147], v[60:63]
    buffer_load_dwordx4 v4, s[16:19], s32 offen offset:1536 lds
L_pad0_1:
    s_cbranch_vccnz L_pad0_3
    v_mfma_f32_16x16x32_bf16 v[60:63], a[180:183], a[148:151], v[60:63]
    s_mov_b32 m0, s36
    v_exp_f32 v57, v57
    v_mfma_f32_16x16x32_bf16 v[60:63], a[184:187], a[152:155], v[60:63]
    s_add_u32 s32, s32, s49
    ds_write_addtid_b32 v73 offset:1280
    v_cvt_pk_bf16_f32 v76, v56, v57
    v_mfma_f32_16x16x32_bf16 v[60:63], a[188:191], a[156:159], v[60:63]
    s_waitcnt lgkmcnt(6)
    v_exp_f32 v58, v58
    v_mfma_f32_16x16x32_bf16 v[144:147], v[96:99], a[192:195], v[144:147]
    v_exp_f32 v59, v59
    v_mfma_f32_16x16x32_bf16 v[144:147], v[112:115], a[196:199], v[144:147]
    ds_write_addtid_b32 v76 offset:1536
    v_cvt_pk_bf16_f32 v77, v58, v59
    v_mfma_f32_16x16x32_bf16 v[176:179], v[100:103], a[192:195], v[176:179]
    ds_write_addtid_b32 v77 offset:1792
    v_add_f32 v9, v48, v9
    v_mfma_f32_16x16x32_bf16 v[176:179], v[116:119], a[196:199], v[176:179]
    v_exp_f32 v60, v60
    v_mfma_f32_16x16x32_bf16 v[208:211], v[104:107], a[192:195], v[208:211]
    s_add_u32 m0, s34, 0
    v_exp_f32 v61, v61
    v_mfma_f32_16x16x32_bf16 v[208:211], v[120:123], a[196:199], v[208:211]
    buffer_load_dwordx4 v4, s[16:19], s32 offen lds
    v_mfma_f32_16x16x32_bf16 v[240:243], v[108:111], a[192:195], v[240:243]
    v_cvt_pk_bf16_f32 v14, v60, v61
    v_add_f32 v10, v52, v10
    v_mfma_f32_16x16x32_bf16 v[240:243], v[124:127], a[196:199], v[240:243]
    v_exp_f32 v62, v62
    v_mfma_f32_16x16x32_bf16 v[244:247], v[108:111], a[200:203], v[244:247]
    s_mov_b32 m0, s36
    v_exp_f32 v63, v63
    v_mfma_f32_16x16x32_bf16 v[244:247], v[124:127], a[204:207], v[244:247]
    ds_write_addtid_b32 v14 offset:2048
    v_cvt_pk_bf16_f32 v15, v62, v63
    v_mfma_f32_16x16x32_bf16 v[212:215], v[104:107], a[200:203], v[212:215]
    ds_write_addtid_b32 v15 offset:2304
    v_add_f32 v11, v56, v11
    v_mfma_f32_16x16x32_bf16 v[212:215], v[120:123], a[204:207], v[212:215]
    v_add_f32 v12, v60, v12
    v_add_f32 v8, v45, v8
    v_mfma_f32_16x16x32_bf16 v[180:183], v[100:103], a[200:203], v[180:183]
    v_add_f32 v9, v49, v9
    v_add_f32 v10, v53, v10
    v_mfma_f32_16x16x32_bf16 v[180:183], v[116:119], a[204:207], v[180:183]
    s_add_u32 m0, s34, 1568
    ds_read_b128 a[160:163], v1 offset:16640
    v_add_f32 v11, v57, v11
    v_mfma_f32_16x16x32_bf16 v[148:151], v[96:99], a[200:203], v[148:151]
    buffer_load_dwordx4 v4, s[16:19], s32 offen offset:512 lds
    v_mfma_f32_16x16x32_bf16 v[148:151], v[112:115], a[204:207], v[148:151]
    ds_read_b128 a[164:167], v1 offset:16704
    v_add_f32 v12, v61, v12
    v_mfma_f32_16x16x32_bf16 v[152:155], v[96:99], a[208:211], v[152:155]
    ds_read_b128 a[168:171], v1 offset:16768
    v_add_f32 v8, v46, v8
    v_mfma_f32_16x16x32_bf16 v[152:155], v[112:115], a[212:215], v[152:155]
    ds_read_b128 a[172:175], v1 offset:16832
    v_add_f32 v9, v50, v9
    v_mfma_f32_16x16x32_bf16 v[184:187], v[100:103], a[208:211], v[184:187]
    ds_read_b128 a[176:179], v1 offset:16896
    v_add_f32 v10, v54, v10
    v_mfma_f32_16x16x32_bf16 v[184:187], v[116:119], a[212:215], v[184:187]
    ds_read_b128 a[180:183], v1 offset:16960
    v_add_f32 v11, v58, v11
    v_mfma_f32_16x16x32_bf16 v[216:219], v[104:107], a[208:211], v[216:219]
    ds_read_b128 a[184:187], v1 offset:17024
    v_add_f32 v12, v62, v12
    v_mfma_f32_16x16x32_bf16 v[216:219], v[120:123], a[212:215], v[216:219]
    ds_read_b128 a[188:191], v1 offset:17088
    v_add_f32 v8, v47, v8
    v_mfma_f32_16x16x32_bf16 v[248:251], v[108:111], a[208:211], v[248:251]
    s_add_u32 m0, s34, 3136
    ds_read_b64_tr_b16 a[192:193], v2 offset:49920
    v_add_f32 v9, v51, v9
    v_mfma_f32_16x16x32_bf16 v[248:251], v[124:127], a[212:215], v[248:251]
    buffer_load_dwordx4 v4, s[16:19], s32 offen offset:1024 lds
    v_mfma_f32_16x16x32_bf16 v[252:255], v[108:111], a[216:219], v[252:255]
    ds_read_b64_tr_b16 a[194:195], v3 offset:49920
    v_add_f32 v10, v55, v10
    v_mfma_f32_16x16x32_bf16 v[252:255], v[124:127], a[220:223], v[252:255]
    ds_read_b64_tr_b16 a[200:201], v2 offset:49936
    v_add_f32 v11, v59, v11
    v_mfma_f32_16x16x32_bf16 v[220:223], v[104:107], a[216:219], v[220:223]
    ds_read_b64_tr_b16 a[202:203], v3 offset:49936
    v_add_f32 v12, v63, v12
    v_mfma_f32_16x16x32_bf16 v[220:223], v[120:123], a[220:223], v[220:223]
    ds_read_b64_tr_b16 a[208:209], v2 offset:49952
    v_mfma_f32_16x16x32_bf16 v[188:191], v[100:103], a[216:219], v[188:191]
    v_mfma_f32_16x16x32_bf16 v[188:191], v[116:119], a[220:223], v[188:191]
    ds_read_b64_tr_b16 a[210:211], v3 offset:49952
    v_mfma_f32_16x16x32_bf16 v[156:159], v[96:99], a[216:219], v[156:159]
    s_waitcnt vmcnt(11) lgkmcnt(6)
    ds_read_b64_tr_b16 a[216:217], v2 offset:49968
    v_mfma_f32_16x16x32_bf16 v[156:159], v[112:115], a[220:223], v[156:159]
    s_barrier
    ds_read_b64_tr_b16 a[218:219], v3 offset:49968
    v_mfma_f32_16x16x32_bf16 v[44:47], a[160:163], a[0:3], v[24:27]
    s_add_u32 m0, s35, 33280
    ds_read_b64_tr_b16 a[196:197], v2 offset:0
    v_mfma_f32_16x16x32_bf16 v[44:47], a[164:167], a[4:7], v[44:47]
    buffer_load_dwordx4 v5, s[20:23], s33 offen lds
    v_mfma_f32_16x16x32_bf16 v[44:47], a[168:171], a[8:11], v[44:47]
    ds_read2st64_b32 v[66:67], v6 offset0:0 offset1:1
    v_mfma_f32_16x16x32_bf16 v[44:47], a[172:175], a[12:15], v[44:47]
    ds_read_b64_tr_b16 a[198:199], v3 offset:0
    v_mfma_f32_16x16x32_bf16 v[44:47], a[176:179], a[16:19], v[44:47]
    ds_read2st64_b32 v[70:71], v6 offset0:2 offset1:3
    v_mfma_f32_16x16x32_bf16 v[44:47], a[180:183], a[20:23], v[44:47]
    ds_read2st64_b32 v[74:75], v6 offset0:4 offset1:5
    v_mfma_f32_16x16x32_bf16 v[44:47], a[184:187], a[24:27], v[44:47]
    ds_read2st64_b32 v[78:79], v6 offset0:6 offset1:7
    v_mfma_f32_16x16x32_bf16 v[44:47], a[188:191], a[28:31], v[44:47]
    ds_read_b64_tr_b16 a[204:205], v2 offset:16
    v_mfma_f32_16x16x32_bf16 v[48:51], a[188:191], a[60:63], v[28:31]
    ds_read_b64_tr_b16 a[206:207], v3 offset:16
    v_mfma_f32_16x16x32_bf16 v[48:51], a[184:187], a[56:59], v[48:51]
    s_add_u32 m0, s35, 34832
    ds_read_b64_tr_b16 a[212:213], v2 offset:32
    v_mfma_f32_16x16x32_bf16 v[48:51], a[180:183], a[52:55], v[48:51]
    buffer_load_dwordx4 v5, s[20:23], s33 offen offset:512 lds
    v_mfma_f32_16x16x32_bf16 v[48:51], a[176:179], a[48:51], v[48:51]
    ds_read_b64_tr_b16 a[214:215], v3 offset:32
    v_mfma_f32_16x16x32_bf16 v[48:51], a[172:175], a[44:47], v[48:51]
    ds_read_b64_tr_b16 a[220:221], v2 offset:48
    v_mfma_f32_16x16x32_bf16 v[48:51], a[168:171], a[40:43], v[48:51]
    s_add_u32 m0, s35, 36384
    ds_read_b64_tr_b16 a[222:223], v3 offset:48
    v_mfma_f32_16x16x32_bf16 v[48:51], a[164:167], a[36:39], v[48:51]
    buffer_load_dwordx4 v5, s[20:23], s33 offen offset:1024 lds
    v_mfma_f32_16x16x32_bf16 v[48:51], a[160:163], a[32:35], v[48:51]
    v_exp_f32 v44, v44
    v_mfma_f32_16x16x32_bf16 v[52:55], a[160:163], a[64:67], v[32:35]
    v_exp_f32 v45, v45
    v_mfma_f32_16x16x32_bf16 v[52:55], a[164:167], a[68:71], v[52:55]
    v_cvt_pk_bf16_f32 v80, v44, v45
    v_add_f32 v8, v44, v8
    v_mfma_f32_16x16x32_bf16 v[52:55], a[168:171], a[72:75], v[52:55]
    s_add_u32 m0, s35, 37936
    v_exp_f32 v46, v46
    v_mfma_f32_16x16x32_bf16 v[52:55], a[172:175], a[76:79], v[52:55]
    buffer_load_dwordx4 v5, s[20:23], s33 offen offset:1536 lds
    v_mfma_f32_16x16x32_bf16 v[52:55], a[176:179], a[80:83], v[52:55]
    s_mov_b32 m0, s36
    v_exp_f32 v47, v47
    v_mfma_f32_16x16x32_bf16 v[52:55], a[180:183], a[84:87], v[52:55]
    s_add_u32 s33, s33, s49
    ds_write_addtid_b32 v80 offset:10240
    v_cvt_pk_bf16_f32 v81, v46, v47
    v_mfma_f32_16x16x32_bf16 v[52:55], a[184:187], a[88:91], v[52:55]
    v_exp_f32 v48, v48
    v_mfma_f32_16x16x32_bf16 v[52:55], a[188:191], a[92:95], v[52:55]
    v_exp_f32 v49, v49
    v_mfma_f32_16x16x32_bf16 v[56:59], a[188:191], a[124:127], v[36:39]
    ds_write_addtid_b32 v81 offset:10496
    v_cvt_pk_bf16_f32 v84, v48, v49
    v_mfma_f32_16x16x32_bf16 v[56:59], a[184:187], a[120:123], v[56:59]
    v_exp_f32 v50, v50
    v_mfma_f32_16x16x32_bf16 v[56:59], a[180:183], a[116:119], v[56:59]
    s_add_u32 m0, s34, 4704
    v_exp_f32 v51, v51
    v_mfma_f32_16x16x32_bf16 v[56:59], a[176:179], a[112:115], v[56:59]
    buffer_load_dwordx4 v4, s[16:19], s32 offen offset:1536 lds
    v_mfma_f32_16x16x32_bf16 v[56:59], a[172:175], a[108:111], v[56:59]
    s_mov_b32 m0, s36
    v_exp_f32 v52, v52
    v_mfma_f32_16x16x32_bf16 v[56:59], a[168:171], a[104:107], v[56:59]
    s_add_u32 s32, s32, s49
    ds_write_addtid_b32 v84 offset:10752
    v_cvt_pk_bf16_f32 v85, v50, v51
    v_mfma_f32_16x16x32_bf16 v[56:59], a[164:167], a[100:103], v[56:59]
    v_exp_f32 v53, v53
    v_mfma_f32_16x16x32_bf16 v[56:59], a[160:163], a[96:99], v[56:59]
    ds_write_addtid_b32 v85 offset:11008
    v_cvt_pk_bf16_f32 v88, v52, v53
    v_mfma_f32_16x16x32_bf16 v[60:63], a[160:163], a[128:131], v[40:43]
    v_exp_f32 v54, v54
    v_mfma_f32_16x16x32_bf16 v[60:63], a[164:167], a[132:135], v[60:63]
    v_exp_f32 v55, v55
    v_mfma_f32_16x16x32_bf16 v[60:63], a[168:171], a[136:139], v[60:63]
    ds_write_addtid_b32 v88 offset:11264
    v_cvt_pk_bf16_f32 v89, v54, v55
    v_mfma_f32_16x16x32_bf16 v[60:63], a[172:175], a[140:143], v[60:63]
    s_add_u32 m0, s34, 16640
    v_exp_f32 v56, v56
    v_mfma_f32_16x16x32_bf16 v[60:63], a[176:179], a[144:147], v[60:63]
    buffer_load_dwordx4 v4, s[16:19], s32 offen lds
    v_mfma_f32_16x16x32_bf16 v[60:63], a[180:183], a[148:151], v[60:63]
    s_mov_b32 m0, s36
    v_exp_f32 v57, v57
    v_mfma_f32_16x16x32_bf16 v[60:63], a[184:187], a[152:155], v[60:63]
    ds_write_addtid_b32 v89 offset:11520
    v_cvt_pk_bf16_f32 v92, v56, v57
    v_mfma_f32_16x16x32_bf16 v[60:63], a[188:191], a[156:159], v[60:63]
    s_waitcnt lgkmcnt(6)
    v_exp_f32 v58, v58
    v_mfma_f32_16x16x32_bf16 v[128:131], v[112:115], a[192:195], v[128:131]
    v_exp_f32 v59, v59
    v_mfma_f32_16x16x32_bf16 v[128:131], v[64:67], a[196:199], v[128:131]
    ds_write_addtid_b32 v92 offset:11776
    v_cvt_pk_bf16_f32 v93, v58, v59
    v_mfma_f32_16x16x32_bf16 v[160:163], v[116:119], a[192:195], v[160:163]
    ds_write_addtid_b32 v93 offset:12032
    v_add_f32 v9, v48, v9
    v_mfma_f32_16x16x32_bf16 v[160:163], v[68:71], a[196:199], v[160:163]
    v_exp_f32 v60, v60
    v_mfma_f32_16x16x32_bf16 v[192:195], v[120:123], a[192:195], v[192:195]
    s_add_u32 m0, s34, 18208
    v_exp_f32 v61, v61
    v_mfma_f32_16x16x32_bf16 v[192:195], v[72:75], a[196:199], v[192:195]
    buffer_load_dwordx4 v4, s[16:19], s32 offen offset:512 lds
    v_mfma_f32_16x16x32_bf16 v[224:227], v[124:127], a[192:195], v[224:227]
    v_cvt_pk_bf16_f32 v14, v60, v61
    v_add_f32 v10, v52, v10
    v_mfma_f32_16x16x32_bf16 v[224:227], v[76:79], a[196:199], v[224:227]
    v_exp_f32 v62, v62
    v_mfma_f32_16x16x32_bf16 v[228:231], v[124:127], a[200:203], v[228:231]
    s_mov_b32 m0, s36
    v_exp_f32 v63, v63
    v_mfma_f32_16x16x32_bf16 v[228:231], v[76:79], a[204:207], v[228:231]
    ds_write_addtid_b32 v14 offset:12288
    v_cvt_pk_bf16_f32 v15, v62, v63
    v_mfma_f32_16x16x32_bf16 v[196:199], v[120:123], a[200:203], v[196:199]
    ds_write_addtid_b32 v15 offset:12544
    v_add_f32 v11, v56, v11
    v_mfma_f32_16x16x32_bf16 v[196:199], v[72:75], a[204:207], v[196:199]
    v_add_f32 v12, v60, v12
    v_add_f32 v8, v45, v8
    v_mfma_f32_16x16x32_bf16 v[164:167], v[116:119], a[200:203], v[164:167]
    v_add_f32 v9, v49, v9
    v_add_f32 v10, v53, v10
    v_mfma_f32_16x16x32_bf16 v[164:167], v[68:71], a[204:207], v[164:167]
    s_add_u32 m0, s34, 19776
    ds_read_b128 a[160:163], v1 offset:33280
    v_add_f32 v11, v57, v11
    v_mfma_f32_16x16x32_bf16 v[132:135], v[112:115], a[200:203], v[132:135]
    buffer_load_dwordx4 v4, s[16:19], s32 offen offset:1024 lds
    v_mfma_f32_16x16x32_bf16 v[132:135], v[64:67], a[204:207], v[132:135]
    ds_read_b128 a[164:167], v1 offset:33344
    v_add_f32 v12, v61, v12
    v_mfma_f32_16x16x32_bf16 v[136:139], v[112:115], a[208:211], v[136:139]
    ds_read_b128 a[168:171], v1 offset:33408
    v_add_f32 v8, v46, v8
    v_mfma_f32_16x16x32_bf16 v[136:139], v[64:67], a[212:215], v[136:139]
    ds_read_b128 a[172:175], v1 offset:33472
    v_add_f32 v9, v50, v9
    v_mfma_f32_16x16x32_bf16 v[168:171], v[116:119], a[208:211], v[168:171]
    ds_read_b128 a[176:179], v1 offset:33536
    v_add_f32 v10, v54, v10
    v_mfma_f32_16x16x32_bf16 v[168:171], v[68:71], a[212:215], v[168:171]
    ds_read_b128 a[180:183], v1 offset:33600
    v_add_f32 v11, v58, v11
    v_mfma_f32_16x16x32_bf16 v[200:203], v[120:123], a[208:211], v[200:203]
    ds_read_b128 a[184:187], v1 offset:33664
    v_add_f32 v12, v62, v12
    v_mfma_f32_16x16x32_bf16 v[200:203], v[72:75], a[212:215], v[200:203]
    ds_read_b128 a[188:191], v1 offset:33728
    v_add_f32 v8, v47, v8
    v_mfma_f32_16x16x32_bf16 v[232:235], v[124:127], a[208:211], v[232:235]
    s_add_u32 m0, s34, 21344
    ds_read_b64_tr_b16 a[192:193], v2 offset:128
    v_add_f32 v9, v51, v9
    v_mfma_f32_16x16x32_bf16 v[232:235], v[76:79], a[212:215], v[232:235]
    buffer_load_dwordx4 v4, s[16:19], s32 offen offset:1536 lds
    v_mfma_f32_16x16x32_bf16 v[236:239], v[124:127], a[216:219], v[236:239]
    s_add_u32 s32, s32, s49
    ds_read_b64_tr_b16 a[194:195], v3 offset:128
    v_add_f32 v10, v55, v10
    v_mfma_f32_16x16x32_bf16 v[236:239], v[76:79], a[220:223], v[236:239]
    ds_read_b64_tr_b16 a[200:201], v2 offset:144
    v_add_f32 v11, v59, v11
    v_mfma_f32_16x16x32_bf16 v[204:207], v[120:123], a[216:219], v[204:207]
    ds_read_b64_tr_b16 a[202:203], v3 offset:144
    v_add_f32 v12, v63, v12
    v_mfma_f32_16x16x32_bf16 v[204:207], v[72:75], a[220:223], v[204:207]
    ds_read_b64_tr_b16 a[208:209], v2 offset:160
    v_mfma_f32_16x16x32_bf16 v[172:175], v[116:119], a[216:219], v[172:175]
    v_mfma_f32_16x16x32_bf16 v[172:175], v[68:71], a[220:223], v[172:175]
    ds_read_b64_tr_b16 a[210:211], v3 offset:160
    v_mfma_f32_16x16x32_bf16 v[140:143], v[112:115], a[216:219], v[140:143]
    s_waitcnt vmcnt(12) lgkmcnt(6)
    ds_read_b64_tr_b16 a[216:217], v2 offset:176
    v_mfma_f32_16x16x32_bf16 v[140:143], v[64:67], a[220:223], v[140:143]
    s_barrier
    ds_read_b64_tr_b16 a[218:219], v3 offset:176
.p2align 3
L_loop0:
    v_mfma_f32_16x16x32_bf16 v[44:47], a[160:163], a[0:3], v[24:27]
    s_add_u32 m0, s35, 49920
    ds_read_b64_tr_b16 a[196:197], v2 offset:16768
    v_mfma_f32_16x16x32_bf16 v[44:47], a[164:167], a[4:7], v[44:47]
    buffer_load_dwordx4 v5, s[20:23], s33 offen lds
    v_mfma_f32_16x16x32_bf16 v[44:47], a[168:171], a[8:11], v[44:47]
    ds_read2st64_b32 v[82:83], v6 offset0:40 offset1:41
    v_mfma_f32_16x16x32_bf16 v[44:47], a[172:175], a[12:15], v[44:47]
    ds_read_b64_tr_b16 a[198:199], v3 offset:16768
    v_mfma_f32_16x16x32_bf16 v[44:47], a[176:179], a[16:19], v[44:47]
    ds_read2st64_b32 v[86:87], v6 offset0:42 offset1:43
    v_mfma_f32_16x16x32_bf16 v[44:47], a[180:183], a[20:23], v[44:47]
    ds_read2st64_b32 v[90:91], v6 offset0:44 offset1:45
    v_mfma_f32_16x16x32_bf16 v[44:47], a[184:187], a[24:27], v[44:47]
    ds_read2st64_b32 v[94:95], v6 offset0:46 offset1:47
    v_mfma_f32_16x16x32_bf16 v[44:47], a[188:191], a[28:31], v[44:47]
    ds_read_b64_tr_b16 a[204:205], v2 offset:16784
    v_mfma_f32_16x16x32_bf16 v[48:51], a[188:191], a[60:63], v[28:31]
    ds_read_b64_tr_b16 a[206:207], v3 offset:16784
    v_mfma_f32_16x16x32_bf16 v[48:51], a[184:187], a[56:59], v[48:51]
    s_add_u32 m0, s35, 51472
    ds_read_b64_tr_b16 a[212:213], v2 offset:16800
    v_mfma_f32_16x16x32_bf16 v[48:51], a[180:183], a[52:55], v[48:51]
    buffer_load_dwordx4 v5, s[20:23], s33 offen offset:512 lds
    v_mfma_f32_16x16x32_bf16 v[48:51], a[176:179], a[48:51], v[48:51]
    ds_read_b64_tr_b16 a[214:215], v3 offset:16800
    v_mfma_f32_16x16x32_bf16 v[48:51], a[172:175], a[44:47], v[48:51]
    ds_read_b64_tr_b16 a[220:221], v2 offset:16816
    v_mfma_f32_16x16x32_bf16 v[48:51], a[168:171], a[40:43], v[48:51]
    ds_read_b64_tr_b16 a[222:223], v3 offset:16816
    v_mfma_f32_16x16x32_bf16 v[48:51], a[164:167], a[36:39], v[48:51]
    buffer_load_dword v20, v19, s[20:23], 0 offen
    v_mfma_f32_16x16x32_bf16 v[48:51], a[160:163], a[32:35], v[48:51]
    v_exp_f32 v44, v44
    v_mfma_f32_16x16x32_bf16 v[52:55], a[160:163], a[64:67], v[32:35]
    v_exp_f32 v45, v45
    v_mfma_f32_16x16x32_bf16 v[52:55], a[164:167], a[68:71], v[52:55]
    v_cvt_pk_bf16_f32 v96, v44, v45
    v_add_f32 v8, v44, v8
    v_mfma_f32_16x16x32_bf16 v[52:55], a[168:171], a[72:75], v[52:55]
    s_add_u32 m0, s35, 53024
    v_exp_f32 v46, v46
    v_mfma_f32_16x16x32_bf16 v[52:55], a[172:175], a[76:79], v[52:55]
    buffer_load_dwordx4 v5, s[20:23], s33 offen offset:1024 lds
    v_mfma_f32_16x16x32_bf16 v[52:55], a[176:179], a[80:83], v[52:55]
    s_mov_b32 m0, s36
    v_exp_f32 v47, v47
    v_mfma_f32_16x16x32_bf16 v[52:55], a[180:183], a[84:87], v[52:55]
    ds_write_addtid_b32 v96 offset:0
    v_cvt_pk_bf16_f32 v97, v46, v47
    v_mfma_f32_16x16x32_bf16 v[52:55], a[184:187], a[88:91], v[52:55]
    v_exp_f32 v48, v48
    v_mfma_f32_16x16x32_bf16 v[52:55], a[188:191], a[92:95], v[52:55]
    v_exp_f32 v49, v49
    v_mfma_f32_16x16x32_bf16 v[56:59], a[188:191], a[124:127], v[36:39]
    ds_write_addtid_b32 v97 offset:256
    v_cvt_pk_bf16_f32 v100, v48, v49
    v_mfma_f32_16x16x32_bf16 v[56:59], a[184:187], a[120:123], v[56:59]
    v_exp_f32 v50, v50
    v_mfma_f32_16x16x32_bf16 v[56:59], a[180:183], a[116:119], v[56:59]
    s_add_u32 m0, s35, 54576
    v_exp_f32 v51, v51
    v_mfma_f32_16x16x32_bf16 v[56:59], a[176:179], a[112:115], v[56:59]
    buffer_load_dwordx4 v5, s[20:23], s33 offen offset:1536 lds
    v_mfma_f32_16x16x32_bf16 v[56:59], a[172:175], a[108:111], v[56:59]
    s_mov_b32 m0, s36
    v_exp_f32 v52, v52
    v_mfma_f32_16x16x32_bf16 v[56:59], a[168:171], a[104:107], v[56:59]
    s_add_u32 s33, s33, s49
    ds_write_addtid_b32 v100 offset:512
    v_cvt_pk_bf16_f32 v101, v50, v51
    v_mfma_f32_16x16x32_bf16 v[56:59], a[164:167], a[100:103], v[56:59]
    v_exp_f32 v53, v53
    v_mfma_f32_16x16x32_bf16 v[56:59], a[160:163], a[96:99], v[56:59]
    ds_write_addtid_b32 v101 offset:768
    v_cvt_pk_bf16_f32 v104, v52, v53
    v_mfma_f32_16x16x32_bf16 v[60:63], a[160:163], a[128:131], v[40:43]
    v_exp_f32 v54, v54
    v_mfma_f32_16x16x32_bf16 v[60:63], a[164:167], a[132:135], v[60:63]
    v_exp_f32 v55, v55
    v_mfma_f32_16x16x32_bf16 v[60:63], a[168:171], a[136:139], v[60:63]
    ds_write_addtid_b32 v104 offset:1024
    v_cvt_pk_bf16_f32 v105, v54, v55
    v_mfma_f32_16x16x32_bf16 v[60:63], a[172:175], a[140:143], v[60:63]
    s_add_u32 m0, s34, 33280
    v_exp_f32 v56, v56
    v_mfma_f32_16x16x32_bf16 v[60:63], a[176:179], a[144:147], v[60:63]
    buffer_load_dwordx4 v4, s[16:19], s32 offen lds
    v_mfma_f32_16x16x32_bf16 v[60:63], a[180:183], a[148:151], v[60:63]
    s_mov_b32 m0, s36
    v_exp_f32 v57, v57
    v_mfma_f32_16x16x32_bf16 v[60:63], a[184:187], a[152:155], v[60:63]
    ds_write_addtid_b32 v105 offset:1280
    v_cvt_pk_bf16_f32 v108, v56, v57
    v_mfma_f32_16x16x32_bf16 v[60:63], a[188:191], a[156:159], v[60:63]
    s_waitcnt lgkmcnt(6)
    v_exp_f32 v58, v58
    v_mfma_f32_16x16x32_bf16 v[144:147], v[64:67], a[192:195], v[144:147]
    v_exp_f32 v59, v59
    v_mfma_f32_16x16x32_bf16 v[144:147], v[80:83], a[196:199], v[144:147]
    ds_write_addtid_b32 v108 offset:1536
    v_cvt_pk_bf16_f32 v109, v58, v59
    v_mfma_f32_16x16x32_bf16 v[176:179], v[68:71], a[192:195], v[176:179]
    ds_write_addtid_b32 v109 offset:1792
    v_add_f32 v9, v48, v9
    v_mfma_f32_16x16x32_bf16 v[176:179], v[84:87], a[196:199], v[176:179]
    v_exp_f32 v60, v60
    v_mfma_f32_16x16x32_bf16 v[208:211], v[72:75], a[192:195], v[208:211]
    s_add_u32 m0, s34, 34848
    v_exp_f32 v61, v61
    v_mfma_f32_16x16x32_bf16 v[208:211], v[88:91], a[196:199], v[208:211]
    buffer_load_dwordx4 v4, s[16:19], s32 offen offset:512 lds
    v_mfma_f32_16x16x32_bf16 v[240:243], v[76:79], a[192:195], v[240:243]
    v_cvt_pk_bf16_f32 v14, v60, v61
    v_add_f32 v10, v52, v10
    v_mfma_f32_16x16x32_bf16 v[240:243], v[92:95], a[196:199], v[240:243]
    v_exp_f32 v62, v62
    v_mfma_f32_16x16x32_bf16 v[244:247], v[76:79], a[200:203], v[244:247]
    s_mov_b32 m0, s36
    v_exp_f32 v63, v63
    v_mfma_f32_16x16x32_bf16 v[244:247], v[92:95], a[204:207], v[244:247]
    ds_write_addtid_b32 v14 offset:2048
    v_cvt_pk_bf16_f32 v15, v62, v63
    v_mfma_f32_16x16x32_bf16 v[212:215], v[72:75], a[200:203], v[212:215]
    ds_write_addtid_b32 v15 offset:2304
    v_add_f32 v11, v56, v11
    v_mfma_f32_16x16x32_bf16 v[212:215], v[88:91], a[204:207], v[212:215]
    v_add_f32 v12, v60, v12
    v_add_u32 v19, 0x1000000, v19
    v_mfma_f32_16x16x32_bf16 v[180:183], v[68:71], a[200:203], v[180:183]
    v_add_f32 v8, v45, v8
    v_add_f32 v9, v49, v9
    v_mfma_f32_16x16x32_bf16 v[180:183], v[84:87], a[204:207], v[180:183]
    s_add_u32 m0, s34, 36416
    ds_read_b128 a[160:163], v1 offset:49920
    v_add_f32 v10, v53, v10
    v_mfma_f32_16x16x32_bf16 v[148:151], v[64:67], a[200:203], v[148:151]
    buffer_load_dwordx4 v4, s[16:19], s32 offen offset:1024 lds
    v_mfma_f32_16x16x32_bf16 v[148:151], v[80:83], a[204:207], v[148:151]
    ds_read_b128 a[164:167], v1 offset:49984
    v_add_f32 v11, v57, v11
    v_mfma_f32_16x16x32_bf16 v[152:155], v[64:67], a[208:211], v[152:155]
    ds_read_b128 a[168:171], v1 offset:50048
    v_add_f32 v12, v61, v12
    v_mfma_f32_16x16x32_bf16 v[152:155], v[80:83], a[212:215], v[152:155]
    ds_read_b128 a[172:175], v1 offset:50112
    v_add_f32 v8, v46, v8
    v_mfma_f32_16x16x32_bf16 v[184:187], v[68:71], a[208:211], v[184:187]
    ds_read_b128 a[176:179], v1 offset:50176
    v_add_f32 v9, v50, v9
    v_mfma_f32_16x16x32_bf16 v[184:187], v[84:87], a[212:215], v[184:187]
    ds_read_b128 a[180:183], v1 offset:50240
    v_add_f32 v10, v54, v10
    v_mfma_f32_16x16x32_bf16 v[216:219], v[72:75], a[208:211], v[216:219]
    ds_read_b128 a[184:187], v1 offset:50304
    v_add_f32 v11, v58, v11
    v_mfma_f32_16x16x32_bf16 v[216:219], v[88:91], a[212:215], v[216:219]
    ds_read_b128 a[188:191], v1 offset:50368
    v_add_f32 v12, v62, v12
    v_mfma_f32_16x16x32_bf16 v[248:251], v[76:79], a[208:211], v[248:251]
    s_add_u32 m0, s34, 37984
    ds_read_b64_tr_b16 a[192:193], v2 offset:16640
    v_add_f32 v8, v47, v8
    v_mfma_f32_16x16x32_bf16 v[248:251], v[92:95], a[212:215], v[248:251]
    buffer_load_dwordx4 v4, s[16:19], s32 offen offset:1536 lds
    v_mfma_f32_16x16x32_bf16 v[252:255], v[76:79], a[216:219], v[252:255]
    s_add_u32 s32, s32, s49
    ds_read_b64_tr_b16 a[194:195], v3 offset:16640
    v_add_f32 v9, v51, v9
    v_mfma_f32_16x16x32_bf16 v[252:255], v[92:95], a[220:223], v[252:255]
    ds_read_b64_tr_b16 a[200:201], v2 offset:16656
    v_add_f32 v10, v55, v10
    v_mfma_f32_16x16x32_bf16 v[220:223], v[72:75], a[216:219], v[220:223]
    ds_read_b64_tr_b16 a[202:203], v3 offset:16656
    v_add_f32 v11, v59, v11
    v_mfma_f32_16x16x32_bf16 v[220:223], v[88:91], a[220:223], v[220:223]
    ds_read_b64_tr_b16 a[208:209], v2 offset:16672
    v_add_f32 v12, v63, v12
    v_mfma_f32_16x16x32_bf16 v[188:191], v[68:71], a[216:219], v[188:191]
    v_mfma_f32_16x16x32_bf16 v[188:191], v[84:87], a[220:223], v[188:191]
    ds_read_b64_tr_b16 a[210:211], v3 offset:16672
    v_mfma_f32_16x16x32_bf16 v[156:159], v[64:67], a[216:219], v[156:159]
    s_waitcnt vmcnt(13) lgkmcnt(6)
    ds_read_b64_tr_b16 a[216:217], v2 offset:16688
    v_mfma_f32_16x16x32_bf16 v[156:159], v[80:83], a[220:223], v[156:159]
    s_barrier
    ds_read_b64_tr_b16 a[218:219], v3 offset:16688
    v_mfma_f32_16x16x32_bf16 v[44:47], a[160:163], a[0:3], v[24:27]
    s_add_u32 m0, s35, 0
    ds_read_b64_tr_b16 a[196:197], v2 offset:33280
    v_mfma_f32_16x16x32_bf16 v[44:47], a[164:167], a[4:7], v[44:47]
    buffer_load_dwordx4 v5, s[20:23], s33 offen lds
    v_mfma_f32_16x16x32_bf16 v[44:47], a[168:171], a[8:11], v[44:47]
    ds_read2st64_b32 v[98:99], v6 offset0:0 offset1:1
    v_mfma_f32_16x16x32_bf16 v[44:47], a[172:175], a[12:15], v[44:47]
    ds_read_b64_tr_b16 a[198:199], v3 offset:33280
    v_mfma_f32_16x16x32_bf16 v[44:47], a[176:179], a[16:19], v[44:47]
    ds_read2st64_b32 v[102:103], v6 offset0:2 offset1:3
    v_mfma_f32_16x16x32_bf16 v[44:47], a[180:183], a[20:23], v[44:47]
    ds_read2st64_b32 v[106:107], v6 offset0:4 offset1:5
    v_mfma_f32_16x16x32_bf16 v[44:47], a[184:187], a[24:27], v[44:47]
    ds_read2st64_b32 v[110:111], v6 offset0:6 offset1:7
    v_mfma_f32_16x16x32_bf16 v[44:47], a[188:191], a[28:31], v[44:47]
    ds_read_b64_tr_b16 a[204:205], v2 offset:33296
    v_mfma_f32_16x16x32_bf16 v[48:51], a[188:191], a[60:63], v[28:31]
    ds_read_b64_tr_b16 a[206:207], v3 offset:33296
    v_mfma_f32_16x16x32_bf16 v[48:51], a[184:187], a[56:59], v[48:51]
    s_add_u32 m0, s35, 1552
    ds_read_b64_tr_b16 a[212:213], v2 offset:33312
    v_mfma_f32_16x16x32_bf16 v[48:51], a[180:183], a[52:55], v[48:51]
    buffer_load_dwordx4 v5, s[20:23], s33 offen offset:512 lds
    v_mfma_f32_16x16x32_bf16 v[48:51], a[176:179], a[48:51], v[48:51]
    ds_read_b64_tr_b16 a[214:215], v3 offset:33312
    v_mfma_f32_16x16x32_bf16 v[48:51], a[172:175], a[44:47], v[48:51]
    ds_read_b64_tr_b16 a[220:221], v2 offset:33328
    v_mfma_f32_16x16x32_bf16 v[48:51], a[168:171], a[40:43], v[48:51]
    ds_read_b64_tr_b16 a[222:223], v3 offset:33328
    v_mfma_f32_16x16x32_bf16 v[48:51], a[164:167], a[36:39], v[48:51]
    v_mfma_f32_16x16x32_bf16 v[48:51], a[160:163], a[32:35], v[48:51]
    v_exp_f32 v44, v44
    v_mfma_f32_16x16x32_bf16 v[52:55], a[160:163], a[64:67], v[32:35]
    v_exp_f32 v45, v45
    v_mfma_f32_16x16x32_bf16 v[52:55], a[164:167], a[68:71], v[52:55]
    v_cvt_pk_bf16_f32 v112, v44, v45
    v_add_f32 v8, v44, v8
    v_mfma_f32_16x16x32_bf16 v[52:55], a[168:171], a[72:75], v[52:55]
    s_add_u32 m0, s35, 3104
    v_exp_f32 v46, v46
    v_mfma_f32_16x16x32_bf16 v[52:55], a[172:175], a[76:79], v[52:55]
    buffer_load_dwordx4 v5, s[20:23], s33 offen offset:1024 lds
    v_mfma_f32_16x16x32_bf16 v[52:55], a[176:179], a[80:83], v[52:55]
    s_mov_b32 m0, s36
    v_exp_f32 v47, v47
    v_mfma_f32_16x16x32_bf16 v[52:55], a[180:183], a[84:87], v[52:55]
    ds_write_addtid_b32 v112 offset:10240
    v_cvt_pk_bf16_f32 v113, v46, v47
    v_mfma_f32_16x16x32_bf16 v[52:55], a[184:187], a[88:91], v[52:55]
    v_exp_f32 v48, v48
    v_mfma_f32_16x16x32_bf16 v[52:55], a[188:191], a[92:95], v[52:55]
    v_exp_f32 v49, v49
    v_mfma_f32_16x16x32_bf16 v[56:59], a[188:191], a[124:127], v[36:39]
    ds_write_addtid_b32 v113 offset:10496
    v_cvt_pk_bf16_f32 v116, v48, v49
    v_mfma_f32_16x16x32_bf16 v[56:59], a[184:187], a[120:123], v[56:59]
    v_exp_f32 v50, v50
    v_mfma_f32_16x16x32_bf16 v[56:59], a[180:183], a[116:119], v[56:59]
    s_add_u32 m0, s35, 4656
    v_exp_f32 v51, v51
    v_mfma_f32_16x16x32_bf16 v[56:59], a[176:179], a[112:115], v[56:59]
    buffer_load_dwordx4 v5, s[20:23], s33 offen offset:1536 lds
    v_mfma_f32_16x16x32_bf16 v[56:59], a[172:175], a[108:111], v[56:59]
    s_mov_b32 m0, s36
    v_exp_f32 v52, v52
    v_mfma_f32_16x16x32_bf16 v[56:59], a[168:171], a[104:107], v[56:59]
    s_add_u32 s33, s33, s49
    ds_write_addtid_b32 v116 offset:10752
    v_cvt_pk_bf16_f32 v117, v50, v51
    v_mfma_f32_16x16x32_bf16 v[56:59], a[164:167], a[100:103], v[56:59]
    v_exp_f32 v53, v53
    v_mfma_f32_16x16x32_bf16 v[56:59], a[160:163], a[96:99], v[56:59]
    ds_write_addtid_b32 v117 offset:11008
    v_cvt_pk_bf16_f32 v120, v52, v53
    v_mfma_f32_16x16x32_bf16 v[60:63], a[160:163], a[128:131], v[40:43]
    v_exp_f32 v54, v54
    v_mfma_f32_16x16x32_bf16 v[60:63], a[164:167], a[132:135], v[60:63]
    v_exp_f32 v55, v55
    v_mfma_f32_16x16x32_bf16 v[60:63], a[168:171], a[136:139], v[60:63]
    ds_write_addtid_b32 v120 offset:11264
    v_cvt_pk_bf16_f32 v121, v54, v55
    v_mfma_f32_16x16x32_bf16 v[60:63], a[172:175], a[140:143], v[60:63]
    s_add_u32 m0, s34, 49920
    v_exp_f32 v56, v56
    v_mfma_f32_16x16x32_bf16 v[60:63], a[176:179], a[144:147], v[60:63]
    buffer_load_dwordx4 v4, s[16:19], s32 offen lds
    v_mfma_f32_16x16x32_bf16 v[60:63], a[180:183], a[148:151], v[60:63]
    s_mov_b32 m0, s36
    v_exp_f32 v57, v57
    v_mfma_f32_16x16x32_bf16 v[60:63], a[184:187], a[152:155], v[60:63]
    ds_write_addtid_b32 v121 offset:11520
    v_cvt_pk_bf16_f32 v124, v56, v57
    v_mfma_f32_16x16x32_bf16 v[60:63], a[188:191], a[156:159], v[60:63]
    s_waitcnt lgkmcnt(6)
    v_exp_f32 v58, v58
    v_mfma_f32_16x16x32_bf16 v[128:131], v[80:83], a[192:195], v[128:131]
    v_exp_f32 v59, v59
    v_mfma_f32_16x16x32_bf16 v[128:131], v[96:99], a[196:199], v[128:131]
    ds_write_addtid_b32 v124 offset:11776
    v_cvt_pk_bf16_f32 v125, v58, v59
    v_mfma_f32_16x16x32_bf16 v[160:163], v[84:87], a[192:195], v[160:163]
    ds_write_addtid_b32 v125 offset:12032
    v_add_f32 v9, v48, v9
    v_mfma_f32_16x16x32_bf16 v[160:163], v[100:103], a[196:199], v[160:163]
    v_exp_f32 v60, v60
    v_mfma_f32_16x16x32_bf16 v[192:195], v[88:91], a[192:195], v[192:195]
    s_add_u32 m0, s34, 51488
    v_exp_f32 v61, v61
    v_mfma_f32_16x16x32_bf16 v[192:195], v[104:107], a[196:199], v[192:195]
    buffer_load_dwordx4 v4, s[16:19], s32 offen offset:512 lds
    v_mfma_f32_16x16x32_bf16 v[224:227], v[92:95], a[192:195], v[224:227]
    v_cvt_pk_bf16_f32 v14, v60, v61
    v_add_f32 v10, v52, v10
    v_mfma_f32_16x16x32_bf16 v[224:227], v[108:111], a[196:199], v[224:227]
L_pad0_2:
    s_cbranch_vccnz L_walked0
    v_exp_f32 v62, v62
    v_mfma_f32_16x16x32_bf16 v[228:231], v[92:95], a[200:203], v[228:231]
    s_mov_b32 m0, s36
    v_exp_f32 v63, v63
    v_mfma_f32_16x16x32_bf16 v[228:231], v[108:111], a[204:207], v[228:231]
    ds_write_addtid_b32 v14 offset:12288
    v_cvt_pk_bf16_f32 v15, v62, v63
    v_mfma_f32_16x16x32_bf16 v[196:199], v[88:91], a[200:203], v[196:199]
    ds_write_addtid_b32 v15 offset:12544
    v_add_f32 v11, v56, v11
    v_mfma_f32_16x16x32_bf16 v[196:199], v[104:107], a[204:207], v[196:199]
    v_add_f32 v12, v60, v12
    v_add_f32 v8, v45, v8
    v_mfma_f32_16x16x32_bf16 v[164:167], v[84:87], a[200:203], v[164:167]
    v_add_f32 v9, v49, v9
    v_add_f32 v10, v53, v10
    v_mfma_f32_16x16x32_bf16 v[164:167], v[100:103], a[204:207], v[164:167]
    s_add_u32 m0, s34, 53056
    ds_read_b128 a[160:163], v1 offset:0
    v_add_f32 v11, v57, v11
    v_mfma_f32_16x16x32_bf16 v[132:135], v[80:83], a[200:203], v[132:135]
    buffer_load_dwordx4 v4, s[16:19], s32 offen offset:1024 lds
    v_mfma_f32_16x16x32_bf16 v[132:135], v[96:99], a[204:207], v[132:135]
    ds_read_b128 a[164:167], v1 offset:64
    v_add_f32 v12, v61, v12
    v_mfma_f32_16x16x32_bf16 v[136:139], v[80:83], a[208:211], v[136:139]
    ds_read_b128 a[168:171], v1 offset:128
    v_add_f32 v8, v46, v8
    v_mfma_f32_16x16x32_bf16 v[136:139], v[96:99], a[212:215], v[136:139]
    ds_read_b128 a[172:175], v1 offset:192
    v_add_f32 v9, v50, v9
    v_mfma_f32_16x16x32_bf16 v[168:171], v[84:87], a[208:211], v[168:171]
    ds_read_b128 a[176:179], v1 offset:256
    v_add_f32 v10, v54, v10
    v_mfma_f32_16x16x32_bf16 v[168:171], v[100:103], a[212:215], v[168:171]
    ds_read_b128 a[180:183], v1 offset:320
    v_add_f32 v11, v58, v11
    v_mfma_f32_16x16x32_bf16 v[200:203], v[88:91], a[208:211], v[200:203]
    ds_read_b128 a[184:187], v1 offset:384
    v_add_f32 v12, v62, v12
    v_mfma_f32_16x16x32_bf16 v[200:203], v[104:107], a[212:215], v[200:203]
    ds_read_b128 a[188:191], v1 offset:448
    v_add_f32 v8, v47, v8
    v_mfma_f32_16x16x32_bf16 v[232:235], v[92:95], a[208:211], v[232:235]
    s_add_u32 m0, s34, 54624
    ds_read_b64_tr_b16 a[192:193], v2 offset:33408
    v_add_f32 v9, v51, v9
    v_mfma_f32_16x16x32_bf16 v[232:235], v[108:111], a[212:215], v[232:235]
    buffer_load_dwordx4 v4, s[16:19], s32 offen offset:1536 lds
    v_mfma_f32_16x16x32_bf16 v[236:239], v[92:95], a[216:219], v[236:239]
    s_add_u32 s32, s32, s49
    ds_read_b64_tr_b16 a[194:195], v3 offset:33408
    v_add_f32 v10, v55, v10
    v_mfma_f32_16x16x32_bf16 v[236:239], v[108:111], a[220:223], v[236:239]
    ds_read_b64_tr_b16 a[200:201], v2 offset:33424
    v_add_f32 v11, v59, v11
    v_mfma_f32_16x16x32_bf16 v[204:207], v[88:91], a[216:219], v[204:207]
    ds_read_b64_tr_b16 a[202:203], v3 offset:33424
    v_add_f32 v12, v63, v12
    v_mfma_f32_16x16x32_bf16 v[204:207], v[104:107], a[220:223], v[204:207]
    ds_read_b64_tr_b16 a[208:209], v2 offset:33440
    v_mfma_f32_16x16x32_bf16 v[172:175], v[84:87], a[216:219], v[172:175]
    v_mfma_f32_16x16x32_bf16 v[172:175], v[100:103], a[220:223], v[172:175]
    ds_read_b64_tr_b16 a[210:211], v3 offset:33440
    v_mfma_f32_16x16x32_bf16 v[140:143], v[80:83], a[216:219], v[140:143]
    s_waitcnt vmcnt(12) lgkmcnt(6)
    ds_read_b64_tr_b16 a[216:217], v2 offset:33456
    v_mfma_f32_16x16x32_bf16 v[140:143], v[96:99], a[220:223], v[140:143]
    s_barrier
    ds_read_b64_tr_b16 a[218:219], v3 offset:33456
    v_mfma_f32_16x16x32_bf16 v[44:47], a[160:163], a[0:3], v[24:27]
    s_add_u32 m0, s35, 16640
    ds_read_b64_tr_b16 a[196:197], v2 offset:50048
    v_mfma_f32_16x16x32_bf16 v[44:47], a[164:167], a[4:7], v[44:47]
    buffer_load_dwordx4 v5, s[20:23], s33 offen lds
    v_mfma_f32_16x16x32_bf16 v[44:47], a[168:171], a[8:11], v[44:47]
    ds_read2st64_b32 v[114:115], v6 offset0:40 offset1:41
    v_mfma_f32_16x16x32_bf16 v[44:47], a[172:175], a[12:15], v[44:47]
    ds_read_b64_tr_b16 a[198:199], v3 offset:50048
    v_mfma_f32_16x16x32_bf16 v[44:47], a[176:179], a[16:19], v[44:47]
    ds_read2st64_b32 v[118:119], v6 offset0:42 offset1:43
    v_mfma_f32_16x16x32_bf16 v[44:47], a[180:183], a[20:23], v[44:47]
    ds_read2st64_b32 v[122:123], v6 offset0:44 offset1:45
    v_mfma_f32_16x16x32_bf16 v[44:47], a[184:187], a[24:27], v[44:47]
    ds_read2st64_b32 v[126:127], v6 offset0:46 offset1:47
    v_mfma_f32_16x16x32_bf16 v[44:47], a[188:191], a[28:31], v[44:47]
    ds_read_b64_tr_b16 a[204:205], v2 offset:50064
    v_mfma_f32_16x16x32_bf16 v[48:51], a[188:191], a[60:63], v[28:31]
    ds_read_b64_tr_b16 a[206:207], v3 offset:50064
    v_mfma_f32_16x16x32_bf16 v[48:51], a[184:187], a[56:59], v[48:51]
    s_add_u32 m0, s35, 18192
    ds_read_b64_tr_b16 a[212:213], v2 offset:50080
    v_mfma_f32_16x16x32_bf16 v[48:51], a[180:183], a[52:55], v[48:51]
    buffer_load_dwordx4 v5, s[20:23], s33 offen offset:512 lds
    v_mfma_f32_16x16x32_bf16 v[48:51], a[176:179], a[48:51], v[48:51]
    ds_read_b64_tr_b16 a[214:215], v3 offset:50080
    v_mfma_f32_16x16x32_bf16 v[48:51], a[172:175], a[44:47], v[48:51]
    ds_read_b64_tr_b16 a[220:221], v2 offset:50096
    v_mfma_f32_16x16x32_bf16 v[48:51], a[168:171], a[40:43], v[48:51]
    ds_read_b64_tr_b16 a[222:223], v3 offset:50096
    v_mfma_f32_16x16x32_bf16 v[48:51], a[164:167], a[36:39], v[48:51]
    v_mfma_f32_16x16x32_bf16 v[48:51], a[160:163], a[32:35], v[48:51]
    v_exp_f32 v44, v44
    v_mfma_f32_16x16x32_bf16 v[52:55], a[160:163], a[64:67], v[32:35]
    v_exp_f32 v45, v45
    v_mfma_f32_16x16x32_bf16 v[52:55], a[164:167], a[68:71], v[52:55]
    v_cvt_pk_bf16_f32 v64, v44, v45
    v_add_f32 v8, v44, v8
    v_mfma_f32_16x16x32_bf16 v[52:55], a[168:171], a[72:75], v[52:55]
    s_add_u32 m0, s35, 19744
    v_exp_f32 v46, v46
    v_mfma_f32_16x16x32_bf16 v[52:55], a[172:175], a[76:79], v[52:55]
    buffer_load_dwordx4 v5, s[20:23], s33 offen offset:1024 lds
    v_mfma_f32_16x16x32_bf16 v[52:55], a[176:179], a[80:83], v[52:55]
    s_mov_b32 m0, s36
    v_exp_f32 v47, v47
    v_mfma_f32_16x16x32_bf16 v[52:55], a[180:183], a[84:87], v[52:55]
    s_cmp_eq_u32 s31, 1
    s_cselect_b32 s18, 0, s18
    ds_write_addtid_b32 v64 offset:0
    v_cvt_pk_bf16_f32 v65, v46, v47
    v_mfma_f32_16x16x32_bf16 v[52:55], a[184:187], a[88:91], v[52:55]
    v_exp_f32 v48, v48
    v_mfma_f32_16x16x32_bf16 v[52:55], a[188:191], a[92:95], v[52:55]
    v_exp_f32 v49, v49
    v_mfma_f32_16x16x32_bf16 v[56:59], a[188:191], a[124:127], v[36:39]
    ds_write_addtid_b32 v65 offset:256
    v_cvt_pk_bf16_f32 v68, v48, v49
    v_mfma_f32_16x16x32_bf16 v[56:59], a[184:187], a[120:123], v[56:59]
    v_exp_f32 v50, v50
    v_mfma_f32_16x16x32_bf16 v[56:59], a[180:183], a[116:119], v[56:59]
    s_add_u32 m0, s35, 21296
    v_exp_f32 v51, v51
    v_mfma_f32_16x16x32_bf16 v[56:59], a[176:179], a[112:115], v[56:59]
    buffer_load_dwordx4 v5, s[20:23], s33 offen offset:1536 lds
    v_mfma_f32_16x16x32_bf16 v[56:59], a[172:175], a[108:111], v[56:59]
    s_mov_b32 m0, s36
    v_exp_f32 v52, v52
    v_mfma_f32_16x16x32_bf16 v[56:59], a[168:171], a[104:107], v[56:59]
    s_add_u32 s33, s33, s49
    ds_write_addtid_b32 v68 offset:512
    v_cvt_pk_bf16_f32 v69, v50, v51
    v_mfma_f32_16x16x32_bf16 v[56:59], a[164:167], a[100:103], v[56:59]
    v_exp_f32 v53, v53
    v_mfma_f32_16x16x32_bf16 v[56:59], a[160:163], a[96:99], v[56:59]
    ds_write_addtid_b32 v69 offset:768
    v_cvt_pk_bf16_f32 v72, v52, v53
    v_mfma_f32_16x16x32_bf16 v[60:63], a[160:163], a[128:131], v[40:43]
    v_exp_f32 v54, v54
    v_mfma_f32_16x16x32_bf16 v[60:63], a[164:167], a[132:135], v[60:63]
    v_exp_f32 v55, v55
    v_mfma_f32_16x16x32_bf16 v[60:63], a[168:171], a[136:139], v[60:63]
    ds_write_addtid_b32 v72 offset:1024
    v_cvt_pk_bf16_f32 v73, v54, v55
    v_mfma_f32_16x16x32_bf16 v[60:63], a[172:175], a[140:143], v[60:63]
    s_add_u32 m0, s34, 0
    v_exp_f32 v56, v56
    v_mfma_f32_16x16x32_bf16 v[60:63], a[176:179], a[144:147], v[60:63]
    buffer_load_dwordx4 v4, s[16:19], s32 offen lds
    v_mfma_f32_16x16x32_bf16 v[60:63], a[180:183], a[148:151], v[60:63]
    s_mov_b32 m0, s36
    v_exp_f32 v57, v57
    v_mfma_f32_16x16x32_bf16 v[60:63], a[184:187], a[152:155], v[60:63]
    ds_write_addtid_b32 v73 offset:1280
    v_cvt_pk_bf16_f32 v76, v56, v57
    v_mfma_f32_16x16x32_bf16 v[60:63], a[188:191], a[156:159], v[60:63]
    s_waitcnt lgkmcnt(6)
    v_exp_f32 v58, v58
    v_mfma_f32_16x16x32_bf16 v[144:147], v[96:99], a[192:195], v[144:147]
    v_exp_f32 v59, v59
    v_mfma_f32_16x16x32_bf16 v[144:147], v[112:115], a[196:199], v[144:147]
    ds_write_addtid_b32 v76 offset:1536
    v_cvt_pk_bf16_f32 v77, v58, v59
    v_mfma_f32_16x16x32_bf16 v[176:179], v[100:103], a[192:195], v[176:179]
    ds_write_addtid_b32 v77 offset:1792
    v_add_f32 v9, v48, v9
    v_mfma_f32_16x16x32_bf16 v[176:179], v[116:119], a[196:199], v[176:179]
    v_exp_f32 v60, v60
    v_mfma_f32_16x16x32_bf16 v[208:211], v[104:107], a[192:195], v[208:211]
    s_add_u32 m0, s34, 1568
    v_exp_f32 v61, v61
    v_mfma_f32_16x16x32_bf16 v[208:211], v[120:123], a[196:199], v[208:211]
    buffer_load_dwordx4 v4, s[16:19], s32 offen offset:512 lds
    v_mfma_f32_16x16x32_bf16 v[240:243], v[108:111], a[192:195], v[240:243]
    v_cvt_pk_bf16_f32 v14, v60, v61
    v_add_f32 v10, v52, v10
    v_mfma_f32_16x16x32_bf16 v[240:243], v[124:127], a[196:199], v[240:243]
    v_exp_f32 v62, v62
    v_mfma_f32_16x16x32_bf16 v[244:247], v[108:111], a[200:203], v[244:247]
    s_mov_b32 m0, s36
    v_exp_f32 v63, v63
    v_mfma_f32_16x16x32_bf16 v[244:247], v[124:127], a[204:207], v[244:247]
    ds_write_addtid_b32 v14 offset:2048
    v_cvt_pk_bf16_f32 v15, v62, v63
    v_mfma_f32_16x16x32_bf16 v[212:215], v[104:107], a[200:203], v[212:215]
    ds_write_addtid_b32 v15 offset:2304
    v_add_f32 v11, v56, v11
    v_mfma_f32_16x16x32_bf16 v[212:215], v[120:123], a[204:207], v[212:215]
    v_add_f32 v12, v60, v12
    v_add_f32 v8, v45, v8
    v_mfma_f32_16x16x32_bf16 v[180:183], v[100:103], a[200:203], v[180:183]
    v_add_f32 v9, v49, v9
    v_add_f32 v10, v53, v10
    v_mfma_f32_16x16x32_bf16 v[180:183], v[116:119], a[204:207], v[180:183]
    s_add_u32 m0, s34, 3136
    ds_read_b128 a[160:163], v1 offset:16640
    v_add_f32 v11, v57, v11
    v_mfma_f32_16x16x32_bf16 v[148:151], v[96:99], a[200:203], v[148:151]
    buffer_load_dwordx4 v4, s[16:19], s32 offen offset:1024 lds
    v_mfma_f32_16x16x32_bf16 v[148:151], v[112:115], a[204:207], v[148:151]
    ds_read_b128 a[164:167], v1 offset:16704
    v_add_f32 v12, v61, v12
    v_mfma_f32_16x16x32_bf16 v[152:155], v[96:99], a[208:211], v[152:155]
    ds_read_b128 a[168:171], v1 offset:16768
    v_add_f32 v8, v46, v8
    v_mfma_f32_16x16x32_bf16 v[152:155], v[112:115], a[212:215], v[152:155]
    ds_read_b128 a[172:175], v1 offset:16832
    v_add_f32 v9, v50, v9
    v_mfma_f32_16x16x32_bf16 v[184:187], v[100:103], a[208:211], v[184:187]
    ds_read_b128 a[176:179], v1 offset:16896
    v_add_f32 v10, v54, v10
    v_mfma_f32_16x16x32_bf16 v[184:187], v[116:119], a[212:215], v[184:187]
    ds_read_b128 a[180:183], v1 offset:16960
    v_add_f32 v11, v58, v11
    v_mfma_f32_16x16x32_bf16 v[216:219], v[104:107], a[208:211], v[216:219]
    ds_read_b128 a[184:187], v1 offset:17024
    v_add_f32 v12, v62, v12
    v_mfma_f32_16x16x32_bf16 v[216:219], v[120:123], a[212:215], v[216:219]
    ds_read_b128 a[188:191], v1 offset:17088
    v_add_f32 v8, v47, v8
    v_mfma_f32_16x16x32_bf16 v[248:251], v[108:111], a[208:211], v[248:251]
    s_add_u32 m0, s34, 4704
    ds_read_b64_tr_b16 a[192:193], v2 offset:49920
    v_add_f32 v9, v51, v9
    v_mfma_f32_16x16x32_bf16 v[248:251], v[124:127], a[212:215], v[248:251]
    buffer_load_dwordx4 v4, s[16:19], s32 offen offset:1536 lds
    v_mfma_f32_16x16x32_bf16 v[252:255], v[108:111], a[216:219], v[252:255]
    s_add_u32 s32, s32, s49
    ds_read_b64_tr_b16 a[194:195], v3 offset:49920
    v_add_f32 v10, v55, v10
    v_mfma_f32_16x16x32_bf16 v[252:255], v[124:127], a[220:223], v[252:255]
    ds_read_b64_tr_b16 a[200:201], v2 offset:49936
    v_add_f32 v11, v59, v11
    v_mfma_f32_16x16x32_bf16 v[220:223], v[104:107], a[216:219], v[220:223]
    ds_read_b64_tr_b16 a[202:203], v3 offset:49936
    v_add_f32 v12, v63, v12
    v_mfma_f32_16x16x32_bf16 v[220:223], v[120:123], a[220:223], v[220:223]
    ds_read_b64_tr_b16 a[208:209], v2 offset:49952
    v_mfma_f32_16x16x32_bf16 v[188:191], v[100:103], a[216:219], v[188:191]
    v_mfma_f32_16x16x32_bf16 v[188:191], v[116:119], a[220:223], v[188:191]
    ds_read_b64_tr_b16 a[210:211], v3 offset:49952
    v_mfma_f32_16x16x32_bf16 v[156:159], v[96:99], a[216:219], v[156:159]
    s_waitcnt vmcnt(12) lgkmcnt(6)
    ds_read_b64_tr_b16 a[216:217], v2 offset:49968
    v_mfma_f32_16x16x32_bf16 v[156:159], v[112:115], a[220:223], v[156:159]
    s_barrier
    ds_read_b64_tr_b16 a[218:219], v3 offset:49968
    v_mfma_f32_16x16x32_bf16 v[44:47], a[160:163], a[0:3], v[24:27]
    s_add_u32 m0, s35, 33280
    ds_read_b64_tr_b16 a[196:197], v2 offset:0
    v_mfma_f32_16x16x32_bf16 v[44:47], a[164:167], a[4:7], v[44:47]
    buffer_load_dwordx4 v5, s[20:23], s33 offen lds
    v_mfma_f32_16x16x32_bf16 v[44:47], a[168:171], a[8:11], v[44:47]
    ds_read2st64_b32 v[66:67], v6 offset0:0 offset1:1
    v_mfma_f32_16x16x32_bf16 v[44:47], a[172:175], a[12:15], v[44:47]
    ds_read_b64_tr_b16 a[198:199], v3 offset:0
    v_mfma_f32_16x16x32_bf16 v[44:47], a[176:179], a[16:19], v[44:47]
    ds_read2st64_b32 v[70:71], v6 offset0:2 offset1:3
    v_mfma_f32_16x16x32_bf16 v[44:47], a[180:183], a[20:23], v[44:47]
    ds_read2st64_b32 v[74:75], v6 offset0:4 offset1:5
    v_mfma_f32_16x16x32_bf16 v[44:47], a[184:187], a[24:27], v[44:47]
    ds_read2st64_b32 v[78:79], v6 offset0:6 offset1:7
    v_mfma_f32_16x16x32_bf16 v[44:47], a[188:191], a[28:31], v[44:47]
    ds_read_b64_tr_b16 a[204:205], v2 offset:16
    v_mfma_f32_16x16x32_bf16 v[48:51], a[188:191], a[60:63], v[28:31]
    ds_read_b64_tr_b16 a[206:207], v3 offset:16
    v_mfma_f32_16x16x32_bf16 v[48:51], a[184:187], a[56:59], v[48:51]
    s_add_u32 m0, s35, 34832
    ds_read_b64_tr_b16 a[212:213], v2 offset:32
    v_mfma_f32_16x16x32_bf16 v[48:51], a[180:183], a[52:55], v[48:51]
    buffer_load_dwordx4 v5, s[20:23], s33 offen offset:512 lds
    v_mfma_f32_16x16x32_bf16 v[48:51], a[176:179], a[48:51], v[48:51]
    ds_read_b64_tr_b16 a[214:215], v3 offset:32
    v_mfma_f32_16x16x32_bf16 v[48:51], a[172:175], a[44:47], v[48:51]
    ds_read_b64_tr_b16 a[220:221], v2 offset:48
    v_mfma_f32_16x16x32_bf16 v[48:51], a[168:171], a[40:43], v[48:51]
    ds_read_b64_tr_b16 a[222:223], v3 offset:48
    v_mfma_f32_16x16x32_bf16 v[48:51], a[164:167], a[36:39], v[48:51]
    v_mfma_f32_16x16x32_bf16 v[48:51], a[160:163], a[32:35], v[48:51]
    v_exp_f32 v44, v44
    v_mfma_f32_16x16x32_bf16 v[52:55], a[160:163], a[64:67], v[32:35]
    v_exp_f32 v45, v45
    v_mfma_f32_16x16x32_bf16 v[52:55], a[164:167], a[68:71], v[52:55]
    v_cvt_pk_bf16_f32 v80, v44, v45
    v_add_f32 v8, v44, v8
    v_mfma_f32_16x16x32_bf16 v[52:55], a[168:171], a[72:75], v[52:55]
    s_add_u32 m0, s35, 36384
    v_exp_f32 v46, v46
    v_mfma_f32_16x16x32_bf16 v[52:55], a[172:175], a[76:79], v[52:55]
    buffer_load_dwordx4 v5, s[20:23], s33 offen offset:1024 lds
    v_mfma_f32_16x16x32_bf16 v[52:55], a[176:179], a[80:83], v[52:55]
    s_mov_b32 m0, s36
    v_exp_f32 v47, v47
    v_mfma_f32_16x16x32_bf16 v[52:55], a[180:183], a[84:87], v[52:55]
    ds_write_addtid_b32 v80 offset:10240
    v_cvt_pk_bf16_f32 v81, v46, v47
    v_mfma_f32_16x16x32_bf16 v[52:55], a[184:187], a[88:91], v[52:55]
    v_exp_f32 v48, v48
    v_mfma_f32_16x16x32_bf16 v[52:55], a[188:191], a[92:95], v[52:55]
    v_exp_f32 v49, v49
    v_mfma_f32_16x16x32_bf16 v[56:59], a[188:191], a[124:127], v[36:39]
    ds_write_addtid_b32 v81 offset:10496
    v_cvt_pk_bf16_f32 v84, v48, v49
    v_mfma_f32_16x16x32_bf16 v[56:59], a[184:187], a[120:123], v[56:59]
    v_exp_f32 v50, v50
    v_mfma_f32_16x16x32_bf16 v[56:59], a[180:183], a[116:119], v[56:59]
    s_add_u32 m0, s35, 37936
    v_exp_f32 v51, v51
    v_mfma_f32_16x16x32_bf16 v[56:59], a[176:179], a[112:115], v[56:59]
    buffer_load_dwordx4 v5, s[20:23], s33 offen offset:1536 lds
    v_mfma_f32_16x16x32_bf16 v[56:59], a[172:175], a[108:111], v[56:59]
    s_mov_b32 m0, s36
    v_exp_f32 v52, v52
    v_mfma_f32_16x16x32_bf16 v[56:59], a[168:171], a[104:107], v[56:59]
    s_add_u32 s33, s33, s49
    ds_write_addtid_b32 v84 offset:10752
    v_cvt_pk_bf16_f32 v85, v50, v51
    v_mfma_f32_16x16x32_bf16 v[56:59], a[164:167], a[100:103], v[56:59]
    v_exp_f32 v53, v53
    v_mfma_f32_16x16x32_bf16 v[56:59], a[160:163], a[96:99], v[56:59]
    ds_write_addtid_b32 v85 offset:11008
    v_cvt_pk_bf16_f32 v88, v52, v53
    v_mfma_f32_16x16x32_bf16 v[60:63], a[160:163], a[128:131], v[40:43]
    v_exp_f32 v54, v54
    v_mfma_f32_16x16x32_bf16 v[60:63], a[164:167], a[132:135], v[60:63]
    v_exp_f32 v55, v55
    v_mfma_f32_16x16x32_bf16 v[60:63], a[168:171], a[136:139], v[60:63]
    ds_write_addtid_b32 v88 offset:11264
    v_cvt_pk_bf16_f32 v89, v54, v55
    v_mfma_f32_16x16x32_bf16 v[60:63], a[172:175], a[140:143], v[60:63]
    s_add_u32 m0, s34, 16640
    v_exp_f32 v56, v56
    v_mfma_f32_16x16x32_bf16 v[60:63], a[176:179], a[144:147], v[60:63]
    buffer_load_dwordx4 v4, s[16:19], s32 offen lds
    v_mfma_f32_16x16x32_bf16 v[60:63], a[180:183], a[148:151], v[60:63]
    s_mov_b32 m0, s36
    v_exp_f32 v57, v57
    v_mfma_f32_16x16x32_bf16 v[60:63], a[184:187], a[152:155], v[60:63]
    ds_write_addtid_b32 v89 offset:11520
    v_cvt_pk_bf16_f32 v92, v56, v57
    v_mfma_f32_16x16x32_bf16 v[60:63], a[188:191], a[156:159], v[60:63]
    s_waitcnt lgkmcnt(6)
    v_exp_f32 v58, v58
    v_mfma_f32_16x16x32_bf16 v[128:131], v[112:115], a[192:195], v[128:131]
    v_exp_f32 v59, v59
    v_mfma_f32_16x16x32_bf16 v[128:131], v[64:67], a[196:199], v[128:131]
    ds_write_addtid_b32 v92 offset:11776
    v_cvt_pk_bf16_f32 v93, v58, v59
    v_mfma_f32_16x16x32_bf16 v[160:163], v[116:119], a[192:195], v[160:163]
    ds_write_addtid_b32 v93 offset:12032
    v_add_f32 v9, v48, v9
    v_mfma_f32_16x16x32_bf16 v[160:163], v[68:71], a[196:199], v[160:163]
    v_exp_f32 v60, v60
    v_mfma_f32_16x16x32_bf16 v[192:195], v[120:123], a[192:195], v[192:195]
    s_add_u32 m0, s34, 18208
    v_exp_f32 v61, v61
    v_mfma_f32_16x16x32_bf16 v[192:195], v[72:75], a[196:199], v[192:195]
    buffer_load_dwordx4 v4, s[16:19], s32 offen offset:512 lds
    v_mfma_f32_16x16x32_bf16 v[224:227], v[124:127], a[192:195], v[224:227]
    v_cvt_pk_bf16_f32 v14, v60, v61
    v_add_f32 v10, v52, v10
    v_mfma_f32_16x16x32_bf16 v[224:227], v[76:79], a[196:199], v[224:227]
    v_exp_f32 v62, v62
    v_mfma_f32_16x16x32_bf16 v[228:231], v[124:127], a[200:203], v[228:231]
    s_mov_b32 m0, s36
    v_exp_f32 v63, v63
    v_mfma_f32_16x16x32_bf16 v[228:231], v[76:79], a[204:207], v[228:231]
    ds_write_addtid_b32 v14 offset:12288
    v_cvt_pk_bf16_f32 v15, v62, v63
    v_mfma_f32_16x16x32_bf16 v[196:199], v[120:123], a[200:203], v[196:199]
    ds_write_addtid_b32 v15 offset:12544
    v_add_f32 v11, v56, v11
    v_mfma_f32_16x16x32_bf16 v[196:199], v[72:75], a[204:207], v[196:199]
    s_sub_u32 s31, s31, 1
    v_add_f32 v12, v60, v12
    v_add_f32 v8, v45, v8
    v_mfma_f32_16x16x32_bf16 v[164:167], v[116:119], a[200:203], v[164:167]
    v_add_f32 v9, v49, v9
    v_add_f32 v10, v53, v10
    v_mfma_f32_16x16x32_bf16 v[164:167], v[68:71], a[204:207], v[164:167]
    s_add_u32 m0, s34, 19776
    ds_read_b128 a[160:163], v1 offset:33280
    v_add_f32 v11, v57, v11
    v_mfma_f32_16x16x32_bf16 v[132:135], v[112:115], a[200:203], v[132:135]
    buffer_load_dwordx4 v4, s[16:19], s32 offen offset:1024 lds
    v_mfma_f32_16x16x32_bf16 v[132:135], v[64:67], a[204:207], v[132:135]
    ds_read_b128 a[164:167], v1 offset:33344
    v_add_f32 v12, v61, v12
    v_mfma_f32_16x16x32_bf16 v[136:139], v[112:115], a[208:211], v[136:139]
    ds_read_b128 a[168:171], v1 offset:33408
    v_add_f32 v8, v46, v8
    v_mfma_f32_16x16x32_bf16 v[136:139], v[64:67], a[212:215], v[136:139]
    ds_read_b128 a[172:175], v1 offset:33472
    v_add_f32 v9, v50, v9
    v_mfma_f32_16x16x32_bf16 v[168:171], v[116:119], a[208:211], v[168:171]
    ds_read_b128 a[176:179], v1 offset:33536
    v_add_f32 v10, v54, v10
    v_mfma_f32_16x16x32_bf16 v[168:171], v[68:71], a[212:215], v[168:171]
    ds_read_b128 a[180:183], v1 offset:33600
    v_add_f32 v11, v58, v11
    v_mfma_f32_16x16x32_bf16 v[200:203], v[120:123], a[208:211], v[200:203]
    ds_read_b128 a[184:187], v1 offset:33664
    v_add_f32 v12, v62, v12
    v_mfma_f32_16x16x32_bf16 v[200:203], v[72:75], a[212:215], v[200:203]
    ds_read_b128 a[188:191], v1 offset:33728
    v_add_f32 v8, v47, v8
    v_mfma_f32_16x16x32_bf16 v[232:235], v[124:127], a[208:211], v[232:235]
    s_add_u32 m0, s34, 21344
    ds_read_b64_tr_b16 a[192:193], v2 offset:128
    v_add_f32 v9, v51, v9
    v_mfma_f32_16x16x32_bf16 v[232:235], v[76:79], a[212:215], v[232:235]
    buffer_load_dwordx4 v4, s[16:19], s32 offen offset:1536 lds
    v_mfma_f32_16x16x32_bf16 v[236:239], v[124:127], a[216:219], v[236:239]
    s_add_u32 s32, s32, s49
    ds_read_b64_tr_b16 a[194:195], v3 offset:128
    v_add_f32 v10, v55, v10
    v_mfma_f32_16x16x32_bf16 v[236:239], v[76:79], a[220:223], v[236:239]
    ds_read_b64_tr_b16 a[200:201], v2 offset:144
    v_add_f32 v11, v59, v11
    v_mfma_f32_16x16x32_bf16 v[204:207], v[120:123], a[216:219], v[204:207]
    ds_read_b64_tr_b16 a[202:203], v3 offset:144
    v_add_f32 v12, v63, v12
    v_mfma_f32_16x16x32_bf16 v[204:207], v[72:75], a[220:223], v[204:207]
    ds_read_b64_tr_b16 a[208:209], v2 offset:160
    v_mfma_f32_16x16x32_bf16 v[172:175], v[116:119], a[216:219], v[172:175]
    v_mfma_f32_16x16x32_bf16 v[172:175], v[68:71], a[220:223], v[172:175]
    s_cmp_lg_u32 s31, 0
    ds_read_b64_tr_b16 a[210:211], v3 offset:160
    v_mfma_f32_16x16x32_bf16 v[140:143], v[112:115], a[216:219], v[140:143]
    s_waitcnt vmcnt(12) lgkmcnt(6)
    ds_read_b64_tr_b16 a[216:217], v2 offset:176
    v_mfma_f32_16x16x32_bf16 v[140:143], v[64:67], a[220:223], v[140:143]
    s_barrier
    ds_read_b64_tr_b16 a[218:219], v3 offset:176
    s_cbranch_scc1 L_loop0
    v_mfma_f32_16x16x32_bf16 v[44:47], a[160:163], a[0:3], v[24:27]
    s_add_u32 m0, s35, 49920
    ds_read_b64_tr_b16 a[196:197], v2 offset:16640
    v_mfma_f32_16x16x32_bf16 v[44:47], a[164:167], a[4:7], v[44:47]
    buffer_load_dwordx4 v5, s[20:23], s33 offen lds
    v_mfma_f32_16x16x32_bf16 v[44:47], a[168:171], a[8:11], v[44:47]
    ds_read2st64_b32 v[82:83], v6 offset0:40 offset1:41
    v_mfma_f32_16x16x32_bf16 v[44:47], a[172:175], a[12:15], v[44:47]
    ds_read_b64_tr_b16 a[198:199], v3 offset:16640
    v_mfma_f32_16x16x32_bf16 v[44:47], a[176:179], a[16:19], v[44:47]
    s_add_u32 m0, s35, 51472
    ds_read2st64_b32 v[86:87], v6 offset0:42 offset1:43
    v_mfma_f32_16x16x32_bf16 v[44:47], a[180:183], a[20:23], v[44:47]
    buffer_load_dwordx4 v5, s[20:23], s33 offen offset:512 lds
    v_mfma_f32_16x16x32_bf16 v[44:47], a[184:187], a[24:27], v[44:47]
    ds_read2st64_b32 v[90:91], v6 offset0:44 offset1:45
    v_mfma_f32_16x16x32_bf16 v[44:47], a[188:191], a[28:31], v[44:47]
    ds_read2st64_b32 v[94:95], v6 offset0:46 offset1:47
    v_mfma_f32_16x16x32_bf16 v[48:51], a[188:191], a[60:63], v[28:31]
    s_add_u32 m0, s35, 53024
    ds_read_b64_tr_b16 a[204:205], v2 offset:16656
    v_mfma_f32_16x16x32_bf16 v[48:51], a[184:187], a[56:59], v[48:51]
    buffer_load_dwordx4 v5, s[20:23], s33 offen offset:1024 lds
    v_mfma_f32_16x16x32_bf16 v[48:51], a[180:183], a[52:55], v[48:51]
    ds_read_b64_tr_b16 a[206:207], v3 offset:16656
    v_mfma_f32_16x16x32_bf16 v[48:51], a[176:179], a[48:51], v[48:51]
    v_exp_f32 v44, v44
    v_mfma_f32_16x16x32_bf16 v[48:51], a[172:175], a[44:47], v[48:51]
    s_add_u32 m0, s35, 54576
    v_exp_f32 v45, v45
    v_mfma_f32_16x16x32_bf16 v[48:51], a[168:171], a[40:43], v[48:51]
    buffer_load_dwordx4 v5, s[20:23], s33 offen offset:1536 lds
    v_mfma_f32_16x16x32_bf16 v[48:51], a[164:167], a[36:39], v[48:51]
    s_add_u32 s33, s33, s49
    v_exp_f32 v46, v46
    v_mfma_f32_16x16x32_bf16 v[48:51], a[160:163], a[32:35], v[48:51]
    v_exp_f32 v47, v47
    v_mfma_f32_16x16x32_bf16 v[52:55], a[160:163], a[64:67], v[32:35]
    s_mov_b32 m0, s36
    ds_read_b64_tr_b16 a[212:213], v2 offset:16672
    v_cvt_pk_bf16_f32 v96, v44, v45
    v_mfma_f32_16x16x32_bf16 v[52:55], a[164:167], a[68:71], v[52:55]
    ds_write_addtid_b32 v96 offset:0
    v_cvt_pk_bf16_f32 v97, v46, v47
    v_mfma_f32_16x16x32_bf16 v[52:55], a[168:171], a[72:75], v[52:55]
    ds_write_addtid_b32 v97 offset:256
    v_add_f32 v8, v44, v8
    v_mfma_f32_16x16x32_bf16 v[52:55], a[172:175], a[76:79], v[52:55]
    v_exp_f32 v48, v48
    v_mfma_f32_16x16x32_bf16 v[52:55], a[176:179], a[80:83], v[52:55]
    v_exp_f32 v49, v49
    v_mfma_f32_16x16x32_bf16 v[52:55], a[180:183], a[84:87], v[52:55]
    v_exp_f32 v50, v50
    v_mfma_f32_16x16x32_bf16 v[52:55], a[184:187], a[88:91], v[52:55]
    v_exp_f32 v51, v51
    v_mfma_f32_16x16x32_bf16 v[52:55], a[188:191], a[92:95], v[52:55]
    ds_read_b64_tr_b16 a[214:215], v3 offset:16672
    v_cvt_pk_bf16_f32 v100, v48, v49
    v_mfma_f32_16x16x32_bf16 v[56:59], a[188:191], a[124:127], v[36:39]
    ds_write_addtid_b32 v100 offset:512
    v_cvt_pk_bf16_f32 v101, v50, v51
    v_mfma_f32_16x16x32_bf16 v[56:59], a[184:187], a[120:123], v[56:59]
    ds_write_addtid_b32 v101 offset:768
    v_add_f32 v9, v48, v9
    v_mfma_f32_16x16x32_bf16 v[56:59], a[180:183], a[116:119], v[56:59]
    ds_read_b64_tr_b16 a[220:221], v2 offset:16688
    v_add_f32 v8, v45, v8
    v_mfma_f32_16x16x32_bf16 v[56:59], a[176:179], a[112:115], v[56:59]
    v_exp_f32 v52, v52
    v_mfma_f32_16x16x32_bf16 v[56:59], a[172:175], a[108:111], v[56:59]
    v_exp_f32 v53, v53
    v_mfma_f32_16x16x32_bf16 v[56:59], a[168:171], a[104:107], v[56:59]
    v_exp_f32 v54, v54
    v_mfma_f32_16x16x32_bf16 v[56:59], a[164:167], a[100:103], v[56:59]
    v_exp_f32 v55, v55
    v_mfma_f32_16x16x32_bf16 v[56:59], a[160:163], a[96:99], v[56:59]
    ds_read_b64_tr_b16 a[222:223], v3 offset:16688
    v_cvt_pk_bf16_f32 v104, v52, v53
    v_mfma_f32_16x16x32_bf16 v[60:63], a[160:163], a[128:131], v[40:43]
    ds_write_addtid_b32 v104 offset:1024
    v_cvt_pk_bf16_f32 v105, v54, v55
    v_mfma_f32_16x16x32_bf16 v[60:63], a[164:167], a[132:135], v[60:63]
    ds_write_addtid_b32 v105 offset:1280
    v_add_f32 v10, v52, v10
    v_mfma_f32_16x16x32_bf16 v[60:63], a[168:171], a[136:139], v[60:63]
    v_add_f32 v9, v49, v9
    v_add_f32 v10, v53, v10
    v_mfma_f32_16x16x32_bf16 v[60:63], a[172:175], a[140:143], v[60:63]
    v_exp_f32 v56, v56
    v_mfma_f32_16x16x32_bf16 v[60:63], a[176:179], a[144:147], v[60:63]
    v_exp_f32 v57, v57
    v_mfma_f32_16x16x32_bf16 v[60:63], a[180:183], a[148:151], v[60:63]
    v_exp_f32 v58, v58
    v_mfma_f32_16x16x32_bf16 v[60:63], a[184:187], a[152:155], v[60:63]
    v_exp_f32 v59, v59
    v_mfma_f32_16x16x32_bf16 v[60:63], a[188:191], a[156:159], v[60:63]
    s_waitcnt lgkmcnt(3)
    ds_read_b128 a[160:163], v1 offset:49920
    v_cvt_pk_bf16_f32 v108, v56, v57
    v_mfma_f32_16x16x32_bf16 v[128:131], v[80:83], a[196:199], v[128:131]
    ds_read_b128 a[164:167], v1 offset:49984
    v_cvt_pk_bf16_f32 v109, v58, v59
    v_mfma_f32_16x16x32_bf16 v[160:163], v[84:87], a[196:199], v[160:163]
    ds_read_b128 a[168:171], v1 offset:50048
    v_add_f32 v8, v46, v8
    v_mfma_f32_16x16x32_bf16 v[192:195], v[88:91], a[196:199], v[192:195]
    ds_read_b128 a[172:175], v1 offset:50112
    v_add_f32 v9, v50, v9
    v_mfma_f32_16x16x32_bf16 v[224:227], v[92:95], a[196:199], v[224:227]
    v_exp_f32 v60, v60
    v_mfma_f32_16x16x32_bf16 v[228:231], v[92:95], a[204:207], v[228:231]
    v_exp_f32 v61, v61
    v_mfma_f32_16x16x32_bf16 v[196:199], v[88:91], a[204:207], v[196:199]
    ds_read_b128 a[176:179], v1 offset:50176
    v_cvt_pk_bf16_f32 v14, v60, v61
    v_mfma_f32_16x16x32_bf16 v[164:167], v[84:87], a[204:207], v[164:167]
    ds_write_addtid_b32 v108 offset:1536
    v_add_f32 v10, v54, v10
    v_mfma_f32_16x16x32_bf16 v[132:135], v[80:83], a[204:207], v[132:135]
    v_exp_f32 v62, v62
    v_mfma_f32_16x16x32_bf16 v[136:139], v[80:83], a[212:215], v[136:139]
    ds_read_b128 a[180:183], v1 offset:50240
    v_add_f32 v8, v47, v8
    v_mfma_f32_16x16x32_bf16 v[168:171], v[84:87], a[212:215], v[168:171]
    ds_write_addtid_b32 v109 offset:1792
    v_add_f32 v9, v51, v9
    v_exp_f32 v63, v63
    v_mfma_f32_16x16x32_bf16 v[200:203], v[88:91], a[212:215], v[200:203]
    ds_read_b128 a[184:187], v1 offset:50304
    v_cvt_pk_bf16_f32 v15, v62, v63
    v_mfma_f32_16x16x32_bf16 v[232:235], v[92:95], a[212:215], v[232:235]
    s_waitcnt lgkmcnt(5)
    ds_read_b128 a[188:191], v1 offset:50368
    v_add_f32 v10, v55, v10
    v_mfma_f32_16x16x32_bf16 v[236:239], v[92:95], a[220:223], v[236:239]
    ds_write_addtid_b32 v14 offset:2048
    ds_write_addtid_b32 v15 offset:2304
    v_mfma_f32_16x16x32_bf16 v[204:207], v[88:91], a[220:223], v[204:207]
    v_mfma_f32_16x16x32_bf16 v[172:175], v[84:87], a[220:223], v[172:175]
    s_waitcnt vmcnt(0) lgkmcnt(0)
    v_mfma_f32_16x16x32_bf16 v[140:143], v[80:83], a[220:223], v[140:143]
    s_barrier
    v_mfma_f32_16x16x32_bf16 v[44:47], a[160:163], a[0:3], v[24:27]
    ds_read_b64_tr_b16 a[192:193], v2 offset:33280
    v_add_f32 v11, v56, v11
    v_mfma_f32_16x16x32_bf16 v[44:47], a[164:167], a[4:7], v[44:47]
    ds_read2st64_b32 v[98:99], v6 offset0:0 offset1:1
    v_add_f32 v11, v57, v11
    v_mfma_f32_16x16x32_bf16 v[44:47], a[168:171], a[8:11], v[44:47]
L_pad0_3:
    s_cbranch_vccnz L_walked0
    ds_read_b64_tr_b16 a[194:195], v3 offset:33280
    v_add_f32 v11, v58, v11
    v_mfma_f32_16x16x32_bf16 v[44:47], a[172:175], a[12:15], v[44:47]
    ds_read2st64_b32 v[102:103], v6 offset0:2 offset1:3
    v_add_f32 v11, v59, v11
    v_mfma_f32_16x16x32_bf16 v[44:47], a[176:179], a[16:19], v[44:47]
    ds_read_b64_tr_b16 a[196:197], v2 offset:33296
    v_add_f32 v12, v60, v12
    v_mfma_f32_16x16x32_bf16 v[44:47], a[180:183], a[20:23], v[44:47]
    ds_read_b64_tr_b16 a[198:199], v3 offset:33296
    v_add_f32 v12, v61, v12
    v_mfma_f32_16x16x32_bf16 v[44:47], a[184:187], a[24:27], v[44:47]
    ds_read_b64_tr_b16 a[200:201], v2 offset:33312
    v_add_f32 v12, v62, v12
    v_mfma_f32_16x16x32_bf16 v[44:47], a[188:191], a[28:31], v[44:47]
    ds_read_b64_tr_b16 a[202:203], v3 offset:33312
    v_add_f32 v12, v63, v12
    v_mfma_f32_16x16x32_bf16 v[48:51], a[160:163], a[32:35], v[28:31]
    ds_read_b64_tr_b16 a[204:205], v2 offset:33328
    v_mfma_f32_16x16x32_bf16 v[48:51], a[164:167], a[36:39], v[48:51]
    ds_read_b64_tr_b16 a[206:207], v3 offset:33328
    v_mfma_f32_16x16x32_bf16 v[48:51], a[168:171], a[40:43], v[48:51]
    ds_read_b64_tr_b16 a[208:209], v2 offset:49920
    v_mfma_f32_16x16x32_bf16 v[48:51], a[172:175], a[44:47], v[48:51]
    v_exp_f32 v44, v44
    v_mfma_f32_16x16x32_bf16 v[48:51], a[176:179], a[48:51], v[48:51]
    v_exp_f32 v45, v45
    v_mfma_f32_16x16x32_bf16 v[48:51], a[180:183], a[52:55], v[48:51]
    v_exp_f32 v46, v46
    v_mfma_f32_16x16x32_bf16 v[48:51], a[184:187], a[56:59], v[48:51]
    v_exp_f32 v47, v47
    v_mfma_f32_16x16x32_bf16 v[48:51], a[188:191], a[60:63], v[48:51]
    s_mov_b32 m0, s36
    v_cvt_pk_bf16_f32 v112, v44, v45
    v_cvt_pk_bf16_f32 v113, v46, v47
    v_mfma_f32_16x16x32_bf16 v[52:55], a[160:163], a[64:67], v[32:35]
    ds_write_addtid_b32 v112 offset:10240
    v_add_f32 v8, v44, v8
    v_mfma_f32_16x16x32_bf16 v[52:55], a[164:167], a[68:71], v[52:55]
    ds_write_addtid_b32 v113 offset:10496
    v_add_f32 v8, v45, v8
    v_mfma_f32_16x16x32_bf16 v[52:55], a[168:171], a[72:75], v[52:55]
    ds_read_b64_tr_b16 a[210:211], v3 offset:49920
    v_add_f32 v8, v46, v8
    v_mfma_f32_16x16x32_bf16 v[52:55], a[172:175], a[76:79], v[52:55]
    v_exp_f32 v48, v48
    v_mfma_f32_16x16x32_bf16 v[52:55], a[176:179], a[80:83], v[52:55]
    v_exp_f32 v49, v49
    v_mfma_f32_16x16x32_bf16 v[52:55], a[180:183], a[84:87], v[52:55]
    v_exp_f32 v50, v50
    v_mfma_f32_16x16x32_bf16 v[52:55], a[184:187], a[88:91], v[52:55]
    v_exp_f32 v51, v51
    v_mfma_f32_16x16x32_bf16 v[52:55], a[188:191], a[92:95], v[52:55]
    s_waitcnt lgkmcnt(3)
    ds_read_b64_tr_b16 a[212:213], v2 offset:49936
    v_cvt_pk_bf16_f32 v116, v48, v49
    v_mfma_f32_16x16x32_bf16 v[128:131], v[96:99], a[192:195], v[128:131]
    ds_write_addtid_b32 v116 offset:10752
    v_cvt_pk_bf16_f32 v117, v50, v51
    v_mfma_f32_16x16x32_bf16 v[160:163], v[100:103], a[192:195], v[160:163]
    ds_write_addtid_b32 v117 offset:11008
    v_add_f32 v8, v47, v8
    v_mfma_f32_16x16x32_bf16 v[164:167], v[100:103], a[196:199], v[164:167]
    ds_write_addtid_b32 v8 offset:20480
    v_add_f32 v9, v48, v9
    v_add_f32 v9, v49, v9
    v_add_f32 v9, v50, v9
    v_add_f32 v9, v51, v9
    v_mfma_f32_16x16x32_bf16 v[132:135], v[96:99], a[196:199], v[132:135]
    ds_write_addtid_b32 v9 offset:20736
    v_mfma_f32_16x16x32_bf16 v[136:139], v[96:99], a[200:203], v[136:139]
    v_exp_f32 v52, v52
    v_mfma_f32_16x16x32_bf16 v[168:171], v[100:103], a[200:203], v[168:171]
    s_waitcnt lgkmcnt(0)
    v_exp_f32 v53, v53
    v_mfma_f32_16x16x32_bf16 v[172:175], v[100:103], a[204:207], v[172:175]
    s_barrier
    ds_read2st64_b32 v[24:25], v6 offset0:80 offset1:81
    v_add_f32 v10, v52, v10
    v_mfma_f32_16x16x32_bf16 v[140:143], v[96:99], a[204:207], v[140:143]
    ds_read2st64_b32 v[114:115], v6 offset0:40 offset1:41
    v_add_f32 v10, v53, v10
    v_mfma_f32_16x16x32_bf16 v[56:59], a[160:163], a[96:99], v[36:39]
    v_exp_f32 v54, v54
    v_mfma_f32_16x16x32_bf16 v[56:59], a[164:167], a[100:103], v[56:59]
    ds_read_b64_tr_b16 a[214:215], v3 offset:49936
    v_add_f32 v10, v54, v10
    v_mfma_f32_16x16x32_bf16 v[56:59], a[168:171], a[104:107], v[56:59]
    ds_read_b64_tr_b16 a[216:217], v2 offset:49952
    v_cvt_pk_bf16_f32 v120, v52, v53
    v_mfma_f32_16x16x32_bf16 v[56:59], a[172:175], a[108:111], v[56:59]
    ds_read2st64_b32 v[118:119], v6 offset0:42 offset1:43
    v_mfma_f32_16x16x32_bf16 v[56:59], a[176:179], a[112:115], v[56:59]
    s_waitcnt lgkmcnt(4)
    v_add_f32 v44, v8, v24
    v_add_f32 v45, v8, v24
    v_mfma_f32_16x16x32_bf16 v[56:59], a[180:183], a[116:119], v[56:59]
    s_nop 0
    v_permlane32_swap_b32 v44, v45
    v_add_f32 v24, v44, v45
    v_mfma_f32_16x16x32_bf16 v[56:59], a[184:187], a[120:123], v[56:59]
    v_add_f32 v45, v44, v45
    v_add_f32 v48, v9, v25
    v_mfma_f32_16x16x32_bf16 v[56:59], a[188:191], a[124:127], v[56:59]
    v_permlane16_swap_b32 v24, v45
    v_add_f32 v44, v24, v45
    v_mfma_f32_16x16x32_bf16 v[60:63], a[160:163], a[128:131], v[40:43]
    v_rcp_f32 v44, v44
    v_mfma_f32_16x16x32_bf16 v[60:63], a[164:167], a[132:135], v[60:63]
    ds_write_addtid_b32 v44 offset:22016
    v_add_f32 v49, v9, v25
    v_mfma_f32_16x16x32_bf16 v[60:63], a[168:171], a[136:139], v[60:63]
    ds_read_b128 v[44:47], v21 offset:22016
    v_permlane32_swap_b32 v48, v49
    v_mfma_f32_16x16x32_bf16 v[60:63], a[172:175], a[140:143], v[60:63]
    ds_read_b64_tr_b16 a[218:219], v3 offset:49952
    v_add_f32 v25, v48, v49
    v_mfma_f32_16x16x32_bf16 v[60:63], a[176:179], a[144:147], v[60:63]
    ds_read_b64_tr_b16 a[220:221], v2 offset:49968
    v_add_f32 v49, v48, v49
    v_mfma_f32_16x16x32_bf16 v[60:63], a[180:183], a[148:151], v[60:63]
    ds_read_b64_tr_b16 a[222:223], v3 offset:49968
    v_permlane16_swap_b32 v25, v49
    v_mfma_f32_16x16x32_bf16 v[60:63], a[184:187], a[152:155], v[60:63]
    ds_read2st64_b32 v[106:107], v6 offset0:4 offset1:5
    v_add_f32 v48, v25, v49
    v_mfma_f32_16x16x32_bf16 v[60:63], a[188:191], a[156:159], v[60:63]
    s_waitcnt lgkmcnt(6)
    v_rcp_f32 v48, v48
    v_mfma_f32_16x16x32_bf16 v[128:131], v[112:115], a[208:211], v[128:131]
    ds_write_addtid_b32 v48 offset:22272
    v_mfma_f32_16x16x32_bf16 v[132:135], v[112:115], a[212:215], v[132:135]
    s_waitcnt lgkmcnt(4)
    ds_read_b128 v[48:51], v21 offset:22272
    v_mfma_f32_16x16x32_bf16 v[136:139], v[112:115], a[216:219], v[136:139]
    s_waitcnt lgkmcnt(3)
    v_exp_f32 v55, v55
    v_mfma_f32_16x16x32_bf16 v[140:143], v[112:115], a[220:223], v[140:143]
    ds_read2st64_b32 v[110:111], v6 offset0:6 offset1:7
    v_add_f32 v10, v55, v10
    v_mfma_f32_16x16x32_bf16 v[160:163], v[116:119], a[208:211], v[160:163]
    v_exp_f32 v56, v56
    v_mfma_f32_16x16x32_bf16 v[164:167], v[116:119], a[212:215], v[164:167]
    ds_write_addtid_b32 v120 offset:11264
    v_cvt_pk_bf16_f32 v121, v54, v55
    v_mfma_f32_16x16x32_bf16 v[168:171], v[116:119], a[216:219], v[168:171]
    v_exp_f32 v57, v57
    v_mfma_f32_16x16x32_bf16 v[172:175], v[116:119], a[220:223], v[172:175]
    s_waitcnt lgkmcnt(4)
    v_exp_f32 v58, v58
    v_pk_mul_f32 v[128:129], v[128:129], v[44:45]
    v_pk_mul_f32 v[132:133], v[132:133], v[44:45]
    v_pk_mul_f32 v[136:137], v[136:137], v[44:45]
    v_pk_mul_f32 v[140:141], v[140:141], v[44:45]
    v_pk_mul_f32 v[130:131], v[130:131], v[46:47]
    v_pk_mul_f32 v[134:135], v[134:135], v[46:47]
    v_pk_mul_f32 v[138:139], v[138:139], v[46:47]
    v_pk_mul_f32 v[142:143], v[142:143], v[46:47]
    v_cvt_pk_bf16_f32 v128, v128, v132
    v_cvt_pk_bf16_f32 v129, v129, v133
    v_cvt_pk_bf16_f32 v130, v130, v134
    v_cvt_pk_bf16_f32 v131, v131, v135
    v_cvt_pk_bf16_f32 v136, v136, v140
    v_cvt_pk_bf16_f32 v137, v137, v141
    v_cvt_pk_bf16_f32 v138, v138, v142
    v_cvt_pk_bf16_f32 v139, v139, v143
    ds_write2_b32 v22, v128, v136 offset0:0 offset1:1
    ds_write2_b32 v22, v129, v137 offset0:36 offset1:37
    ds_write2_b32 v22, v130, v138 offset0:72 offset1:73
    ds_write2_b32 v22, v131, v139 offset0:108 offset1:109
    ds_read_b64_tr_b16 a[240:241], v23 offset:0
    ds_read_b64_tr_b16 a[242:243], v23 offset:32
    ds_read_b64_tr_b16 a[244:245], v23 offset:1152
    ds_read_b64_tr_b16 a[246:247], v23 offset:1184
    s_waitcnt lgkmcnt(10)
    v_pk_mul_f32 v[160:161], v[160:161], v[48:49]
    v_pk_mul_f32 v[164:165], v[164:165], v[48:49]
    v_pk_mul_f32 v[168:169], v[168:169], v[48:49]
    v_pk_mul_f32 v[172:173], v[172:173], v[48:49]
    v_pk_mul_f32 v[162:163], v[162:163], v[50:51]
    v_pk_mul_f32 v[166:167], v[166:167], v[50:51]
    v_pk_mul_f32 v[170:171], v[170:171], v[50:51]
    v_pk_mul_f32 v[174:175], v[174:175], v[50:51]
    v_cvt_pk_bf16_f32 v160, v160, v164
    v_cvt_pk_bf16_f32 v161, v161, v165
    v_cvt_pk_bf16_f32 v162, v162, v166
    v_cvt_pk_bf16_f32 v163, v163, v167
    v_cvt_pk_bf16_f32 v168, v168, v172
    v_cvt_pk_bf16_f32 v169, v169, v173
    v_cvt_pk_bf16_f32 v170, v170, v174
    v_cvt_pk_bf16_f32 v171, v171, v175
    s_waitcnt lgkmcnt(2)
    buffer_store_dwordx4 a[240:243], v13, s[24:27], 0 offen sc0 sc1
    s_waitcnt lgkmcnt(0)
    buffer_store_dwordx4 a[244:247], v13, s[24:27], s4 offen sc0 sc1
    ds_write2_b32 v22, v160, v168 offset0:0 offset1:1
    ds_write2_b32 v22, v161, v169 offset0:36 offset1:37
    ds_write2_b32 v22, v162, v170 offset0:72 offset1:73
    ds_write2_b32 v22, v163, v171 offset0:108 offset1:109
    ds_read_b64_tr_b16 a[248:249], v23 offset:0
    ds_read_b64_tr_b16 a[250:251], v23 offset:32
    ds_read_b64_tr_b16 a[252:253], v23 offset:1152
    ds_read_b64_tr_b16 a[254:255], v23 offset:1184
    v_mfma_f32_16x16x32_bf16 v[192:195], v[104:107], a[192:195], v[192:195]
    ds_write_addtid_b32 v121 offset:11520
    v_cvt_pk_bf16_f32 v124, v56, v57
    v_mfma_f32_16x16x32_bf16 v[224:227], v[108:111], a[192:195], v[224:227]
    v_exp_f32 v59, v59
    v_mfma_f32_16x16x32_bf16 v[228:231], v[108:111], a[196:199], v[228:231]
    ds_read_b64_tr_b16 a[224:225], v2 offset:128
    v_cvt_pk_bf16_f32 v125, v58, v59
    v_mfma_f32_16x16x32_bf16 v[196:199], v[104:107], a[196:199], v[196:199]
    v_exp_f32 v60, v60
    v_mfma_f32_16x16x32_bf16 v[200:203], v[104:107], a[200:203], v[200:203]
    ds_read_b64_tr_b16 a[226:227], v3 offset:128
    v_add_f32 v11, v56, v11
    v_mfma_f32_16x16x32_bf16 v[232:235], v[108:111], a[200:203], v[232:235]
    s_waitcnt lgkmcnt(5)
    buffer_store_dwordx4 a[248:251], v13, s[24:27], s48 offen sc0 sc1
    v_mfma_f32_16x16x32_bf16 v[236:239], v[108:111], a[204:207], v[236:239]
    s_waitcnt lgkmcnt(3)
    buffer_store_dwordx4 a[252:255], v13, s[24:27], s5 offen sc0 sc1
    v_mfma_f32_16x16x32_bf16 v[204:207], v[104:107], a[204:207], v[204:207]
    s_waitcnt lgkmcnt(0)
    v_exp_f32 v61, v61
    v_add_f32 v11, v57, v11
    v_exp_f32 v62, v62
    v_add_f32 v11, v58, v11
    v_exp_f32 v63, v63
    v_add_f32 v11, v59, v11
    v_add_f32 v12, v60, v12
    v_add_f32 v12, v61, v12
    v_add_f32 v12, v62, v12
    v_add_f32 v12, v63, v12
    v_mfma_f32_16x16x32_bf16 v[144:147], v[64:67], a[224:227], v[144:147]
    ds_write_addtid_b32 v124 offset:11776
    v_max3_u32 v16, v8, v9, v10
    v_mfma_f32_16x16x32_bf16 v[176:179], v[68:71], a[224:227], v[176:179]
    ds_write_addtid_b32 v125 offset:12032
    v_max3_u32 v16, v16, v11, v12
    ds_read_b64_tr_b16 a[228:229], v2 offset:144
    ds_read_b64_tr_b16 a[230:231], v3 offset:144
    v_cvt_pk_bf16_f32 v14, v60, v61
    v_cvt_pk_bf16_f32 v15, v62, v63
    v_mfma_f32_16x16x32_bf16 v[208:211], v[72:75], a[224:227], v[208:211]
    ds_write_addtid_b32 v16 offset:21760
    ds_write_addtid_b32 v14 offset:12288
    ds_write_addtid_b32 v10 offset:20992
    ds_write_addtid_b32 v11 offset:21248
    ds_write_addtid_b32 v12 offset:21504
    ds_write_addtid_b32 v15 offset:12544
    v_mfma_f32_16x16x32_bf16 v[240:243], v[76:79], a[224:227], v[240:243]
    s_waitcnt lgkmcnt(6)
    ds_read_b64_tr_b16 a[232:233], v2 offset:160
    v_mfma_f32_16x16x32_bf16 v[244:247], v[76:79], a[228:231], v[244:247]
    s_waitcnt lgkmcnt(1)
    ds_read_b64_tr_b16 a[234:235], v3 offset:160
    v_mfma_f32_16x16x32_bf16 v[212:215], v[72:75], a[228:231], v[212:215]
    s_barrier
    ds_read2st64_b32 v[26:27], v6 offset0:82 offset1:83
    v_mfma_f32_16x16x32_bf16 v[180:183], v[68:71], a[228:231], v[180:183]
    ds_read_b64_tr_b16 a[236:237], v2 offset:176
    v_mfma_f32_16x16x32_bf16 v[148:151], v[64:67], a[228:231], v[148:151]
    s_waitcnt lgkmcnt(2)
    ds_read_b64_tr_b16 a[238:239], v3 offset:176
    v_mfma_f32_16x16x32_bf16 v[152:155], v[64:67], a[232:235], v[152:155]
    ds_read2st64_b32 v[122:123], v6 offset0:44 offset1:45
    v_mfma_f32_16x16x32_bf16 v[184:187], v[68:71], a[232:235], v[184:187]
    ds_read2st64_b32 v[126:127], v6 offset0:46 offset1:47
    v_mfma_f32_16x16x32_bf16 v[216:219], v[72:75], a[232:235], v[216:219]
    ds_read2st64_b32 v[30:31], v6 offset0:85 offset1:105
    v_mfma_f32_16x16x32_bf16 v[248:251], v[76:79], a[232:235], v[248:251]
    s_waitcnt lgkmcnt(3)
    v_add_f32 v52, v10, v26
    v_add_f32 v53, v10, v26
    v_mfma_f32_16x16x32_bf16 v[252:255], v[76:79], a[236:239], v[252:255]
    s_nop 0
    v_permlane32_swap_b32 v52, v53
    v_add_f32 v26, v52, v53
    v_mfma_f32_16x16x32_bf16 v[220:223], v[72:75], a[236:239], v[220:223]
    v_add_f32 v53, v52, v53
    v_add_f32 v56, v11, v27
    v_mfma_f32_16x16x32_bf16 v[188:191], v[68:71], a[236:239], v[188:191]
    ds_read_b64_tr_b16 a[160:161], v2 offset:16768
    v_permlane16_swap_b32 v26, v53
    v_mfma_f32_16x16x32_bf16 v[156:159], v[64:67], a[236:239], v[156:159]
    s_waitcnt lgkmcnt(3)
    ds_read2st64_b32 v[32:33], v7 offset0:85 offset1:105
    v_add_f32 v52, v26, v53
    v_mfma_f32_16x16x32_bf16 v[192:195], v[120:123], a[208:211], v[192:195]
    v_rcp_f32 v52, v52
    v_mfma_f32_16x16x32_bf16 v[196:199], v[120:123], a[212:215], v[196:199]
    ds_write_addtid_b32 v52 offset:22528
    v_add_f32 v57, v11, v27
    v_mfma_f32_16x16x32_bf16 v[200:203], v[120:123], a[216:219], v[200:203]
    ds_read_b128 v[52:55], v21 offset:22528
    v_permlane32_swap_b32 v56, v57
    v_mfma_f32_16x16x32_bf16 v[204:207], v[120:123], a[220:223], v[204:207]
    s_waitcnt lgkmcnt(4)
    ds_read_b64_tr_b16 a[162:163], v3 offset:16768
    v_add_f32 v27, v56, v57
    v_mfma_f32_16x16x32_bf16 v[224:227], v[124:127], a[208:211], v[224:227]
    ds_read_b64_tr_b16 a[164:165], v2 offset:33408
    v_add_f32 v57, v56, v57
    v_mfma_f32_16x16x32_bf16 v[228:231], v[124:127], a[212:215], v[228:231]
    ds_read_b64_tr_b16 a[166:167], v3 offset:33408
    v_permlane16_swap_b32 v27, v57
    v_mfma_f32_16x16x32_bf16 v[232:235], v[124:127], a[216:219], v[232:235]
    ds_read_b64_tr_b16 a[168:169], v2 offset:50048
    v_add_f32 v56, v27, v57
    v_mfma_f32_16x16x32_bf16 v[236:239], v[124:127], a[220:223], v[236:239]
    s_waitcnt lgkmcnt(3)
    v_rcp_f32 v56, v56
    s_nop 0
    ds_write_addtid_b32 v56 offset:22784
    ds_read_b128 v[56:59], v21 offset:22784
    ds_read_b64_tr_b16 a[170:171], v3 offset:50048
    v_pk_mul_f32 v[192:193], v[192:193], v[52:53]
    v_pk_mul_f32 v[196:197], v[196:197], v[52:53]
    v_pk_mul_f32 v[200:201], v[200:201], v[52:53]
    v_pk_mul_f32 v[204:205], v[204:205], v[52:53]
    v_pk_mul_f32 v[194:195], v[194:195], v[54:55]
    v_pk_mul_f32 v[198:199], v[198:199], v[54:55]
    v_pk_mul_f32 v[202:203], v[202:203], v[54:55]
    v_pk_mul_f32 v[206:207], v[206:207], v[54:55]
    v_cvt_pk_bf16_f32 v192, v192, v196
    v_cvt_pk_bf16_f32 v193, v193, v197
    v_cvt_pk_bf16_f32 v194, v194, v198
    v_cvt_pk_bf16_f32 v195, v195, v199
    v_cvt_pk_bf16_f32 v200, v200, v204
    v_cvt_pk_bf16_f32 v201, v201, v205
    v_cvt_pk_bf16_f32 v202, v202, v206
    v_cvt_pk_bf16_f32 v203, v203, v207
    ds_write2_b32 v22, v192, v200 offset0:0 offset1:1
    ds_write2_b32 v22, v193, v201 offset0:36 offset1:37
    ds_write2_b32 v22, v194, v202 offset0:72 offset1:73
    ds_write2_b32 v22, v195, v203 offset0:108 offset1:109
    ds_read_b64_tr_b16 a[240:241], v23 offset:0
    ds_read_b64_tr_b16 a[242:243], v23 offset:32
    ds_read_b64_tr_b16 a[244:245], v23 offset:1152
    ds_read_b64_tr_b16 a[246:247], v23 offset:1184
    s_waitcnt lgkmcnt(9)
    v_pk_mul_f32 v[224:225], v[224:225], v[56:57]
    v_pk_mul_f32 v[228:229], v[228:229], v[56:57]
    v_pk_mul_f32 v[232:233], v[232:233], v[56:57]
    v_pk_mul_f32 v[236:237], v[236:237], v[56:57]
    v_pk_mul_f32 v[226:227], v[226:227], v[58:59]
    v_pk_mul_f32 v[230:231], v[230:231], v[58:59]
    v_pk_mul_f32 v[234:235], v[234:235], v[58:59]
    v_pk_mul_f32 v[238:239], v[238:239], v[58:59]
    v_cvt_pk_bf16_f32 v224, v224, v228
    v_cvt_pk_bf16_f32 v225, v225, v229
    v_cvt_pk_bf16_f32 v226, v226, v230
    v_cvt_pk_bf16_f32 v227, v227, v231
    v_cvt_pk_bf16_f32 v232, v232, v236
    v_cvt_pk_bf16_f32 v233, v233, v237
    v_cvt_pk_bf16_f32 v234, v234, v238
    v_cvt_pk_bf16_f32 v235, v235, v239
    s_waitcnt lgkmcnt(2)
    buffer_store_dwordx4 a[240:243], v13, s[24:27], s49 offen sc0 sc1
    s_waitcnt lgkmcnt(0)
    buffer_store_dwordx4 a[244:247], v13, s[24:27], s6 offen sc0 sc1
    ds_write2_b32 v22, v224, v232 offset0:0 offset1:1
    ds_write2_b32 v22, v225, v233 offset0:36 offset1:37
    ds_write2_b32 v22, v226, v234 offset0:72 offset1:73
    ds_write2_b32 v22, v227, v235 offset0:108 offset1:109
    ds_read_b64_tr_b16 a[248:249], v23 offset:0
    ds_read_b64_tr_b16 a[250:251], v23 offset:32
    ds_read_b64_tr_b16 a[252:253], v23 offset:1152
    ds_read_b64_tr_b16 a[254:255], v23 offset:1184
    v_mfma_f32_16x16x32_bf16 v[144:147], v[80:83], a[160:163], v[144:147]
    ds_read_b64_tr_b16 a[172:173], v2 offset:16784
    v_max3_u32 v30, v30, v31, v32
    ds_read_b64_tr_b16 a[174:175], v3 offset:16784
    v_mfma_f32_16x16x32_bf16 v[144:147], v[96:99], a[164:167], v[144:147]
    ds_read_b64_tr_b16 a[176:177], v2 offset:33424
    v_max_u32 v30, v30, v33
    ds_read_b64_tr_b16 a[178:179], v3 offset:33424
    v_mfma_f32_16x16x32_bf16 v[144:147], v[112:115], a[168:171], v[144:147]
    s_waitcnt lgkmcnt(2)
    ds_read_b64_tr_b16 a[180:181], v2 offset:50064
    v_cmp_lt_u32 vcc, s52, v30
    ds_read_b64_tr_b16 a[182:183], v3 offset:50064
    v_mfma_f32_16x16x32_bf16 v[148:151], v[80:83], a[172:175], v[148:151]
    s_cbranch_vccnz L_fallback0
    ds_read_b64_tr_b16 a[184:185], v2 offset:16800
    ds_read_b64_tr_b16 a[186:187], v3 offset:16800
    s_waitcnt lgkmcnt(4)
    v_mfma_f32_16x16x32_bf16 v[148:151], v[96:99], a[176:179], v[148:151]
    s_waitcnt lgkmcnt(2)
    ds_read_b64_tr_b16 a[188:189], v2 offset:33440
    ds_read_b64_tr_b16 a[190:191], v3 offset:33440
    v_mfma_f32_16x16x32_bf16 v[148:151], v[112:115], a[180:183], v[148:151]
    s_waitcnt lgkmcnt(2)
    ds_read_b64_tr_b16 a[192:193], v2 offset:50080
    ds_read_b64_tr_b16 a[194:195], v3 offset:50080
    v_mfma_f32_16x16x32_bf16 v[152:155], v[80:83], a[184:187], v[152:155]
    s_waitcnt lgkmcnt(2)
    ds_read_b64_tr_b16 a[196:197], v2 offset:16816
    v_mul_f32 v144, v144, v44
    ds_read_b64_tr_b16 a[198:199], v3 offset:16816
    v_mfma_f32_16x16x32_bf16 v[152:155], v[96:99], a[188:191], v[152:155]
    buffer_store_dwordx4 a[248:251], v13, s[24:27], s50 offen sc0 sc1
    ds_read_b64_tr_b16 a[200:201], v2 offset:33456
    ds_read_b64_tr_b16 a[202:203], v3 offset:33456
    s_waitcnt lgkmcnt(4)
    v_mfma_f32_16x16x32_bf16 v[152:155], v[112:115], a[192:195], v[152:155]
    buffer_store_dwordx4 a[252:255], v13, s[24:27], s7 offen sc0 sc1
    ds_read_b64_tr_b16 a[204:205], v2 offset:50096
    ds_read_b64_tr_b16 a[206:207], v3 offset:50096
    s_waitcnt lgkmcnt(4)
    v_mfma_f32_16x16x32_bf16 v[156:159], v[80:83], a[196:199], v[156:159]
    s_waitcnt lgkmcnt(2)
    v_mul_f32 v145, v145, v45
    v_mul_f32 v146, v146, v46
    v_mfma_f32_16x16x32_bf16 v[156:159], v[96:99], a[200:203], v[156:159]
    s_waitcnt lgkmcnt(0)
    v_mul_f32 v147, v147, v47
    v_mul_f32 v148, v148, v44
    v_mfma_f32_16x16x32_bf16 v[156:159], v[112:115], a[204:207], v[156:159]
    v_mul_f32 v149, v149, v45
    v_mul_f32 v150, v150, v46
    v_mfma_f32_16x16x32_bf16 v[176:179], v[84:87], a[160:163], v[176:179]
    v_mul_f32 v151, v151, v47
    v_cvt_pk_bf16_f32 v144, v144, v148
    v_mfma_f32_16x16x32_bf16 v[176:179], v[100:103], a[164:167], v[176:179]
    v_cvt_pk_bf16_f32 v145, v145, v149
    v_cvt_pk_bf16_f32 v146, v146, v150
    v_mfma_f32_16x16x32_bf16 v[176:179], v[116:119], a[168:171], v[176:179]
    v_cvt_pk_bf16_f32 v147, v147, v151
    v_mul_f32 v152, v152, v44
    v_mfma_f32_16x16x32_bf16 v[180:183], v[84:87], a[172:175], v[180:183]
    v_mul_f32 v153, v153, v45
    v_mul_f32 v154, v154, v46
    v_mfma_f32_16x16x32_bf16 v[180:183], v[100:103], a[176:179], v[180:183]
    v_mul_f32 v155, v155, v47
    v_mul_f32 v156, v156, v44
    v_mfma_f32_16x16x32_bf16 v[180:183], v[116:119], a[180:183], v[180:183]
    v_mul_f32 v157, v157, v45
    v_mul_f32 v158, v158, v46
    v_mfma_f32_16x16x32_bf16 v[184:187], v[84:87], a[184:187], v[184:187]
    v_mul_f32 v159, v159, v47
    v_cvt_pk_bf16_f32 v152, v152, v156
    v_mfma_f32_16x16x32_bf16 v[184:187], v[100:103], a[188:191], v[184:187]
    v_cvt_pk_bf16_f32 v153, v153, v157
    v_cvt_pk_bf16_f32 v154, v154, v158
    v_mfma_f32_16x16x32_bf16 v[184:187], v[116:119], a[192:195], v[184:187]
    v_cvt_pk_bf16_f32 v155, v155, v159
    v_mul_f32 v176, v176, v48
    v_mfma_f32_16x16x32_bf16 v[188:191], v[84:87], a[196:199], v[188:191]
    v_mul_f32 v177, v177, v49
    v_mul_f32 v178, v178, v50
    v_mfma_f32_16x16x32_bf16 v[188:191], v[100:103], a[200:203], v[188:191]
    v_mul_f32 v179, v179, v51
    v_mul_f32 v180, v180, v48
    ds_write2_b32 v22, v144, v152 offset0:0 offset1:1
    ds_write2_b32 v22, v145, v153 offset0:36 offset1:37
    ds_write2_b32 v22, v146, v154 offset0:72 offset1:73
    ds_write2_b32 v22, v147, v155 offset0:108 offset1:109
    ds_read_b64_tr_b16 a[240:241], v23 offset:0
    ds_read_b64_tr_b16 a[242:243], v23 offset:32
    ds_read_b64_tr_b16 a[244:245], v23 offset:1152
    ds_read_b64_tr_b16 a[246:247], v23 offset:1184
    v_mfma_f32_16x16x32_bf16 v[188:191], v[116:119], a[204:207], v[188:191]
    v_mul_f32 v181, v181, v49
    v_mul_f32 v182, v182, v50
    v_mfma_f32_16x16x32_bf16 v[208:211], v[88:91], a[160:163], v[208:211]
    v_mul_f32 v183, v183, v51
    v_cvt_pk_bf16_f32 v176, v176, v180
    v_mfma_f32_16x16x32_bf16 v[208:211], v[104:107], a[164:167], v[208:211]
    v_cvt_pk_bf16_f32 v177, v177, v181
    v_cvt_pk_bf16_f32 v178, v178, v182
    v_mfma_f32_16x16x32_bf16 v[208:211], v[120:123], a[168:171], v[208:211]
    v_cvt_pk_bf16_f32 v179, v179, v183
    v_mul_f32 v184, v184, v48
    v_mfma_f32_16x16x32_bf16 v[212:215], v[88:91], a[172:175], v[212:215]
    v_mul_f32 v185, v185, v49
    v_mul_f32 v186, v186, v50
    v_mfma_f32_16x16x32_bf16 v[212:215], v[104:107], a[176:179], v[212:215]
    s_waitcnt lgkmcnt(2)
    buffer_store_dwordx4 a[240:243], v13, s[24:27], 0 offen offset:128 sc0 sc1
    v_mfma_f32_16x16x32_bf16 v[212:215], v[120:123], a[180:183], v[212:215]
    s_waitcnt lgkmcnt(0)
    buffer_store_dwordx4 a[244:247], v13, s[24:27], s4 offen offset:128 sc0 sc1
    v_mfma_f32_16x16x32_bf16 v[216:219], v[88:91], a[184:187], v[216:219]
    v_mul_f32 v187, v187, v51
    v_mul_f32 v188, v188, v48
    v_mfma_f32_16x16x32_bf16 v[216:219], v[104:107], a[188:191], v[216:219]
    v_mul_f32 v189, v189, v49
    v_mul_f32 v190, v190, v50
    v_mfma_f32_16x16x32_bf16 v[216:219], v[120:123], a[192:195], v[216:219]
    v_mul_f32 v191, v191, v51
    v_cvt_pk_bf16_f32 v184, v184, v188
    v_mfma_f32_16x16x32_bf16 v[220:223], v[88:91], a[196:199], v[220:223]
    v_cvt_pk_bf16_f32 v185, v185, v189
    v_cvt_pk_bf16_f32 v186, v186, v190
    v_mfma_f32_16x16x32_bf16 v[220:223], v[104:107], a[200:203], v[220:223]
    v_cvt_pk_bf16_f32 v187, v187, v191
    v_mul_f32 v208, v208, v52
    ds_write2_b32 v22, v176, v184 offset0:0 offset1:1
    ds_write2_b32 v22, v177, v185 offset0:36 offset1:37
    ds_write2_b32 v22, v178, v186 offset0:72 offset1:73
    ds_write2_b32 v22, v179, v187 offset0:108 offset1:109
    ds_read_b64_tr_b16 a[248:249], v23 offset:0
    ds_read_b64_tr_b16 a[250:251], v23 offset:32
    ds_read_b64_tr_b16 a[252:253], v23 offset:1152
    ds_read_b64_tr_b16 a[254:255], v23 offset:1184
    v_mfma_f32_16x16x32_bf16 v[220:223], v[120:123], a[204:207], v[220:223]
    v_mul_f32 v209, v209, v53
    v_mul_f32 v210, v210, v54
    v_mfma_f32_16x16x32_bf16 v[240:243], v[92:95], a[160:163], v[240:243]
    v_mul_f32 v211, v211, v55
    v_mul_f32 v212, v212, v52
    v_mfma_f32_16x16x32_bf16 v[240:243], v[108:111], a[164:167], v[240:243]
    v_mul_f32 v213, v213, v53
    v_mul_f32 v214, v214, v54
    v_mfma_f32_16x16x32_bf16 v[240:243], v[124:127], a[168:171], v[240:243]
    v_mul_f32 v215, v215, v55
    v_cvt_pk_bf16_f32 v208, v208, v212
    v_mfma_f32_16x16x32_bf16 v[244:247], v[92:95], a[172:175], v[244:247]
    v_cvt_pk_bf16_f32 v209, v209, v213
    v_cvt_pk_bf16_f32 v210, v210, v214
    v_mfma_f32_16x16x32_bf16 v[244:247], v[108:111], a[176:179], v[244:247]
    s_waitcnt lgkmcnt(2)
    buffer_store_dwordx4 a[248:251], v13, s[24:27], s48 offen offset:128 sc0 sc1
    v_mfma_f32_16x16x32_bf16 v[244:247], v[124:127], a[180:183], v[244:247]
    s_waitcnt lgkmcnt(0)
    buffer_store_dwordx4 a[252:255], v13, s[24:27], s5 offen offset:128 sc0 sc1
    v_mfma_f32_16x16x32_bf16 v[248:251], v[92:95], a[184:187], v[248:251]
    v_cvt_pk_bf16_f32 v211, v211, v215
    v_mul_f32 v216, v216, v52
    v_mfma_f32_16x16x32_bf16 v[248:251], v[108:111], a[188:191], v[248:251]
    v_mul_f32 v217, v217, v53
    v_mul_f32 v218, v218, v54
    v_mfma_f32_16x16x32_bf16 v[248:251], v[124:127], a[192:195], v[248:251]
    v_mul_f32 v219, v219, v55
    v_mul_f32 v220, v220, v52
    v_mfma_f32_16x16x32_bf16 v[252:255], v[92:95], a[196:199], v[252:255]
    v_mul_f32 v221, v221, v53
    v_mul_f32 v222, v222, v54
    v_mfma_f32_16x16x32_bf16 v[252:255], v[108:111], a[200:203], v[252:255]
    v_mul_f32 v223, v223, v55
    v_cvt_pk_bf16_f32 v216, v216, v220
    v_cvt_pk_bf16_f32 v217, v217, v221
    v_cvt_pk_bf16_f32 v218, v218, v222
    v_cvt_pk_bf16_f32 v219, v219, v223
    ds_write2_b32 v22, v208, v216 offset0:0 offset1:1
    ds_write2_b32 v22, v209, v217 offset0:36 offset1:37
    ds_write2_b32 v22, v210, v218 offset0:72 offset1:73
    ds_write2_b32 v22, v211, v219 offset0:108 offset1:109
    ds_read_b64_tr_b16 a[240:241], v23 offset:0
    ds_read_b64_tr_b16 a[242:243], v23 offset:32
    ds_read_b64_tr_b16 a[244:245], v23 offset:1152
    ds_read_b64_tr_b16 a[246:247], v23 offset:1184
    v_mfma_f32_16x16x32_bf16 v[252:255], v[124:127], a[204:207], v[252:255]
    v_pk_mul_f32 v[240:241], v[240:241], v[56:57]
    v_pk_mul_f32 v[244:245], v[244:245], v[56:57]
    v_pk_mul_f32 v[248:249], v[248:249], v[56:57]
    s_nop 4
    v_pk_mul_f32 v[252:253], v[252:253], v[56:57]
    v_pk_mul_f32 v[242:243], v[242:243], v[58:59]
    v_pk_mul_f32 v[246:247], v[246:247], v[58:59]
    v_pk_mul_f32 v[250:251], v[250:251], v[58:59]
    v_pk_mul_f32 v[254:255], v[254:255], v[58:59]
    v_cvt_pk_bf16_f32 v240, v240, v244
    v_cvt_pk_bf16_f32 v241, v241, v245
    v_cvt_pk_bf16_f32 v242, v242, v246
    v_cvt_pk_bf16_f32 v243, v243, v247
    v_cvt_pk_bf16_f32 v248, v248, v252
    v_cvt_pk_bf16_f32 v249, v249, v253
    v_cvt_pk_bf16_f32 v250, v250, v254
    v_cvt_pk_bf16_f32 v251, v251, v255
    s_waitcnt lgkmcnt(2)
    buffer_store_dwordx4 a[240:243], v13, s[24:27], s49 offen offset:128 sc0 sc1
    s_waitcnt lgkmcnt(0)
    buffer_store_dwordx4 a[244:247], v13, s[24:27], s6 offen offset:128 sc0 sc1
    ds_write2_b32 v22, v240, v248 offset0:0 offset1:1
    ds_write2_b32 v22, v241, v249 offset0:36 offset1:37
    ds_write2_b32 v22, v242, v250 offset0:72 offset1:73
    ds_write2_b32 v22, v243, v251 offset0:108 offset1:109
    ds_read_b64_tr_b16 a[248:249], v23 offset:0
    ds_read_b64_tr_b16 a[250:251], v23 offset:32
    ds_read_b64_tr_b16 a[252:253], v23 offset:1152
    ds_read_b64_tr_b16 a[254:255], v23 offset:1184
    s_waitcnt lgkmcnt(2)
    buffer_store_dwordx4 a[248:251], v13, s[24:27], s50 offen offset:128 sc0 sc1
    s_waitcnt lgkmcnt(0)
    buffer_store_dwordx4 a[252:255], v13, s[24:27], s7 offen offset:128 sc0 sc1
    s_endpgm
.p2alignl 12, 0xbf810000
.fill 770, 4, 0xbf810000
L_role1:
    s_lshr_b32 s54, s2, 3
    s_and_b32 s54, s54, 3
    s_lshl_b32 s54, s54, 2
    s_add_u32 s54, s54, s28
    s_mul_i32 s54, s54, 3072
    s_add_u32 s54, s54, 0xfb074000
    v_and_b32 v19, 63, v0
    v_min_u32 v19, 23, v19
    v_lshl_add_u32 v19, v19, 7, s54
    s_mov_b32 s31, 6
    s_mov_b64 vcc, -1
    s_cmp_eq_u32 s30, 0
    s_cbranch_scc1 L_pad1_0
    s_branch L_pad1_1
L_walked1:
    s_mov_b64 vcc, 0
    s_waitcnt vmcnt(9)
    buffer_load_dwordx4 v[160:163], v96, s[12:15], s48 offen
    buffer_load_dwordx4 v[164:167], v96, s[12:15], s48 offen offset:512
    v_lshlrev_b32 v104, 16, v112
    v_and_b32 v105, s39, v112
    v_lshlrev_b32 v106, 16, v113
    v_and_b32 v107, s39, v113
    v_lshlrev_b32 v108, 16, v114
    v_and_b32 v109, s39, v114
    v_lshlrev_b32 v110, 16, v115
    v_and_b32 v111, s39, v115
    v_pk_mul_f32 v[104:105], v[104:105], s[40:41]
    v_pk_mul_f32 v[106:107], v[106:107], s[40:41]
    v_pk_mul_f32 v[108:109], v[108:109], s[40:41]
    v_pk_mul_f32 v[110:111], v[110:111], s[40:41]
    v_cvt_pk_bf16_f32 v112, v104, v105
    v_cvt_pk_bf16_f32 v113, v106, v107
    v_cvt_pk_bf16_f32 v114, v108, v109
    v_cvt_pk_bf16_f32 v115, v110, v111
    ds_write_b128 v99, v[112:115] offset:0
    s_waitcnt vmcnt(10)
    buffer_load_dwordx4 v[168:171], v96, s[12:15], s48 offen offset:1024
    v_lshlrev_b32 v104, 16, v116
    v_and_b32 v105, s39, v116
    v_lshlrev_b32 v106, 16, v117
    v_and_b32 v107, s39, v117
    v_lshlrev_b32 v108, 16, v118
    v_and_b32 v109, s39, v118
    v_lshlrev_b32 v110, 16, v119
    v_and_b32 v111, s39, v119
    v_pk_mul_f32 v[104:105], v[104:105], s[40:41]
    v_pk_mul_f32 v[106:107], v[106:107], s[40:41]
    v_pk_mul_f32 v[108:109], v[108:109], s[40:41]
    v_pk_mul_f32 v[110:111], v[110:111], s[40:41]
    v_cvt_pk_bf16_f32 v116, v104, v105
    v_cvt_pk_bf16_f32 v117, v106, v107
    v_cvt_pk_bf16_f32 v118, v108, v109
    v_cvt_pk_bf16_f32 v119, v110, v111
    ds_write_b128 v99, v[116:119] offset:4160
    s_waitcnt vmcnt(10)
    buffer_load_dwordx4 v[172:175], v96, s[12:15], s48 offen offset:1536
    v_lshlrev_b32 v104, 16, v128
    v_and_b32 v105, s39, v128
    v_lshlrev_b32 v106, 16, v129
    v_and_b32 v107, s39, v129
    v_lshlrev_b32 v108, 16, v130
    v_and_b32 v109, s39, v130
    v_lshlrev_b32 v110, 16, v131
    v_and_b32 v111, s39, v131
    v_pk_mul_f32 v[104:105], v[104:105], s[40:41]
    v_pk_mul_f32 v[106:107], v[106:107], s[40:41]
    v_pk_mul_f32 v[108:109], v[108:109], s[40:41]
    v_pk_mul_f32 v[110:111], v[110:111], s[40:41]
    v_cvt_pk_bf16_f32 v128, v104, v105
    v_cvt_pk_bf16_f32 v129, v106, v107
    v_cvt_pk_bf16_f32 v130, v108, v109
    v_cvt_pk_bf16_f32 v131, v110, v111
    ds_write_b128 v97, v[128:131] offset:33280
    s_waitcnt vmcnt(10)
    s_add_u32 m0, s34, 16640
    s_nop 0
    buffer_load_dwordx4 v4, s[16:19], s32 offen lds
    v_lshlrev_b32 v104, 16, v132
    v_and_b32 v105, s39, v132
    v_lshlrev_b32 v106, 16, v133
    v_and_b32 v107, s39, v133
    v_lshlrev_b32 v108, 16, v134
    v_and_b32 v109, s39, v134
    v_lshlrev_b32 v110, 16, v135
    v_and_b32 v111, s39, v135
    v_pk_mul_f32 v[104:105], v[104:105], s[40:41]
    v_pk_mul_f32 v[106:107], v[106:107], s[40:41]
    v_pk_mul_f32 v[108:109], v[108:109], s[40:41]
    v_pk_mul_f32 v[110:111], v[110:111], s[40:41]
    v_cvt_pk_bf16_f32 v132, v104, v105
    v_cvt_pk_bf16_f32 v133, v106, v107
    v_cvt_pk_bf16_f32 v134, v108, v109
    v_cvt_pk_bf16_f32 v135, v110, v111
    ds_write_b128 v97, v[132:135] offset:35360
    s_waitcnt vmcnt(10)
    s_add_u32 m0, s34, 18208
    s_nop 0
    buffer_load_dwordx4 v4, s[16:19], s32 offen offset:512 lds
    v_lshlrev_b32 v104, 16, v136
    v_and_b32 v105, s39, v136
    v_lshlrev_b32 v106, 16, v137
    v_and_b32 v107, s39, v137
    v_lshlrev_b32 v108, 16, v138
    v_and_b32 v109, s39, v138
    v_lshlrev_b32 v110, 16, v139
    v_and_b32 v111, s39, v139
    v_pk_mul_f32 v[104:105], v[104:105], s[40:41]
    v_pk_mul_f32 v[106:107], v[106:107], s[40:41]
    v_pk_mul_f32 v[108:109], v[108:109], s[40:41]
    v_pk_mul_f32 v[110:111], v[110:111], s[40:41]
    v_cvt_pk_bf16_f32 v136, v104, v105
    v_cvt_pk_bf16_f32 v137, v106, v107
    v_cvt_pk_bf16_f32 v138, v108, v109
    v_cvt_pk_bf16_f32 v139, v110, v111
    ds_write_b128 v97, v[136:139] offset:37440
    s_waitcnt vmcnt(10)
    s_add_u32 m0, s34, 19776
    s_nop 0
    buffer_load_dwordx4 v4, s[16:19], s32 offen offset:1024 lds
    v_lshlrev_b32 v104, 16, v140
    v_and_b32 v105, s39, v140
    v_lshlrev_b32 v106, 16, v141
    v_and_b32 v107, s39, v141
    v_lshlrev_b32 v108, 16, v142
    v_and_b32 v109, s39, v142
    v_lshlrev_b32 v110, 16, v143
    v_and_b32 v111, s39, v143
    v_pk_mul_f32 v[104:105], v[104:105], s[40:41]
    v_pk_mul_f32 v[106:107], v[106:107], s[40:41]
    v_pk_mul_f32 v[108:109], v[108:109], s[40:41]
    v_pk_mul_f32 v[110:111], v[110:111], s[40:41]
    v_cvt_pk_bf16_f32 v140, v104, v105
    v_cvt_pk_bf16_f32 v141, v106, v107
    v_cvt_pk_bf16_f32 v142, v108, v109
    v_cvt_pk_bf16_f32 v143, v110, v111
    ds_write_b128 v97, v[140:143] offset:39520
    s_waitcnt vmcnt(7)
    s_add_u32 m0, s34, 21344
    s_nop 0
    buffer_load_dwordx4 v4, s[16:19], s32 offen offset:1536 lds
    s_add_u32 s32, s32, s49
    buffer_load_dwordx4 v[192:195], v96, s[12:15], s49 offen
    buffer_load_dwordx4 v[196:199], v96, s[12:15], s49 offen offset:512
    buffer_load_dwordx4 v[200:203], v96, s[12:15], s49 offen offset:1024
    s_waitcnt lgkmcnt(0)
    s_barrier
    ds_read_b128 a[192:195], v1 offset:0
    ds_read_b128 a[196:199], v1 offset:64
    ds_read_b128 a[200:203], v1 offset:128
    ds_read_b128 a[204:207], v1 offset:192
    ds_read_b128 a[208:211], v1 offset:256
    ds_read_b128 a[212:215], v1 offset:320
    ds_read_b128 a[216:219], v1 offset:384
    ds_read_b128 a[220:223], v1 offset:448
    ds_read_b128 a[224:227], v103 offset:0
    ds_read_b128 a[228:231], v103 offset:64
    ds_read_b128 a[232:235], v103 offset:128
    ds_read_b128 a[236:239], v103 offset:192
    ds_read_b128 a[240:243], v103 offset:256
    ds_read_b128 a[244:247], v103 offset:320
    ds_read_b128 a[248:251], v103 offset:384
    ds_read_b128 a[252:255], v103 offset:448
    ds_read_b128 a[0:3], v100 offset:33280
    ds_read_b128 a[4:7], v100 offset:33344
    ds_read_b128 a[8:11], v100 offset:33408
    ds_read_b128 a[12:15], v100 offset:33472
    ds_read_b128 a[16:19], v100 offset:33536
    ds_read_b128 a[20:23], v100 offset:33600
    ds_read_b128 a[24:27], v100 offset:33664
    ds_read_b128 a[28:31], v100 offset:33728
    s_waitcnt lgkmcnt(7)
    v_mfma_f32_16x16x32_bf16 v[120:123], a[192:195], a[0:3], 0
    s_waitcnt lgkmcnt(6)
    v_mfma_f32_16x16x32_bf16 v[120:123], a[196:199], a[4:7], v[120:123]
    s_waitcnt lgkmcnt(5)
    v_mfma_f32_16x16x32_bf16 v[120:123], a[200:203], a[8:11], v[120:123]
    s_waitcnt lgkmcnt(4)
    v_mfma_f32_16x16x32_bf16 v[120:123], a[204:207], a[12:15], v[120:123]
    s_waitcnt lgkmcnt(3)
    v_mfma_f32_16x16x32_bf16 v[120:123], a[208:211], a[16:19], v[120:123]
    s_waitcnt lgkmcnt(2)
    v_mfma_f32_16x16x32_bf16 v[120:123], a[212:215], a[20:23], v[120:123]
    s_waitcnt lgkmcnt(1)
    v_mfma_f32_16x16x32_bf16 v[120:123], a[216:219], a[24:27], v[120:123]
    s_waitcnt lgkmcnt(0)
    v_mfma_f32_16x16x32_bf16 v[120:123], a[220:223], a[28:31], v[120:123]
    v_mfma_f32_16x16x32_bf16 v[124:127], a[224:227], a[0:3], 0
    v_mfma_f32_16x16x32_bf16 v[124:127], a[228:231], a[4:7], v[124:127]
    v_mfma_f32_16x16x32_bf16 v[124:127], a[232:235], a[8:11], v[124:127]
    v_mfma_f32_16x16x32_bf16 v[124:127], a[236:239], a[12:15], v[124:127]
    v_mfma_f32_16x16x32_bf16 v[124:127], a[240:243], a[16:19], v[124:127]
    s_nop 2
    v_max3_f32 v20, v120, v121, v122
    v_max_f32 v20, v20, v123
    v_mfma_f32_16x16x32_bf16 v[124:127], a[244:247], a[20:23], v[124:127]
    v_mfma_f32_16x16x32_bf16 v[124:127], a[248:251], a[24:27], v[124:127]
    v_mfma_f32_16x16x32_bf16 v[124:127], a[252:255], a[28:31], v[124:127]
    s_waitcnt vmcnt(10)
    buffer_load_dwordx4 v[204:207], v96, s[12:15], s49 offen offset:1536
    s_nop 5
    v_max3_f32 v20, v20, v124, v125
    v_lshlrev_b32 v104, 16, v160
    v_max3_f32 v16, v20, v126, v127
    v_and_b32 v105, s39, v160
    v_max3_f32 v17, v20, v126, v127
    v_lshlrev_b32 v106, 16, v161
    s_nop 0
    v_permlane32_swap_b32 v16, v17
    v_and_b32 v107, s39, v161
    v_max_f32 v20, v16, v17
    v_lshlrev_b32 v108, 16, v162
    v_max_f32 v17, v16, v17
    v_and_b32 v109, s39, v162
    s_nop 0
    v_permlane16_swap_b32 v20, v17
    v_lshlrev_b32 v110, 16, v163
    v_max_f32 v16, v20, v17
    v_and_b32 v111, s39, v163
    v_add_f32 v16, 0x420c0000, v16
    v_pk_mul_f32 v[104:105], v[104:105], s[40:41]
    v_cndmask_b32 v24, -v16, v24, s[42:43]
    v_pk_mul_f32 v[106:107], v[106:107], s[40:41]
    v_add_f32 v120, v120, v24
    v_pk_mul_f32 v[108:109], v[108:109], s[40:41]
    v_add_f32 v121, v121, v24
    v_pk_mul_f32 v[110:111], v[110:111], s[40:41]
    v_add_f32 v122, v122, v24
    v_cvt_pk_bf16_f32 v160, v104, v105
    v_add_f32 v123, v123, v24
    v_cvt_pk_bf16_f32 v161, v106, v107
    v_add_f32 v124, v124, v24
    v_cvt_pk_bf16_f32 v162, v108, v109
    v_add_f32 v125, v125, v24
    v_cvt_pk_bf16_f32 v163, v110, v111
    v_add_f32 v126, v126, v24
    ds_write_b128 v97, v[160:163] offset:0
    v_add_f32 v127, v127, v24
    v_exp_f32 v120, v120
    v_exp_f32 v121, v121
    s_nop 0
    v_cvt_pk_bf16_f32 v64, v120, v121
    v_exp_f32 v122, v122
    v_exp_f32 v123, v123
    s_nop 0
    v_cvt_pk_bf16_f32 v65, v122, v123
    v_exp_f32 v124, v124
    v_exp_f32 v125, v125
    s_nop 0
    v_cvt_pk_bf16_f32 v66, v124, v125
    v_exp_f32 v126, v126
    v_exp_f32 v127, v127
    s_nop 0
    v_cvt_pk_bf16_f32 v67, v126, v127
    v_cndmask_b32 v25, -v16, v25, s[42:43]
    v_cndmask_b32 v26, -v16, v26, s[42:43]
    v_cndmask_b32 v27, -v16, v27, s[42:43]
    v_add_f32 v8, v120, v8
    v_add_f32 v8, v121, v8
    v_add_f32 v8, v122, v8
    v_add_f32 v8, v123, v8
    s_waitcnt vmcnt(10)
    s_add_u32 m0, s35, 0
    s_nop 0
    buffer_load_dwordx4 v5, s[20:23], s33 offen lds
    v_lshlrev_b32 v104, 16, v164
    v_and_b32 v105, s39, v164
    v_lshlrev_b32 v106, 16, v165
    v_and_b32 v107, s39, v165
    v_lshlrev_b32 v108, 16, v166
    v_and_b32 v109, s39, v166
    v_lshlrev_b32 v110, 16, v167
    v_and_b32 v111, s39, v167
    v_pk_mul_f32 v[104:105], v[104:105], s[40:41]
    v_pk_mul_f32 v[106:107], v[106:107], s[40:41]
    v_pk_mul_f32 v[108:109], v[108:109], s[40:41]
    v_pk_mul_f32 v[110:111], v[110:111], s[40:41]
    v_cvt_pk_bf16_f32 v164, v104, v105
    v_cvt_pk_bf16_f32 v165, v106, v107
    v_cvt_pk_bf16_f32 v166, v108, v109
    v_cvt_pk_bf16_f32 v167, v110, v111
    ds_write_b128 v97, v[164:167] offset:2080
    s_waitcnt vmcnt(10)
    s_add_u32 m0, s35, 1552
    s_nop 0
    buffer_load_dwordx4 v5, s[20:23], s33 offen offset:512 lds
    v_lshlrev_b32 v104, 16, v168
    v_and_b32 v105, s39, v168
    v_lshlrev_b32 v106, 16, v169
    v_and_b32 v107, s39, v169
    v_lshlrev_b32 v108, 16, v170
    v_and_b32 v109, s39, v170
    v_lshlrev_b32 v110, 16, v171
    v_and_b32 v111, s39, v171
    v_pk_mul_f32 v[104:105], v[104:105], s[40:41]
    v_pk_mul_f32 v[106:107], v[106:107], s[40:41]
    v_pk_mul_f32 v[108:109], v[108:109], s[40:41]
    v_pk_mul_f32 v[110:111], v[110:111], s[40:41]
    v_cvt_pk_bf16_f32 v168, v104, v105
    v_cvt_pk_bf16_f32 v169, v106, v107
    v_cvt_pk_bf16_f32 v170, v108, v109
    v_cvt_pk_bf16_f32 v171, v110, v111
    ds_write_b128 v97, v[168:171] offset:4160
    s_waitcnt vmcnt(10)
    s_add_u32 m0, s35, 3104
    s_nop 0
    buffer_load_dwordx4 v5, s[20:23], s33 offen offset:1024 lds
    v_lshlrev_b32 v104, 16, v172
    v_and_b32 v105, s39, v172
    v_lshlrev_b32 v106, 16, v173
    v_and_b32 v107, s39, v173
    v_lshlrev_b32 v108, 16, v174
    v_and_b32 v109, s39, v174
    v_lshlrev_b32 v110, 16, v175
    v_and_b32 v111, s39, v175
    v_pk_mul_f32 v[104:105], v[104:105], s[40:41]
    v_pk_mul_f32 v[106:107], v[106:107], s[40:41]
    v_pk_mul_f32 v[108:109], v[108:109], s[40:41]
    v_pk_mul_f32 v[110:111], v[110:111], s[40:41]
    v_cvt_pk_bf16_f32 v172, v104, v105
    v_cvt_pk_bf16_f32 v173, v106, v107
    v_cvt_pk_bf16_f32 v174, v108, v109
    v_cvt_pk_bf16_f32 v175, v110, v111
    ds_write_b128 v97, v[172:175] offset:6240
    s_waitcnt lgkmcnt(0)
    s_barrier
    ds_read_b128 a[32:35], v100 offset:0
    ds_read_b128 a[36:39], v100 offset:64
    ds_read_b128 a[40:43], v100 offset:128
    ds_read_b128 a[44:47], v100 offset:192
    ds_read_b128 a[48:51], v100 offset:256
    ds_read_b128 a[52:55], v100 offset:320
    ds_read_b128 a[56:59], v100 offset:384
    ds_read_b128 a[60:63], v100 offset:448
    s_waitcnt lgkmcnt(7)
    v_mfma_f32_16x16x32_bf16 v[120:123], a[192:195], a[32:35], 0
    s_waitcnt lgkmcnt(6)
    v_mfma_f32_16x16x32_bf16 v[120:123], a[196:199], a[36:39], v[120:123]
    s_waitcnt lgkmcnt(5)
    v_mfma_f32_16x16x32_bf16 v[120:123], a[200:203], a[40:43], v[120:123]
    s_waitcnt lgkmcnt(4)
    v_mfma_f32_16x16x32_bf16 v[120:123], a[204:207], a[44:47], v[120:123]
    s_waitcnt lgkmcnt(3)
    v_mfma_f32_16x16x32_bf16 v[120:123], a[208:211], a[48:51], v[120:123]
    s_waitcnt lgkmcnt(2)
    v_mfma_f32_16x16x32_bf16 v[120:123], a[212:215], a[52:55], v[120:123]
    s_waitcnt lgkmcnt(1)
    v_mfma_f32_16x16x32_bf16 v[120:123], a[216:219], a[56:59], v[120:123]
    s_waitcnt lgkmcnt(0)
    v_mfma_f32_16x16x32_bf16 v[120:123], a[220:223], a[60:63], v[120:123]
    v_mfma_f32_16x16x32_bf16 v[124:127], a[224:227], a[32:35], 0
    v_mfma_f32_16x16x32_bf16 v[124:127], a[228:231], a[36:39], v[124:127]
    v_mfma_f32_16x16x32_bf16 v[124:127], a[232:235], a[40:43], v[124:127]
    v_mfma_f32_16x16x32_bf16 v[124:127], a[236:239], a[44:47], v[124:127]
    v_mfma_f32_16x16x32_bf16 v[124:127], a[240:243], a[48:51], v[124:127]
    s_nop 2
    v_max3_f32 v20, v120, v121, v122
    v_max_f32 v20, v20, v123
    v_mfma_f32_16x16x32_bf16 v[124:127], a[244:247], a[52:55], v[124:127]
    v_mfma_f32_16x16x32_bf16 v[124:127], a[248:251], a[56:59], v[124:127]
    v_mfma_f32_16x16x32_bf16 v[124:127], a[252:255], a[60:63], v[124:127]
    s_waitcnt vmcnt(6)
    s_add_u32 m0, s35, 4656
    s_nop 0
    buffer_load_dwordx4 v5, s[20:23], s33 offen offset:1536 lds
    s_add_u32 s33, s33, s49
    buffer_load_dwordx4 v[224:227], v96, s[12:15], s50 offen
    buffer_load_dwordx4 v[228:231], v96, s[12:15], s50 offen offset:512
    buffer_load_dwordx4 v[232:235], v96, s[12:15], s50 offen offset:1024
    buffer_load_dwordx4 v[236:239], v96, s[12:15], s50 offen offset:1536
    v_max3_f32 v20, v20, v124, v125
    v_lshlrev_b32 v104, 16, v192
    v_max3_f32 v16, v20, v126, v127
    v_and_b32 v105, s39, v192
    v_max3_f32 v17, v20, v126, v127
    v_lshlrev_b32 v106, 16, v193
    s_nop 0
    v_permlane32_swap_b32 v16, v17
    v_and_b32 v107, s39, v193
    v_max_f32 v20, v16, v17
    v_lshlrev_b32 v108, 16, v194
    v_max_f32 v17, v16, v17
    v_and_b32 v109, s39, v194
    s_nop 0
    v_permlane16_swap_b32 v20, v17
    v_lshlrev_b32 v110, 16, v195
    v_max_f32 v16, v20, v17
    v_and_b32 v111, s39, v195
    v_add_f32 v16, 0x420c0000, v16
    v_pk_mul_f32 v[104:105], v[104:105], s[40:41]
    v_cndmask_b32 v28, -v16, v28, s[42:43]
    v_pk_mul_f32 v[106:107], v[106:107], s[40:41]
    v_add_f32 v120, v120, v28
    v_pk_mul_f32 v[108:109], v[108:109], s[40:41]
    v_add_f32 v121, v121, v28
    v_pk_mul_f32 v[110:111], v[110:111], s[40:41]
    v_add_f32 v122, v122, v28
    v_cvt_pk_bf16_f32 v192, v104, v105
    v_add_f32 v123, v123, v28
    v_cvt_pk_bf16_f32 v193, v106, v107
    v_add_f32 v124, v124, v28
    v_cvt_pk_bf16_f32 v194, v108, v109
    v_add_f32 v125, v125, v28
    v_cvt_pk_bf16_f32 v195, v110, v111
    v_add_f32 v126, v126, v28
    ds_write_b128 v97, v[192:195] offset:49920
    v_add_f32 v127, v127, v28
    v_exp_f32 v120, v120
    v_exp_f32 v121, v121
    s_nop 0
    v_cvt_pk_bf16_f32 v68, v120, v121
    v_exp_f32 v122, v122
    v_exp_f32 v123, v123
    s_nop 0
    v_cvt_pk_bf16_f32 v69, v122, v123
    v_exp_f32 v124, v124
    v_exp_f32 v125, v125
    s_nop 0
    v_cvt_pk_bf16_f32 v70, v124, v125
    v_exp_f32 v126, v126
    v_exp_f32 v127, v127
    s_nop 0
    v_cvt_pk_bf16_f32 v71, v126, v127
    v_cndmask_b32 v29, -v16, v29, s[42:43]
    v_cndmask_b32 v30, -v16, v30, s[42:43]
    v_cndmask_b32 v31, -v16, v31, s[42:43]
    v_add_f32 v9, v120, v9
    v_add_f32 v9, v121, v9
    v_add_f32 v9, v122, v9
    v_add_f32 v9, v123, v9
    s_waitcnt vmcnt(10)
    s_add_u32 m0, s34, 33280
    s_nop 0
    buffer_load_dwordx4 v4, s[16:19], s32 offen lds
    v_lshlrev_b32 v104, 16, v196
    v_and_b32 v105, s39, v196
    v_lshlrev_b32 v106, 16, v197
    v_and_b32 v107, s39, v197
    v_lshlrev_b32 v108, 16, v198
    v_and_b32 v109, s39, v198
    v_lshlrev_b32 v110, 16, v199
    v_and_b32 v111, s39, v199
    v_pk_mul_f32 v[104:105], v[104:105], s[40:41]
    v_pk_mul_f32 v[106:107], v[106:107], s[40:41]
    v_pk_mul_f32 v[108:109], v[108:109], s[40:41]
    v_pk_mul_f32 v[110:111], v[110:111], s[40:41]
    v_cvt_pk_bf16_f32 v196, v104, v105
    v_cvt_pk_bf16_f32 v197, v106, v107
    v_cvt_pk_bf16_f32 v198, v108, v109
    v_cvt_pk_bf16_f32 v199, v110, v111
    ds_write_b128 v97, v[196:199] offset:52000
    s_waitcnt vmcnt(10)
    s_add_u32 m0, s34, 34848
    s_nop 0
    buffer_load_dwordx4 v4, s[16:19], s32 offen offset:512 lds
    v_lshlrev_b32 v104, 16, v200
    v_and_b32 v105, s39, v200
    v_lshlrev_b32 v106, 16, v201
    v_and_b32 v107, s39, v201
    v_lshlrev_b32 v108, 16, v202
    v_and_b32 v109, s39, v202
    v_lshlrev_b32 v110, 16, v203
    v_and_b32 v111, s39, v203
    v_pk_mul_f32 v[104:105], v[104:105], s[40:41]
    v_pk_mul_f32 v[106:107], v[106:107], s[40:41]
    v_pk_mul_f32 v[108:109], v[108:109], s[40:41]
    v_pk_mul_f32 v[110:111], v[110:111], s[40:41]
    v_cvt_pk_bf16_f32 v200, v104, v105
    v_cvt_pk_bf16_f32 v201, v106, v107
    v_cvt_pk_bf16_f32 v202, v108, v109
    v_cvt_pk_bf16_f32 v203, v110, v111
    ds_write_b128 v97, v[200:203] offset:54080
    s_waitcnt vmcnt(10)
    s_add_u32 m0, s34, 36416
    s_nop 0
    buffer_load_dwordx4 v4, s[16:19], s32 offen offset:1024 lds
    v_lshlrev_b32 v104, 16, v204
    v_and_b32 v105, s39, v204
    v_lshlrev_b32 v106, 16, v205
    v_and_b32 v107, s39, v205
    v_lshlrev_b32 v108, 16, v206
    v_and_b32 v109, s39, v206
    v_lshlrev_b32 v110, 16, v207
    v_and_b32 v111, s39, v207
    v_pk_mul_f32 v[104:105], v[104:105], s[40:41]
    v_pk_mul_f32 v[106:107], v[106:107], s[40:41]
    v_pk_mul_f32 v[108:109], v[108:109], s[40:41]
    v_pk_mul_f32 v[110:111], v[110:111], s[40:41]
    v_cvt_pk_bf16_f32 v204, v104, v105
    v_cvt_pk_bf16_f32 v205, v106, v107
    v_cvt_pk_bf16_f32 v206, v108, v109
    v_cvt_pk_bf16_f32 v207, v110, v111
    ds_write_b128 v97, v[204:207] offset:56160
    s_waitcnt lgkmcnt(0)
    s_barrier
    ds_read_b128 a[160:163], v1 offset:16640
    ds_read_b128 a[164:167], v1 offset:16704
    ds_read_b128 a[168:171], v1 offset:16768
    ds_read_b128 a[172:175], v1 offset:16832
    ds_read_b128 a[176:179], v1 offset:16896
    ds_read_b128 a[180:183], v1 offset:16960
    ds_read_b128 a[184:187], v1 offset:17024
    ds_read_b128 a[188:191], v1 offset:17088
    ds_read_b128 a[64:67], v100 offset:49920
    ds_read_b128 a[68:71], v100 offset:49984
    ds_read_b128 a[72:75], v100 offset:50048
    ds_read_b128 a[76:79], v100 offset:50112
    ds_read_b128 a[80:83], v100 offset:50176
    ds_read_b128 a[84:87], v100 offset:50240
    ds_read_b128 a[88:91], v100 offset:50304
    ds_read_b128 a[92:95], v100 offset:50368
    s_waitcnt lgkmcnt(14)
    v_mfma_f32_16x16x32_bf16 v[44:47], a[160:163], a[0:3], v[24:27]
    s_waitcnt lgkmcnt(7)
    v_mfma_f32_16x16x32_bf16 v[44:47], a[164:167], a[4:7], v[44:47]
    v_mfma_f32_16x16x32_bf16 v[44:47], a[168:171], a[8:11], v[44:47]
    v_mfma_f32_16x16x32_bf16 v[44:47], a[172:175], a[12:15], v[44:47]
    v_mfma_f32_16x16x32_bf16 v[44:47], a[176:179], a[16:19], v[44:47]
    v_mfma_f32_16x16x32_bf16 v[44:47], a[180:183], a[20:23], v[44:47]
    v_mfma_f32_16x16x32_bf16 v[44:47], a[184:187], a[24:27], v[44:47]
    v_mfma_f32_16x16x32_bf16 v[44:47], a[188:191], a[28:31], v[44:47]
    v_mfma_f32_16x16x32_bf16 v[120:123], a[192:195], a[64:67], 0
    s_waitcnt lgkmcnt(0)
    v_mfma_f32_16x16x32_bf16 v[120:123], a[196:199], a[68:71], v[120:123]
    v_mfma_f32_16x16x32_bf16 v[120:123], a[200:203], a[72:75], v[120:123]
    v_mfma_f32_16x16x32_bf16 v[120:123], a[204:207], a[76:79], v[120:123]
    s_nop 2
    v_exp_f32 v44, v44
    v_mfma_f32_16x16x32_bf16 v[120:123], a[208:211], a[80:83], v[120:123]
    v_exp_f32 v45, v45
    v_mfma_f32_16x16x32_bf16 v[120:123], a[212:215], a[84:87], v[120:123]
    v_exp_f32 v46, v46
    v_mfma_f32_16x16x32_bf16 v[120:123], a[216:219], a[88:91], v[120:123]
    v_exp_f32 v47, v47
    v_mfma_f32_16x16x32_bf16 v[120:123], a[220:223], a[92:95], v[120:123]
    s_mov_b32 m0, s36
    v_cvt_pk_bf16_f32 v80, v44, v45
    v_cvt_pk_bf16_f32 v81, v46, v47
    v_mfma_f32_16x16x32_bf16 v[124:127], a[224:227], a[64:67], 0
    ds_write_addtid_b32 v80 offset:10240
    v_add_f32 v8, v44, v8
    v_mfma_f32_16x16x32_bf16 v[124:127], a[228:231], a[68:71], v[124:127]
    ds_write_addtid_b32 v81 offset:10496
    v_add_f32 v8, v45, v8
    v_mfma_f32_16x16x32_bf16 v[124:127], a[232:235], a[72:75], v[124:127]
    v_add_f32 v8, v46, v8
    v_add_f32 v8, v47, v8
    v_mfma_f32_16x16x32_bf16 v[124:127], a[236:239], a[76:79], v[124:127]
    v_mfma_f32_16x16x32_bf16 v[124:127], a[240:243], a[80:83], v[124:127]
    v_max3_f32 v20, v120, v121, v122
    v_max_f32 v20, v20, v123
    v_mfma_f32_16x16x32_bf16 v[124:127], a[244:247], a[84:87], v[124:127]
    v_mfma_f32_16x16x32_bf16 v[124:127], a[248:251], a[88:91], v[124:127]
    v_mfma_f32_16x16x32_bf16 v[124:127], a[252:255], a[92:95], v[124:127]
    v_mfma_f32_16x16x32_bf16 v[48:51], a[160:163], a[32:35], v[28:31]
    v_mfma_f32_16x16x32_bf16 v[48:51], a[164:167], a[36:39], v[48:51]
    v_mfma_f32_16x16x32_bf16 v[48:51], a[168:171], a[40:43], v[48:51]
    v_mfma_f32_16x16x32_bf16 v[48:51], a[172:175], a[44:47], v[48:51]
    v_mfma_f32_16x16x32_bf16 v[48:51], a[176:179], a[48:51], v[48:51]
    s_nop 2
    v_max3_f32 v20, v20, v124, v125
    v_max3_f32 v16, v20, v126, v127
    v_mfma_f32_16x16x32_bf16 v[48:51], a[180:183], a[52:55], v[48:51]
    v_max3_f32 v17, v20, v126, v127
    v_mfma_f32_16x16x32_bf16 v[48:51], a[184:187], a[56:59], v[48:51]
    s_nop 0
    v_permlane32_swap_b32 v16, v17
    v_max_f32 v20, v16, v17
    v_mfma_f32_16x16x32_bf16 v[48:51], a[188:191], a[60:63], v[48:51]
    v_max_f32 v17, v16, v17
    s_waitcnt vmcnt(6)
    s_add_u32 m0, s34, 37984
    s_nop 0
    buffer_load_dwordx4 v4, s[16:19], s32 offen offset:1536 lds
    s_add_u32 s32, s32, s49
    s_add_u32 m0, s35, 16640
    s_nop 0
    buffer_load_dwordx4 v5, s[20:23], s33 offen lds
    s_add_u32 m0, s35, 18192
    s_nop 0
    buffer_load_dwordx4 v5, s[20:23], s33 offen offset:512 lds
    s_add_u32 m0, s35, 19744
    s_nop 0
    buffer_load_dwordx4 v5, s[20:23], s33 offen offset:1024 lds
    s_add_u32 m0, s35, 21296
    s_nop 0
    buffer_load_dwordx4 v5, s[20:23], s33 offen offset:1536 lds
    s_add_u32 s33, s33, s49
    v_permlane16_swap_b32 v20, v17
    v_lshlrev_b32 v104, 16, v224
    v_max_f32 v16, v20, v17
    v_and_b32 v105, s39, v224
    v_add_f32 v16, 0x420c0000, v16
    v_lshlrev_b32 v106, 16, v225
    v_cndmask_b32 v32, -v16, v32, s[42:43]
    v_and_b32 v107, s39, v225
    v_add_f32 v120, v120, v32
    v_lshlrev_b32 v108, 16, v226
    v_add_f32 v121, v121, v32
    v_and_b32 v109, s39, v226
    v_add_f32 v122, v122, v32
    v_lshlrev_b32 v110, 16, v227
    v_add_f32 v123, v123, v32
    v_and_b32 v111, s39, v227
    v_add_f32 v124, v124, v32
    v_pk_mul_f32 v[104:105], v[104:105], s[40:41]
    v_add_f32 v125, v125, v32
    v_pk_mul_f32 v[106:107], v[106:107], s[40:41]
    v_add_f32 v126, v126, v32
    v_pk_mul_f32 v[108:109], v[108:109], s[40:41]
    v_add_f32 v127, v127, v32
    v_pk_mul_f32 v[110:111], v[110:111], s[40:41]
    v_exp_f32 v120, v120
    v_cvt_pk_bf16_f32 v224, v104, v105
    v_exp_f32 v121, v121
    v_cvt_pk_bf16_f32 v225, v106, v107
    v_cvt_pk_bf16_f32 v72, v120, v121
    v_cvt_pk_bf16_f32 v226, v108, v109
    v_exp_f32 v122, v122
    v_cvt_pk_bf16_f32 v227, v110, v111
    v_exp_f32 v123, v123
    ds_write_b128 v98, v[224:227] offset:0
    v_cvt_pk_bf16_f32 v73, v122, v123
    v_exp_f32 v124, v124
    v_exp_f32 v125, v125
    s_nop 0
    v_cvt_pk_bf16_f32 v74, v124, v125
    v_exp_f32 v126, v126
    v_exp_f32 v127, v127
    s_nop 0
    v_cvt_pk_bf16_f32 v75, v126, v127
    v_exp_f32 v48, v48
    v_exp_f32 v49, v49
    v_exp_f32 v50, v50
    v_exp_f32 v51, v51
    v_cvt_pk_bf16_f32 v84, v48, v49
    v_cvt_pk_bf16_f32 v85, v50, v51
    s_mov_b32 m0, s36
    s_nop 0
    ds_write_addtid_b32 v84 offset:10752
    ds_write_addtid_b32 v85 offset:11008
    v_add_f32 v9, v48, v9
    v_add_f32 v9, v49, v9
    v_add_f32 v9, v50, v9
    v_add_f32 v9, v51, v9
    v_cndmask_b32 v33, -v16, v33, s[42:43]
    v_cndmask_b32 v34, -v16, v34, s[42:43]
    v_cndmask_b32 v35, -v16, v35, s[42:43]
    v_add_f32 v10, v120, v10
    v_add_f32 v10, v121, v10
    v_add_f32 v10, v122, v10
    v_add_f32 v10, v123, v10
    s_waitcnt vmcnt(10)
    s_add_u32 m0, s34, 49920
    s_nop 0
    buffer_load_dwordx4 v4, s[16:19], s32 offen lds
    v_lshlrev_b32 v104, 16, v228
    v_and_b32 v105, s39, v228
    v_lshlrev_b32 v106, 16, v229
    v_and_b32 v107, s39, v229
    v_lshlrev_b32 v108, 16, v230
    v_and_b32 v109, s39, v230
    v_lshlrev_b32 v110, 16, v231
    v_and_b32 v111, s39, v231
    v_pk_mul_f32 v[104:105], v[104:105], s[40:41]
    v_pk_mul_f32 v[106:107], v[106:107], s[40:41]
    v_pk_mul_f32 v[108:109], v[108:109], s[40:41]
    v_pk_mul_f32 v[110:111], v[110:111], s[40:41]
    v_cvt_pk_bf16_f32 v228, v104, v105
    v_cvt_pk_bf16_f32 v229, v106, v107
    v_cvt_pk_bf16_f32 v230, v108, v109
    v_cvt_pk_bf16_f32 v231, v110, v111
    ds_write_b128 v98, v[228:231] offset:2080
    s_waitcnt vmcnt(10)
    s_add_u32 m0, s34, 51488
    s_nop 0
    buffer_load_dwordx4 v4, s[16:19], s32 offen offset:512 lds
    v_lshlrev_b32 v104, 16, v232
    v_and_b32 v105, s39, v232
    v_lshlrev_b32 v106, 16, v233
    v_and_b32 v107, s39, v233
    v_lshlrev_b32 v108, 16, v234
    v_and_b32 v109, s39, v234
    v_lshlrev_b32 v110, 16, v235
    v_and_b32 v111, s39, v235
    v_pk_mul_f32 v[104:105], v[104:105], s[40:41]
    v_pk_mul_f32 v[106:107], v[106:107], s[40:41]
    v_pk_mul_f32 v[108:109], v[108:109], s[40:41]
    v_pk_mul_f32 v[110:111], v[110:111], s[40:41]
    v_cvt_pk_bf16_f32 v232, v104, v105
    v_cvt_pk_bf16_f32 v233, v106, v107
    v_cvt_pk_bf16_f32 v234, v108, v109
    v_cvt_pk_bf16_f32 v235, v110, v111
    ds_write_b128 v98, v[232:235] offset:4160
    s_waitcnt vmcnt(10)
    v_lshlrev_b32 v104, 16, v236
    v_and_b32 v105, s39, v236
    v_lshlrev_b32 v106, 16, v237
    v_and_b32 v107, s39, v237
    v_lshlrev_b32 v108, 16, v238
    v_and_b32 v109, s39, v238
    v_lshlrev_b32 v110, 16, v239
    v_and_b32 v111, s39, v239
    v_pk_mul_f32 v[104:105], v[104:105], s[40:41]
    v_pk_mul_f32 v[106:107], v[106:107], s[40:41]
    v_pk_mul_f32 v[108:109], v[108:109], s[40:41]
    v_pk_mul_f32 v[110:111], v[110:111], s[40:41]
    v_cvt_pk_bf16_f32 v236, v104, v105
    v_cvt_pk_bf16_f32 v237, v106, v107
    v_cvt_pk_bf16_f32 v238, v108, v109
    v_cvt_pk_bf16_f32 v239, v110, v111
    ds_write_b128 v98, v[236:239] offset:6240
    s_waitcnt lgkmcnt(0)
    s_barrier
    ds_read_b128 a[96:99], v101 offset:0
    ds_read_b128 a[100:103], v101 offset:64
    ds_read_b128 a[104:107], v101 offset:128
    ds_read_b128 a[108:111], v101 offset:192
    ds_read_b128 a[112:115], v101 offset:256
    ds_read_b128 a[116:119], v101 offset:320
    ds_read_b128 a[120:123], v101 offset:384
    ds_read_b128 a[124:127], v101 offset:448
    v_mfma_f32_16x16x32_bf16 v[52:55], a[160:163], a[64:67], v[32:35]
    s_add_u32 m0, s34, 53056
    v_mfma_f32_16x16x32_bf16 v[52:55], a[164:167], a[68:71], v[52:55]
    buffer_load_dwordx4 v4, s[16:19], s32 offen offset:1024 lds
    v_mfma_f32_16x16x32_bf16 v[52:55], a[168:171], a[72:75], v[52:55]
    s_waitcnt lgkmcnt(5)
    v_mfma_f32_16x16x32_bf16 v[52:55], a[172:175], a[76:79], v[52:55]
    s_add_u32 m0, s34, 54624
    v_mfma_f32_16x16x32_bf16 v[52:55], a[176:179], a[80:83], v[52:55]
    buffer_load_dwordx4 v4, s[16:19], s32 offen offset:1536 lds
    v_mfma_f32_16x16x32_bf16 v[52:55], a[180:183], a[84:87], v[52:55]
    s_add_u32 s32, s32, s49
    v_mfma_f32_16x16x32_bf16 v[52:55], a[184:187], a[88:91], v[52:55]
    s_add_u32 m0, s35, 33280
    v_mfma_f32_16x16x32_bf16 v[52:55], a[188:191], a[92:95], v[52:55]
    buffer_load_dwordx4 v5, s[20:23], s33 offen lds
    v_mfma_f32_16x16x32_bf16 v[120:123], a[192:195], a[96:99], 0
    s_waitcnt lgkmcnt(0)
    ds_read_b64_tr_b16 a[192:193], v2 offset:128
    v_mfma_f32_16x16x32_bf16 v[120:123], a[196:199], a[100:103], v[120:123]
    s_add_u32 m0, s35, 34832
    ds_read_b64_tr_b16 a[196:197], v2 offset:0
    v_mfma_f32_16x16x32_bf16 v[120:123], a[200:203], a[104:107], v[120:123]
    buffer_load_dwordx4 v5, s[20:23], s33 offen offset:512 lds
    v_mfma_f32_16x16x32_bf16 v[120:123], a[204:207], a[108:111], v[120:123]
    v_exp_f32 v52, v52
    v_mfma_f32_16x16x32_bf16 v[120:123], a[208:211], a[112:115], v[120:123]
    s_add_u32 m0, s35, 36384
    v_exp_f32 v53, v53
    v_mfma_f32_16x16x32_bf16 v[120:123], a[212:215], a[116:119], v[120:123]
    buffer_load_dwordx4 v5, s[20:23], s33 offen offset:1024 lds
    v_mfma_f32_16x16x32_bf16 v[120:123], a[216:219], a[120:123], v[120:123]
    ds_read_b64_tr_b16 a[198:199], v3 offset:0
    v_cvt_pk_bf16_f32 v88, v52, v53
    v_mfma_f32_16x16x32_bf16 v[120:123], a[220:223], a[124:127], v[120:123]
    s_add_u32 m0, s35, 37936
    ds_read_b64_tr_b16 a[204:205], v2 offset:16
    v_add_f32 v10, v52, v10
    v_mfma_f32_16x16x32_bf16 v[124:127], a[224:227], a[96:99], 0
    buffer_load_dwordx4 v5, s[20:23], s33 offen offset:1536 lds
    v_mfma_f32_16x16x32_bf16 v[124:127], a[228:231], a[100:103], v[124:127]
    s_add_u32 s33, s33, s49
    v_exp_f32 v54, v54
    v_mfma_f32_16x16x32_bf16 v[124:127], a[232:235], a[104:107], v[124:127]
    s_add_u32 m0, s34, 0
    ds_read_b64_tr_b16 a[206:207], v3 offset:16
    v_add_f32 v10, v53, v10
    v_mfma_f32_16x16x32_bf16 v[124:127], a[236:239], a[108:111], v[124:127]
    buffer_load_dwordx4 v4, s[16:19], s32 offen lds
    v_mfma_f32_16x16x32_bf16 v[124:127], a[240:243], a[112:115], v[124:127]
    v_max3_f32 v20, v120, v121, v122
    v_max_f32 v20, v20, v123
    v_mfma_f32_16x16x32_bf16 v[124:127], a[244:247], a[116:119], v[124:127]
    s_add_u32 m0, s34, 1568
    ds_read_b64_tr_b16 a[212:213], v2 offset:32
    v_add_f32 v10, v54, v10
    v_mfma_f32_16x16x32_bf16 v[124:127], a[248:251], a[120:123], v[124:127]
    buffer_load_dwordx4 v4, s[16:19], s32 offen offset:512 lds
    v_mfma_f32_16x16x32_bf16 v[124:127], a[252:255], a[124:127], v[124:127]
    v_exp_f32 v55, v55
    v_mfma_f32_16x16x32_bf16 v[56:59], a[160:163], a[96:99], 0
    ds_read_b64_tr_b16 a[214:215], v3 offset:32
    v_cvt_pk_bf16_f32 v89, v54, v55
    v_mfma_f32_16x16x32_bf16 v[56:59], a[164:167], a[100:103], v[56:59]
    s_waitcnt vmcnt(14)
    ds_read_b64_tr_b16 a[220:221], v2 offset:48
    v_add_f32 v10, v55, v10
    v_mfma_f32_16x16x32_bf16 v[56:59], a[168:171], a[104:107], v[56:59]
    s_barrier
    ds_read_b64_tr_b16 a[222:223], v3 offset:48
    v_mfma_f32_16x16x32_bf16 v[56:59], a[172:175], a[108:111], v[56:59]
    ds_read2st64_b32 a[224:225], v7 offset0:8 offset1:9
    v_mfma_f32_16x16x32_bf16 v[56:59], a[176:179], a[112:115], v[56:59]
    v_max3_f32 v20, v20, v124, v125
    v_max3_f32 v16, v20, v126, v127
    v_mfma_f32_16x16x32_bf16 v[56:59], a[180:183], a[116:119], v[56:59]
    ds_read2st64_b32 a[226:227], v6 offset0:8 offset1:9
    v_max3_f32 v17, v20, v126, v127
    v_mfma_f32_16x16x32_bf16 v[56:59], a[184:187], a[120:123], v[56:59]
    s_nop 0
    v_permlane32_swap_b32 v16, v17
    v_max_f32 v20, v16, v17
    v_mfma_f32_16x16x32_bf16 v[56:59], a[188:191], a[124:127], v[56:59]
    s_waitcnt lgkmcnt(5)
    ds_read_b128 a[160:163], v1 offset:33280
    v_max_f32 v17, v16, v17
    v_mfma_f32_16x16x32_bf16 v[128:131], v[64:67], a[196:199], 0
    s_nop 0
    v_permlane16_swap_b32 v20, v17
    v_max_f32 v16, v20, v17
    v_mfma_f32_16x16x32_bf16 v[132:135], v[64:67], a[204:207], 0
    s_waitcnt lgkmcnt(5)
    v_add_f32 v16, 0x420c0000, v16
    v_cndmask_b32 v36, -v16, v36, s[42:43]
    v_mfma_f32_16x16x32_bf16 v[136:139], v[64:67], a[212:215], 0
    s_waitcnt lgkmcnt(3)
    v_add_f32 v120, v120, v36
    v_add_f32 v121, v121, v36
    v_mfma_f32_16x16x32_bf16 v[140:143], v[64:67], a[220:223], 0
    v_add_f32 v122, v122, v36
    v_add_f32 v123, v123, v36
    v_mfma_f32_16x16x32_bf16 v[160:163], v[68:71], a[196:199], 0
    v_add_f32 v124, v124, v36
    v_add_f32 v125, v125, v36
    v_mfma_f32_16x16x32_bf16 v[164:167], v[68:71], a[204:207], 0
    v_add_f32 v126, v126, v36
    v_add_f32 v127, v127, v36
    v_mfma_f32_16x16x32_bf16 v[168:171], v[68:71], a[212:215], 0
L_pad1_0:
    s_cbranch_vccnz L_pad1_2
    v_exp_f32 v120, v120
    v_mfma_f32_16x16x32_bf16 v[172:175], v[68:71], a[220:223], 0
    v_exp_f32 v121, v121
    v_mfma_f32_16x16x32_bf16 v[192:195], v[72:75], a[196:199], 0
    ds_read_b128 a[164:167], v1 offset:33344
    v_cvt_pk_bf16_f32 v76, v120, v121
    v_mfma_f32_16x16x32_bf16 v[196:199], v[72:75], a[204:207], 0
    v_exp_f32 v122, v122
    v_mfma_f32_16x16x32_bf16 v[200:203], v[72:75], a[212:215], 0
    v_exp_f32 v123, v123
    v_mfma_f32_16x16x32_bf16 v[204:207], v[72:75], a[220:223], 0
    s_waitcnt lgkmcnt(1)
    ds_read_b128 a[168:171], v1 offset:33408
    v_cvt_pk_bf16_f32 v77, v122, v123
    v_mfma_f32_16x16x32_bf16 a[128:131], a[224:227], a[196:199], 0
    v_exp_f32 v124, v124
    v_mfma_f32_16x16x32_bf16 a[132:135], a[224:227], a[204:207], 0
    v_exp_f32 v125, v125
    v_mfma_f32_16x16x32_bf16 a[136:139], a[224:227], a[212:215], 0
    ds_read_b128 a[172:175], v1 offset:33472
    v_cvt_pk_bf16_f32 v78, v124, v125
    v_mfma_f32_16x16x32_bf16 a[140:143], a[224:227], a[220:223], 0
    v_exp_f32 v126, v126
    v_exp_f32 v127, v127
    s_nop 0
    v_cvt_pk_bf16_f32 v79, v126, v127
    s_nop 1
    v_mfma_f32_16x16x32_bf16 v[224:227], v[76:79], a[196:199], 0
    ds_read_b128 a[176:179], v1 offset:33536
    v_add_f32 v56, v56, v36
    v_mfma_f32_16x16x32_bf16 v[228:231], v[76:79], a[204:207], 0
    ds_read_b128 a[180:183], v1 offset:33600
    v_add_f32 v57, v57, v36
    v_mfma_f32_16x16x32_bf16 v[232:235], v[76:79], a[212:215], 0
    v_exp_f32 v56, v56
    v_mfma_f32_16x16x32_bf16 v[236:239], v[76:79], a[220:223], 0
    ds_read_b128 a[184:187], v1 offset:33664
    v_add_f32 v58, v58, v36
    v_exp_f32 v57, v57
    v_add_f32 v59, v59, v36
    v_exp_f32 v58, v58
    v_exp_f32 v59, v59
    ds_read_b128 a[188:191], v1 offset:33728
    s_mov_b32 m0, s36
    s_nop 0
    ds_write_addtid_b32 v88 offset:11264
    ds_write_addtid_b32 v89 offset:11520
    v_cvt_pk_bf16_f32 v92, v56, v57
    v_cvt_pk_bf16_f32 v93, v58, v59
    ds_write_addtid_b32 v92 offset:11776
    ds_write_addtid_b32 v93 offset:12032
    v_add_f32 v11, v56, v11
    v_add_f32 v11, v57, v11
    v_add_f32 v11, v58, v11
    v_add_f32 v11, v59, v11
    ds_read_b64_tr_b16 a[194:195], v3 offset:128
    ds_read_b64_tr_b16 a[200:201], v2 offset:144
    ds_read_b64_tr_b16 a[202:203], v3 offset:144
    ds_read_b64_tr_b16 a[208:209], v2 offset:160
    ds_read_b64_tr_b16 a[210:211], v3 offset:160
    ds_read_b64_tr_b16 a[216:217], v2 offset:176
    ds_read_b64_tr_b16 a[218:219], v3 offset:176
    v_cndmask_b32 v37, -v16, v37, s[42:43]
    v_cndmask_b32 v38, -v16, v38, s[42:43]
    v_cndmask_b32 v39, -v16, v39, s[42:43]
    v_add_f32 v11, v120, v11
    v_add_f32 v11, v121, v11
    v_add_f32 v11, v122, v11
    v_add_f32 v11, v123, v11
    s_add_u32 m0, s34, 3136
    s_nop 0
    buffer_load_dwordx4 v4, s[16:19], s32 offen offset:1024 lds
    s_add_u32 m0, s34, 4704
    s_nop 0
    buffer_load_dwordx4 v4, s[16:19], s32 offen offset:1536 lds
    s_add_u32 s32, s32, s49
    s_waitcnt vmcnt(12) lgkmcnt(7)
    s_barrier
    v_mfma_f32_16x16x32_bf16 v[44:47], a[160:163], a[0:3], v[24:27]
    ds_read_b64_tr_b16 a[196:197], v2 offset:16768
    v_mfma_f32_16x16x32_bf16 v[44:47], a[164:167], a[4:7], v[44:47]
    ds_read2st64_b32 v[82:83], v6 offset0:60 offset1:61
    v_mfma_f32_16x16x32_bf16 v[44:47], a[168:171], a[8:11], v[44:47]
    ds_read_b64_tr_b16 a[198:199], v3 offset:16768
    v_mfma_f32_16x16x32_bf16 v[44:47], a[172:175], a[12:15], v[44:47]
    ds_read2st64_b32 v[86:87], v6 offset0:62 offset1:63
    v_mfma_f32_16x16x32_bf16 v[44:47], a[176:179], a[16:19], v[44:47]
    s_add_u32 m0, s35, 49920
    ds_read2st64_b32 v[90:91], v6 offset0:64 offset1:65
    v_mfma_f32_16x16x32_bf16 v[44:47], a[180:183], a[20:23], v[44:47]
    buffer_load_dwordx4 v5, s[20:23], s33 offen lds
    v_mfma_f32_16x16x32_bf16 v[44:47], a[184:187], a[24:27], v[44:47]
    ds_read2st64_b32 v[94:95], v6 offset0:66 offset1:67
    v_mfma_f32_16x16x32_bf16 v[44:47], a[188:191], a[28:31], v[44:47]
    ds_read2st64_b32 a[228:229], v7 offset0:48 offset1:49
    v_mfma_f32_16x16x32_bf16 v[48:51], a[188:191], a[60:63], v[28:31]
    ds_read2st64_b32 a[230:231], v6 offset0:48 offset1:49
    v_mfma_f32_16x16x32_bf16 v[48:51], a[184:187], a[56:59], v[48:51]
    ds_read_b64_tr_b16 a[204:205], v2 offset:16784
    v_mfma_f32_16x16x32_bf16 v[48:51], a[180:183], a[52:55], v[48:51]
    ds_read_b64_tr_b16 a[206:207], v3 offset:16784
    v_mfma_f32_16x16x32_bf16 v[48:51], a[176:179], a[48:51], v[48:51]
    ds_read_b64_tr_b16 a[212:213], v2 offset:16800
    v_mfma_f32_16x16x32_bf16 v[48:51], a[172:175], a[44:47], v[48:51]
    ds_read_b64_tr_b16 a[214:215], v3 offset:16800
    v_mfma_f32_16x16x32_bf16 v[48:51], a[168:171], a[40:43], v[48:51]
    s_add_u32 m0, s35, 51472
    ds_read_b64_tr_b16 a[220:221], v2 offset:16816
    v_mfma_f32_16x16x32_bf16 v[48:51], a[164:167], a[36:39], v[48:51]
    buffer_load_dwordx4 v5, s[20:23], s33 offen offset:512 lds
    v_mfma_f32_16x16x32_bf16 v[48:51], a[160:163], a[32:35], v[48:51]
    ds_read_b64_tr_b16 a[222:223], v3 offset:16816
    v_mfma_f32_16x16x32_bf16 v[52:55], a[160:163], a[64:67], v[32:35]
    v_exp_f32 v44, v44
    v_mfma_f32_16x16x32_bf16 v[52:55], a[164:167], a[68:71], v[52:55]
    v_exp_f32 v45, v45
    v_mfma_f32_16x16x32_bf16 v[52:55], a[168:171], a[72:75], v[52:55]
    v_cvt_pk_bf16_f32 v96, v44, v45
    v_add_f32 v8, v44, v8
    v_mfma_f32_16x16x32_bf16 v[52:55], a[172:175], a[76:79], v[52:55]
    v_exp_f32 v46, v46
    v_mfma_f32_16x16x32_bf16 v[52:55], a[176:179], a[80:83], v[52:55]
    s_mov_b32 m0, s36
    v_exp_f32 v47, v47
    v_mfma_f32_16x16x32_bf16 v[52:55], a[180:183], a[84:87], v[52:55]
    ds_write_addtid_b32 v96 offset:0
    v_cvt_pk_bf16_f32 v97, v46, v47
    v_mfma_f32_16x16x32_bf16 v[52:55], a[184:187], a[88:91], v[52:55]
    s_add_u32 m0, s35, 53024
    v_exp_f32 v48, v48
    v_mfma_f32_16x16x32_bf16 v[52:55], a[188:191], a[92:95], v[52:55]
    buffer_load_dwordx4 v5, s[20:23], s33 offen offset:1024 lds
    v_mfma_f32_16x16x32_bf16 v[56:59], a[188:191], a[124:127], v[36:39]
    s_mov_b32 m0, s36
    v_exp_f32 v49, v49
    v_mfma_f32_16x16x32_bf16 v[56:59], a[184:187], a[120:123], v[56:59]
    ds_write_addtid_b32 v97 offset:256
    v_cvt_pk_bf16_f32 v100, v48, v49
    v_mfma_f32_16x16x32_bf16 v[56:59], a[180:183], a[116:119], v[56:59]
    v_exp_f32 v50, v50
    v_mfma_f32_16x16x32_bf16 v[56:59], a[176:179], a[112:115], v[56:59]
    v_exp_f32 v51, v51
    v_mfma_f32_16x16x32_bf16 v[56:59], a[172:175], a[108:111], v[56:59]
    ds_write_addtid_b32 v100 offset:512
    v_cvt_pk_bf16_f32 v101, v50, v51
    v_mfma_f32_16x16x32_bf16 v[56:59], a[168:171], a[104:107], v[56:59]
    v_exp_f32 v52, v52
    v_mfma_f32_16x16x32_bf16 v[56:59], a[164:167], a[100:103], v[56:59]
    v_exp_f32 v53, v53
    v_mfma_f32_16x16x32_bf16 v[56:59], a[160:163], a[96:99], v[56:59]
    s_waitcnt lgkmcnt(3)
    ds_write_addtid_b32 v101 offset:768
    v_cvt_pk_bf16_f32 v104, v52, v53
    v_mfma_f32_16x16x32_bf16 v[144:147], v[64:67], a[192:195], v[144:147]
    s_add_u32 m0, s35, 54576
    v_add_f32 v9, v48, v9
    v_add_f32 v10, v52, v10
    v_mfma_f32_16x16x32_bf16 v[144:147], v[80:83], a[196:199], v[144:147]
    buffer_load_dwordx4 v5, s[20:23], s33 offen offset:1536 lds
    v_mfma_f32_16x16x32_bf16 v[176:179], v[68:71], a[192:195], v[176:179]
    s_add_u32 s33, s33, s49
    v_exp_f32 v54, v54
    v_mfma_f32_16x16x32_bf16 v[176:179], v[84:87], a[196:199], v[176:179]
    s_mov_b32 m0, s36
    v_exp_f32 v55, v55
    v_mfma_f32_16x16x32_bf16 v[208:211], v[72:75], a[192:195], v[208:211]
    ds_write_addtid_b32 v104 offset:1024
    v_cvt_pk_bf16_f32 v105, v54, v55
    v_mfma_f32_16x16x32_bf16 v[208:211], v[88:91], a[196:199], v[208:211]
    v_exp_f32 v56, v56
    v_mfma_f32_16x16x32_bf16 v[240:243], v[76:79], a[192:195], v[240:243]
    v_exp_f32 v57, v57
    v_mfma_f32_16x16x32_bf16 v[240:243], v[92:95], a[196:199], v[240:243]
    ds_write_addtid_b32 v105 offset:1280
    v_cvt_pk_bf16_f32 v108, v56, v57
    v_mfma_f32_16x16x32_bf16 a[144:147], a[224:227], a[192:195], a[144:147]
    v_exp_f32 v58, v58
    v_mfma_f32_16x16x32_bf16 a[144:147], a[228:231], a[196:199], a[144:147]
    s_add_u32 m0, s34, 16640
    v_add_f32 v11, v56, v11
    v_add_f32 v8, v45, v8
    v_mfma_f32_16x16x32_bf16 a[148:151], a[224:227], a[200:203], a[148:151]
    buffer_load_dwordx4 v4, s[16:19], s32 offen lds
    v_mfma_f32_16x16x32_bf16 a[148:151], a[228:231], a[204:207], a[148:151]
    s_mov_b32 m0, s36
    v_exp_f32 v59, v59
    v_mfma_f32_16x16x32_bf16 v[244:247], v[76:79], a[200:203], v[244:247]
    ds_write_addtid_b32 v108 offset:1536
    v_cvt_pk_bf16_f32 v109, v58, v59
    v_mfma_f32_16x16x32_bf16 v[244:247], v[92:95], a[204:207], v[244:247]
    v_add_f32 v9, v49, v9
    v_add_f32 v10, v53, v10
    v_mfma_f32_16x16x32_bf16 v[212:215], v[72:75], a[200:203], v[212:215]
    ds_write_addtid_b32 v109 offset:1792
    v_add_f32 v11, v57, v11
    v_mfma_f32_16x16x32_bf16 v[212:215], v[88:91], a[204:207], v[212:215]
    s_add_u32 m0, s34, 18208
    v_add_f32 v8, v46, v8
    v_add_f32 v9, v50, v9
    v_mfma_f32_16x16x32_bf16 v[180:183], v[68:71], a[200:203], v[180:183]
    buffer_load_dwordx4 v4, s[16:19], s32 offen offset:512 lds
    v_mfma_f32_16x16x32_bf16 v[180:183], v[84:87], a[204:207], v[180:183]
    s_add_u32 m0, s34, 19776
    v_add_f32 v10, v54, v10
    v_add_f32 v11, v58, v11
    v_mfma_f32_16x16x32_bf16 v[148:151], v[64:67], a[200:203], v[148:151]
    buffer_load_dwordx4 v4, s[16:19], s32 offen offset:1024 lds
    v_mfma_f32_16x16x32_bf16 v[148:151], v[80:83], a[204:207], v[148:151]
    s_waitcnt vmcnt(15)
    v_add_f32 v8, v47, v8
    v_add_f32 v9, v51, v9
    v_mfma_f32_16x16x32_bf16 v[152:155], v[64:67], a[208:211], v[152:155]
    s_barrier
    v_add_f32 v10, v55, v10
    v_add_f32 v11, v59, v11
    v_mfma_f32_16x16x32_bf16 v[152:155], v[80:83], a[212:215], v[152:155]
    ds_read_b128 a[160:163], v1 offset:49920
    v_mfma_f32_16x16x32_bf16 v[184:187], v[68:71], a[208:211], v[184:187]
    ds_read_b128 a[164:167], v1 offset:49984
    v_mfma_f32_16x16x32_bf16 v[184:187], v[84:87], a[212:215], v[184:187]
    ds_read_b128 a[168:171], v1 offset:50048
    v_mfma_f32_16x16x32_bf16 v[216:219], v[72:75], a[208:211], v[216:219]
    ds_read_b128 a[172:175], v1 offset:50112
    v_mfma_f32_16x16x32_bf16 v[216:219], v[88:91], a[212:215], v[216:219]
    ds_read_b128 a[176:179], v1 offset:50176
    v_mfma_f32_16x16x32_bf16 v[248:251], v[76:79], a[208:211], v[248:251]
    s_add_u32 m0, s34, 21344
    ds_read_b128 a[180:183], v1 offset:50240
    v_mfma_f32_16x16x32_bf16 v[248:251], v[92:95], a[212:215], v[248:251]
    buffer_load_dwordx4 v4, s[16:19], s32 offen offset:1536 lds
    v_mfma_f32_16x16x32_bf16 a[152:155], a[224:227], a[208:211], a[152:155]
    s_add_u32 s32, s32, s49
    ds_read_b128 a[184:187], v1 offset:50304
    v_mfma_f32_16x16x32_bf16 a[152:155], a[228:231], a[212:215], a[152:155]
    ds_read_b128 a[188:191], v1 offset:50368
    v_mfma_f32_16x16x32_bf16 a[156:159], a[224:227], a[216:219], a[156:159]
    ds_read_b64_tr_b16 a[192:193], v2 offset:16640
    v_mfma_f32_16x16x32_bf16 a[156:159], a[228:231], a[220:223], a[156:159]
    ds_read_b64_tr_b16 a[194:195], v3 offset:16640
    v_mfma_f32_16x16x32_bf16 v[252:255], v[76:79], a[216:219], v[252:255]
    ds_read_b64_tr_b16 a[200:201], v2 offset:16656
    v_mfma_f32_16x16x32_bf16 v[252:255], v[92:95], a[220:223], v[252:255]
    v_mfma_f32_16x16x32_bf16 v[220:223], v[72:75], a[216:219], v[220:223]
    s_add_u32 m0, s34, 33280
    ds_read_b64_tr_b16 a[202:203], v3 offset:16656
    v_mfma_f32_16x16x32_bf16 v[220:223], v[88:91], a[220:223], v[220:223]
    buffer_load_dwordx4 v4, s[16:19], s32 offen lds
    v_mfma_f32_16x16x32_bf16 v[188:191], v[68:71], a[216:219], v[188:191]
    ds_read_b64_tr_b16 a[208:209], v2 offset:16672
    v_mfma_f32_16x16x32_bf16 v[188:191], v[84:87], a[220:223], v[188:191]
    ds_read_b64_tr_b16 a[210:211], v3 offset:16672
    v_mfma_f32_16x16x32_bf16 v[156:159], v[64:67], a[216:219], v[156:159]
    s_waitcnt vmcnt(13) lgkmcnt(6)
    ds_read_b64_tr_b16 a[216:217], v2 offset:16688
    v_mfma_f32_16x16x32_bf16 v[156:159], v[80:83], a[220:223], v[156:159]
    s_barrier
    ds_read_b64_tr_b16 a[218:219], v3 offset:16688
    v_mfma_f32_16x16x32_bf16 v[44:47], a[160:163], a[0:3], v[24:27]
    ds_read_b64_tr_b16 a[196:197], v2 offset:33280
    v_mfma_f32_16x16x32_bf16 v[44:47], a[164:167], a[4:7], v[44:47]
    ds_read2st64_b32 v[98:99], v6 offset0:20 offset1:21
    v_mfma_f32_16x16x32_bf16 v[44:47], a[168:171], a[8:11], v[44:47]
    ds_read_b64_tr_b16 a[198:199], v3 offset:33280
    v_mfma_f32_16x16x32_bf16 v[44:47], a[172:175], a[12:15], v[44:47]
    ds_read2st64_b32 v[102:103], v6 offset0:22 offset1:23
    v_mfma_f32_16x16x32_bf16 v[44:47], a[176:179], a[16:19], v[44:47]
    s_add_u32 m0, s35, 0
    ds_read2st64_b32 v[106:107], v6 offset0:24 offset1:25
    v_mfma_f32_16x16x32_bf16 v[44:47], a[180:183], a[20:23], v[44:47]
    buffer_load_dwordx4 v5, s[20:23], s33 offen lds
    v_mfma_f32_16x16x32_bf16 v[44:47], a[184:187], a[24:27], v[44:47]
    ds_read2st64_b32 v[110:111], v6 offset0:26 offset1:27
    v_mfma_f32_16x16x32_bf16 v[44:47], a[188:191], a[28:31], v[44:47]
    ds_read2st64_b32 a[232:233], v7 offset0:8 offset1:9
    v_mfma_f32_16x16x32_bf16 v[48:51], a[188:191], a[60:63], v[28:31]
    ds_read2st64_b32 a[234:235], v6 offset0:8 offset1:9
    v_mfma_f32_16x16x32_bf16 v[48:51], a[184:187], a[56:59], v[48:51]
    ds_read_b64_tr_b16 a[204:205], v2 offset:33296
    v_mfma_f32_16x16x32_bf16 v[48:51], a[180:183], a[52:55], v[48:51]
    ds_read_b64_tr_b16 a[206:207], v3 offset:33296
    v_mfma_f32_16x16x32_bf16 v[48:51], a[176:179], a[48:51], v[48:51]
    ds_read_b64_tr_b16 a[212:213], v2 offset:33312
    v_mfma_f32_16x16x32_bf16 v[48:51], a[172:175], a[44:47], v[48:51]
    ds_read_b64_tr_b16 a[214:215], v3 offset:33312
    v_mfma_f32_16x16x32_bf16 v[48:51], a[168:171], a[40:43], v[48:51]
    s_add_u32 m0, s35, 1552
    ds_read_b64_tr_b16 a[220:221], v2 offset:33328
    v_mfma_f32_16x16x32_bf16 v[48:51], a[164:167], a[36:39], v[48:51]
    buffer_load_dwordx4 v5, s[20:23], s33 offen offset:512 lds
    v_mfma_f32_16x16x32_bf16 v[48:51], a[160:163], a[32:35], v[48:51]
    ds_read_b64_tr_b16 a[222:223], v3 offset:33328
    v_mfma_f32_16x16x32_bf16 v[52:55], a[160:163], a[64:67], v[32:35]
    v_exp_f32 v44, v44
    v_mfma_f32_16x16x32_bf16 v[52:55], a[164:167], a[68:71], v[52:55]
    v_exp_f32 v45, v45
    v_mfma_f32_16x16x32_bf16 v[52:55], a[168:171], a[72:75], v[52:55]
    v_cvt_pk_bf16_f32 v112, v44, v45
    v_add_f32 v8, v44, v8
    v_mfma_f32_16x16x32_bf16 v[52:55], a[172:175], a[76:79], v[52:55]
    v_exp_f32 v46, v46
    v_mfma_f32_16x16x32_bf16 v[52:55], a[176:179], a[80:83], v[52:55]
    s_mov_b32 m0, s36
    v_exp_f32 v47, v47
    v_mfma_f32_16x16x32_bf16 v[52:55], a[180:183], a[84:87], v[52:55]
    ds_write_addtid_b32 v112 offset:10240
    v_cvt_pk_bf16_f32 v113, v46, v47
    v_mfma_f32_16x16x32_bf16 v[52:55], a[184:187], a[88:91], v[52:55]
    s_add_u32 m0, s35, 3104
    v_exp_f32 v48, v48
    v_mfma_f32_16x16x32_bf16 v[52:55], a[188:191], a[92:95], v[52:55]
    buffer_load_dwordx4 v5, s[20:23], s33 offen offset:1024 lds
    v_mfma_f32_16x16x32_bf16 v[56:59], a[188:191], a[124:127], v[36:39]
    s_mov_b32 m0, s36
    v_exp_f32 v49, v49
    v_mfma_f32_16x16x32_bf16 v[56:59], a[184:187], a[120:123], v[56:59]
    ds_write_addtid_b32 v113 offset:10496
    v_cvt_pk_bf16_f32 v116, v48, v49
    v_mfma_f32_16x16x32_bf16 v[56:59], a[180:183], a[116:119], v[56:59]
    v_exp_f32 v50, v50
    v_mfma_f32_16x16x32_bf16 v[56:59], a[176:179], a[112:115], v[56:59]
    v_exp_f32 v51, v51
    v_mfma_f32_16x16x32_bf16 v[56:59], a[172:175], a[108:111], v[56:59]
    ds_write_addtid_b32 v116 offset:10752
    v_cvt_pk_bf16_f32 v117, v50, v51
    v_mfma_f32_16x16x32_bf16 v[56:59], a[168:171], a[104:107], v[56:59]
    v_exp_f32 v52, v52
    v_mfma_f32_16x16x32_bf16 v[56:59], a[164:167], a[100:103], v[56:59]
    v_exp_f32 v53, v53
    v_mfma_f32_16x16x32_bf16 v[56:59], a[160:163], a[96:99], v[56:59]
    s_waitcnt lgkmcnt(3)
    ds_write_addtid_b32 v117 offset:11008
    v_cvt_pk_bf16_f32 v120, v52, v53
    v_mfma_f32_16x16x32_bf16 v[128:131], v[80:83], a[192:195], v[128:131]
    s_add_u32 m0, s35, 4656
    v_add_f32 v9, v48, v9
    v_add_f32 v10, v52, v10
    v_mfma_f32_16x16x32_bf16 v[128:131], v[96:99], a[196:199], v[128:131]
    buffer_load_dwordx4 v5, s[20:23], s33 offen offset:1536 lds
    v_mfma_f32_16x16x32_bf16 v[160:163], v[84:87], a[192:195], v[160:163]
    s_add_u32 s33, s33, s49
    v_exp_f32 v54, v54
    v_mfma_f32_16x16x32_bf16 v[160:163], v[100:103], a[196:199], v[160:163]
    s_mov_b32 m0, s36
    v_exp_f32 v55, v55
    v_mfma_f32_16x16x32_bf16 v[192:195], v[88:91], a[192:195], v[192:195]
    ds_write_addtid_b32 v120 offset:11264
    v_cvt_pk_bf16_f32 v121, v54, v55
    v_mfma_f32_16x16x32_bf16 v[192:195], v[104:107], a[196:199], v[192:195]
    v_exp_f32 v56, v56
    v_mfma_f32_16x16x32_bf16 v[224:227], v[92:95], a[192:195], v[224:227]
    v_exp_f32 v57, v57
    v_mfma_f32_16x16x32_bf16 v[224:227], v[108:111], a[196:199], v[224:227]
    ds_write_addtid_b32 v121 offset:11520
    v_cvt_pk_bf16_f32 v124, v56, v57
    v_mfma_f32_16x16x32_bf16 a[128:131], a[228:231], a[192:195], a[128:131]
    v_exp_f32 v58, v58
    v_mfma_f32_16x16x32_bf16 a[128:131], a[232:235], a[196:199], a[128:131]
    s_add_u32 m0, s34, 34848
    v_add_f32 v11, v56, v11
    v_add_f32 v8, v45, v8
    v_mfma_f32_16x16x32_bf16 a[132:135], a[228:231], a[200:203], a[132:135]
    buffer_load_dwordx4 v4, s[16:19], s32 offen offset:512 lds
    v_mfma_f32_16x16x32_bf16 a[132:135], a[232:235], a[204:207], a[132:135]
    s_mov_b32 m0, s36
    v_exp_f32 v59, v59
    v_mfma_f32_16x16x32_bf16 v[228:231], v[92:95], a[200:203], v[228:231]
    ds_write_addtid_b32 v124 offset:11776
    v_cvt_pk_bf16_f32 v125, v58, v59
    v_mfma_f32_16x16x32_bf16 v[228:231], v[108:111], a[204:207], v[228:231]
    v_add_f32 v9, v49, v9
    v_add_f32 v10, v53, v10
    v_mfma_f32_16x16x32_bf16 v[196:199], v[88:91], a[200:203], v[196:199]
    ds_write_addtid_b32 v125 offset:12032
    v_add_f32 v11, v57, v11
    v_mfma_f32_16x16x32_bf16 v[196:199], v[104:107], a[204:207], v[196:199]
    s_add_u32 m0, s34, 36416
    v_add_f32 v8, v46, v8
    v_add_f32 v9, v50, v9
    v_mfma_f32_16x16x32_bf16 v[164:167], v[84:87], a[200:203], v[164:167]
    buffer_load_dwordx4 v4, s[16:19], s32 offen offset:1024 lds
    v_mfma_f32_16x16x32_bf16 v[164:167], v[100:103], a[204:207], v[164:167]
    s_add_u32 m0, s34, 37984
    v_add_f32 v10, v54, v10
    v_add_f32 v11, v58, v11
    v_mfma_f32_16x16x32_bf16 v[132:135], v[80:83], a[200:203], v[132:135]
    buffer_load_dwordx4 v4, s[16:19], s32 offen offset:1536 lds
    v_mfma_f32_16x16x32_bf16 v[132:135], v[96:99], a[204:207], v[132:135]
    s_waitcnt vmcnt(16)
    v_add_f32 v8, v47, v8
    v_add_f32 v9, v51, v9
    v_mfma_f32_16x16x32_bf16 v[136:139], v[80:83], a[208:211], v[136:139]
    s_barrier
    v_add_f32 v10, v55, v10
    v_add_f32 v11, v59, v11
    v_mfma_f32_16x16x32_bf16 v[136:139], v[96:99], a[212:215], v[136:139]
    s_add_u32 s32, s32, s49
    ds_read_b128 a[160:163], v1 offset:0
    v_mfma_f32_16x16x32_bf16 v[168:171], v[84:87], a[208:211], v[168:171]
    ds_read_b128 a[164:167], v1 offset:64
    v_mfma_f32_16x16x32_bf16 v[168:171], v[100:103], a[212:215], v[168:171]
    ds_read_b128 a[168:171], v1 offset:128
    v_mfma_f32_16x16x32_bf16 v[200:203], v[88:91], a[208:211], v[200:203]
    ds_read_b128 a[172:175], v1 offset:192
    v_mfma_f32_16x16x32_bf16 v[200:203], v[104:107], a[212:215], v[200:203]
    ds_read_b128 a[176:179], v1 offset:256
    v_mfma_f32_16x16x32_bf16 v[232:235], v[92:95], a[208:211], v[232:235]
    s_add_u32 m0, s34, 49920
    ds_read_b128 a[180:183], v1 offset:320
    v_mfma_f32_16x16x32_bf16 v[232:235], v[108:111], a[212:215], v[232:235]
    buffer_load_dwordx4 v4, s[16:19], s32 offen lds
    v_mfma_f32_16x16x32_bf16 a[136:139], a[228:231], a[208:211], a[136:139]
    ds_read_b128 a[184:187], v1 offset:384
    v_mfma_f32_16x16x32_bf16 a[136:139], a[232:235], a[212:215], a[136:139]
    ds_read_b128 a[188:191], v1 offset:448
    v_mfma_f32_16x16x32_bf16 a[140:143], a[228:231], a[216:219], a[140:143]
    ds_read_b64_tr_b16 a[192:193], v2 offset:33408
    v_mfma_f32_16x16x32_bf16 a[140:143], a[232:235], a[220:223], a[140:143]
    ds_read_b64_tr_b16 a[194:195], v3 offset:33408
    v_mfma_f32_16x16x32_bf16 v[236:239], v[92:95], a[216:219], v[236:239]
    ds_read_b64_tr_b16 a[200:201], v2 offset:33424
    v_mfma_f32_16x16x32_bf16 v[236:239], v[108:111], a[220:223], v[236:239]
    v_mfma_f32_16x16x32_bf16 v[204:207], v[88:91], a[216:219], v[204:207]
    s_add_u32 m0, s34, 51488
    ds_read_b64_tr_b16 a[202:203], v3 offset:33424
    v_mfma_f32_16x16x32_bf16 v[204:207], v[104:107], a[220:223], v[204:207]
    buffer_load_dwordx4 v4, s[16:19], s32 offen offset:512 lds
    v_mfma_f32_16x16x32_bf16 v[172:175], v[84:87], a[216:219], v[172:175]
    ds_read_b64_tr_b16 a[208:209], v2 offset:33440
    v_mfma_f32_16x16x32_bf16 v[172:175], v[100:103], a[220:223], v[172:175]
    ds_read_b64_tr_b16 a[210:211], v3 offset:33440
    v_mfma_f32_16x16x32_bf16 v[140:143], v[80:83], a[216:219], v[140:143]
    s_waitcnt vmcnt(10) lgkmcnt(6)
    ds_read_b64_tr_b16 a[216:217], v2 offset:33456
    v_mfma_f32_16x16x32_bf16 v[140:143], v[96:99], a[220:223], v[140:143]
    s_barrier
    ds_read_b64_tr_b16 a[218:219], v3 offset:33456
    v_mfma_f32_16x16x32_bf16 v[44:47], a[160:163], a[0:3], v[24:27]
    ds_read_b64_tr_b16 a[196:197], v2 offset:50048
    v_mfma_f32_16x16x32_bf16 v[44:47], a[164:167], a[4:7], v[44:47]
    ds_read2st64_b32 v[114:115], v6 offset0:60 offset1:61
    v_mfma_f32_16x16x32_bf16 v[44:47], a[168:171], a[8:11], v[44:47]
    ds_read_b64_tr_b16 a[198:199], v3 offset:50048
    v_mfma_f32_16x16x32_bf16 v[44:47], a[172:175], a[12:15], v[44:47]
    ds_read2st64_b32 v[118:119], v6 offset0:62 offset1:63
    v_mfma_f32_16x16x32_bf16 v[44:47], a[176:179], a[16:19], v[44:47]
    s_add_u32 m0, s35, 16640
    ds_read2st64_b32 v[122:123], v6 offset0:64 offset1:65
    v_mfma_f32_16x16x32_bf16 v[44:47], a[180:183], a[20:23], v[44:47]
    buffer_load_dwordx4 v5, s[20:23], s33 offen lds
    v_mfma_f32_16x16x32_bf16 v[44:47], a[184:187], a[24:27], v[44:47]
    ds_read2st64_b32 v[126:127], v6 offset0:66 offset1:67
    v_mfma_f32_16x16x32_bf16 v[44:47], a[188:191], a[28:31], v[44:47]
    ds_read2st64_b32 a[236:237], v7 offset0:48 offset1:49
    v_mfma_f32_16x16x32_bf16 v[48:51], a[188:191], a[60:63], v[28:31]
    ds_read2st64_b32 a[238:239], v6 offset0:48 offset1:49
    v_mfma_f32_16x16x32_bf16 v[48:51], a[184:187], a[56:59], v[48:51]
    ds_read_b64_tr_b16 a[204:205], v2 offset:50064
    v_mfma_f32_16x16x32_bf16 v[48:51], a[180:183], a[52:55], v[48:51]
    ds_read_b64_tr_b16 a[206:207], v3 offset:50064
    v_mfma_f32_16x16x32_bf16 v[48:51], a[176:179], a[48:51], v[48:51]
    ds_read_b64_tr_b16 a[212:213], v2 offset:50080
    v_mfma_f32_16x16x32_bf16 v[48:51], a[172:175], a[44:47], v[48:51]
    ds_read_b64_tr_b16 a[214:215], v3 offset:50080
    v_mfma_f32_16x16x32_bf16 v[48:51], a[168:171], a[40:43], v[48:51]
    s_add_u32 m0, s35, 18192
    ds_read_b64_tr_b16 a[220:221], v2 offset:50096
    v_mfma_f32_16x16x32_bf16 v[48:51], a[164:167], a[36:39], v[48:51]
    buffer_load_dwordx4 v5, s[20:23], s33 offen offset:512 lds
    v_mfma_f32_16x16x32_bf16 v[48:51], a[160:163], a[32:35], v[48:51]
    ds_read_b64_tr_b16 a[222:223], v3 offset:50096
    v_mfma_f32_16x16x32_bf16 v[52:55], a[160:163], a[64:67], v[32:35]
    v_exp_f32 v44, v44
    v_mfma_f32_16x16x32_bf16 v[52:55], a[164:167], a[68:71], v[52:55]
    v_exp_f32 v45, v45
    v_mfma_f32_16x16x32_bf16 v[52:55], a[168:171], a[72:75], v[52:55]
    v_cvt_pk_bf16_f32 v64, v44, v45
    v_add_f32 v8, v44, v8
    v_mfma_f32_16x16x32_bf16 v[52:55], a[172:175], a[76:79], v[52:55]
    v_exp_f32 v46, v46
    v_mfma_f32_16x16x32_bf16 v[52:55], a[176:179], a[80:83], v[52:55]
    s_mov_b32 m0, s36
    v_exp_f32 v47, v47
    v_mfma_f32_16x16x32_bf16 v[52:55], a[180:183], a[84:87], v[52:55]
    ds_write_addtid_b32 v64 offset:0
    v_cvt_pk_bf16_f32 v65, v46, v47
    v_mfma_f32_16x16x32_bf16 v[52:55], a[184:187], a[88:91], v[52:55]
    s_add_u32 m0, s35, 19744
    v_exp_f32 v48, v48
    v_mfma_f32_16x16x32_bf16 v[52:55], a[188:191], a[92:95], v[52:55]
    buffer_load_dwordx4 v5, s[20:23], s33 offen offset:1024 lds
    v_mfma_f32_16x16x32_bf16 v[56:59], a[188:191], a[124:127], v[36:39]
    s_mov_b32 m0, s36
    v_exp_f32 v49, v49
    v_mfma_f32_16x16x32_bf16 v[56:59], a[184:187], a[120:123], v[56:59]
    s_cmp_eq_u32 s31, 1
    s_cselect_b32 s18, 0, s18
    ds_write_addtid_b32 v65 offset:256
    v_cvt_pk_bf16_f32 v68, v48, v49
    v_mfma_f32_16x16x32_bf16 v[56:59], a[180:183], a[116:119], v[56:59]
    v_exp_f32 v50, v50
    v_mfma_f32_16x16x32_bf16 v[56:59], a[176:179], a[112:115], v[56:59]
    v_exp_f32 v51, v51
    v_mfma_f32_16x16x32_bf16 v[56:59], a[172:175], a[108:111], v[56:59]
    ds_write_addtid_b32 v68 offset:512
    v_cvt_pk_bf16_f32 v69, v50, v51
    v_mfma_f32_16x16x32_bf16 v[56:59], a[168:171], a[104:107], v[56:59]
    v_exp_f32 v52, v52
    v_mfma_f32_16x16x32_bf16 v[56:59], a[164:167], a[100:103], v[56:59]
    v_exp_f32 v53, v53
    v_mfma_f32_16x16x32_bf16 v[56:59], a[160:163], a[96:99], v[56:59]
    s_waitcnt lgkmcnt(3)
    ds_write_addtid_b32 v69 offset:768
    v_cvt_pk_bf16_f32 v72, v52, v53
    v_mfma_f32_16x16x32_bf16 v[144:147], v[96:99], a[192:195], v[144:147]
    s_add_u32 m0, s35, 21296
    v_add_f32 v9, v48, v9
    v_add_f32 v10, v52, v10
    v_mfma_f32_16x16x32_bf16 v[144:147], v[112:115], a[196:199], v[144:147]
    buffer_load_dwordx4 v5, s[20:23], s33 offen offset:1536 lds
    v_mfma_f32_16x16x32_bf16 v[176:179], v[100:103], a[192:195], v[176:179]
    s_add_u32 s33, s33, s49
    v_exp_f32 v54, v54
    v_mfma_f32_16x16x32_bf16 v[176:179], v[116:119], a[196:199], v[176:179]
    s_mov_b32 m0, s36
    v_exp_f32 v55, v55
    v_mfma_f32_16x16x32_bf16 v[208:211], v[104:107], a[192:195], v[208:211]
    ds_write_addtid_b32 v72 offset:1024
    v_cvt_pk_bf16_f32 v73, v54, v55
    v_mfma_f32_16x16x32_bf16 v[208:211], v[120:123], a[196:199], v[208:211]
    v_exp_f32 v56, v56
    v_mfma_f32_16x16x32_bf16 v[240:243], v[108:111], a[192:195], v[240:243]
    v_exp_f32 v57, v57
    v_mfma_f32_16x16x32_bf16 v[240:243], v[124:127], a[196:199], v[240:243]
    ds_write_addtid_b32 v73 offset:1280
    v_cvt_pk_bf16_f32 v76, v56, v57
    v_mfma_f32_16x16x32_bf16 a[144:147], a[232:235], a[192:195], a[144:147]
    v_exp_f32 v58, v58
    v_mfma_f32_16x16x32_bf16 a[144:147], a[236:239], a[196:199], a[144:147]
    s_add_u32 m0, s34, 53056
    v_add_f32 v11, v56, v11
    v_add_f32 v8, v45, v8
    v_mfma_f32_16x16x32_bf16 a[148:151], a[232:235], a[200:203], a[148:151]
    buffer_load_dwordx4 v4, s[16:19], s32 offen offset:1024 lds
    v_mfma_f32_16x16x32_bf16 a[148:151], a[236:239], a[204:207], a[148:151]
    s_mov_b32 m0, s36
    v_exp_f32 v59, v59
    v_mfma_f32_16x16x32_bf16 v[244:247], v[108:111], a[200:203], v[244:247]
    ds_write_addtid_b32 v76 offset:1536
    v_cvt_pk_bf16_f32 v77, v58, v59
    v_mfma_f32_16x16x32_bf16 v[244:247], v[124:127], a[204:207], v[244:247]
    v_add_f32 v9, v49, v9
    v_add_f32 v10, v53, v10
    v_mfma_f32_16x16x32_bf16 v[212:215], v[104:107], a[200:203], v[212:215]
    ds_write_addtid_b32 v77 offset:1792
    v_add_f32 v11, v57, v11
    v_mfma_f32_16x16x32_bf16 v[212:215], v[120:123], a[204:207], v[212:215]
    s_add_u32 m0, s34, 54624
    v_add_f32 v8, v46, v8
    v_add_f32 v9, v50, v9
    v_mfma_f32_16x16x32_bf16 v[180:183], v[100:103], a[200:203], v[180:183]
    buffer_load_dwordx4 v4, s[16:19], s32 offen offset:1536 lds
    v_mfma_f32_16x16x32_bf16 v[180:183], v[116:119], a[204:207], v[180:183]
    s_add_u32 m0, s34, 0
    s_add_u32 s32, s32, s49
    v_add_f32 v10, v54, v10
    v_add_f32 v11, v58, v11
    v_mfma_f32_16x16x32_bf16 v[148:151], v[96:99], a[200:203], v[148:151]
    buffer_load_dwordx4 v4, s[16:19], s32 offen lds
    v_mfma_f32_16x16x32_bf16 v[148:151], v[112:115], a[204:207], v[148:151]
    v_add_f32 v8, v47, v8
    v_add_f32 v9, v51, v9
    v_mfma_f32_16x16x32_bf16 v[152:155], v[96:99], a[208:211], v[152:155]
    v_add_f32 v10, v55, v10
    v_add_f32 v11, v59, v11
    v_mfma_f32_16x16x32_bf16 v[152:155], v[112:115], a[212:215], v[152:155]
    ds_read_b128 a[160:163], v1 offset:16640
    v_mfma_f32_16x16x32_bf16 v[184:187], v[100:103], a[208:211], v[184:187]
    ds_read_b128 a[164:167], v1 offset:16704
    v_mfma_f32_16x16x32_bf16 v[184:187], v[116:119], a[212:215], v[184:187]
    ds_read_b128 a[168:171], v1 offset:16768
    v_mfma_f32_16x16x32_bf16 v[216:219], v[104:107], a[208:211], v[216:219]
    ds_read_b128 a[172:175], v1 offset:16832
    v_mfma_f32_16x16x32_bf16 v[216:219], v[120:123], a[212:215], v[216:219]
    ds_read_b128 a[176:179], v1 offset:16896
    v_mfma_f32_16x16x32_bf16 v[248:251], v[108:111], a[208:211], v[248:251]
    s_add_u32 m0, s34, 1568
    ds_read_b128 a[180:183], v1 offset:16960
    v_mfma_f32_16x16x32_bf16 v[248:251], v[124:127], a[212:215], v[248:251]
    buffer_load_dwordx4 v4, s[16:19], s32 offen offset:512 lds
    v_mfma_f32_16x16x32_bf16 a[152:155], a[232:235], a[208:211], a[152:155]
    ds_read_b128 a[184:187], v1 offset:17024
    v_mfma_f32_16x16x32_bf16 a[152:155], a[236:239], a[212:215], a[152:155]
L_pad1_1:
    s_cbranch_vccnz L_pad1_3
    ds_read_b128 a[188:191], v1 offset:17088
    v_mfma_f32_16x16x32_bf16 a[156:159], a[232:235], a[216:219], a[156:159]
    ds_read_b64_tr_b16 a[192:193], v2 offset:49920
    v_mfma_f32_16x16x32_bf16 a[156:159], a[236:239], a[220:223], a[156:159]
    ds_read_b64_tr_b16 a[194:195], v3 offset:49920
    v_mfma_f32_16x16x32_bf16 v[252:255], v[108:111], a[216:219], v[252:255]
    ds_read_b64_tr_b16 a[200:201], v2 offset:49936
    v_mfma_f32_16x16x32_bf16 v[252:255], v[124:127], a[220:223], v[252:255]
    v_mfma_f32_16x16x32_bf16 v[220:223], v[104:107], a[216:219], v[220:223]
    s_add_u32 m0, s34, 3136
    ds_read_b64_tr_b16 a[202:203], v3 offset:49936
    v_mfma_f32_16x16x32_bf16 v[220:223], v[120:123], a[220:223], v[220:223]
    buffer_load_dwordx4 v4, s[16:19], s32 offen offset:1024 lds
    v_mfma_f32_16x16x32_bf16 v[188:191], v[100:103], a[216:219], v[188:191]
    ds_read_b64_tr_b16 a[208:209], v2 offset:49952
    v_mfma_f32_16x16x32_bf16 v[188:191], v[116:119], a[220:223], v[188:191]
    ds_read_b64_tr_b16 a[210:211], v3 offset:49952
    v_mfma_f32_16x16x32_bf16 v[156:159], v[96:99], a[216:219], v[156:159]
    s_waitcnt vmcnt(11) lgkmcnt(6)
    ds_read_b64_tr_b16 a[216:217], v2 offset:49968
    v_mfma_f32_16x16x32_bf16 v[156:159], v[112:115], a[220:223], v[156:159]
    s_barrier
    ds_read_b64_tr_b16 a[218:219], v3 offset:49968
    v_mfma_f32_16x16x32_bf16 v[44:47], a[160:163], a[0:3], v[24:27]
    ds_read_b64_tr_b16 a[196:197], v2 offset:0
    v_mfma_f32_16x16x32_bf16 v[44:47], a[164:167], a[4:7], v[44:47]
    ds_read2st64_b32 v[66:67], v6 offset0:20 offset1:21
    v_mfma_f32_16x16x32_bf16 v[44:47], a[168:171], a[8:11], v[44:47]
    ds_read_b64_tr_b16 a[198:199], v3 offset:0
    v_mfma_f32_16x16x32_bf16 v[44:47], a[172:175], a[12:15], v[44:47]
    ds_read2st64_b32 v[70:71], v6 offset0:22 offset1:23
    v_mfma_f32_16x16x32_bf16 v[44:47], a[176:179], a[16:19], v[44:47]
    s_add_u32 m0, s35, 33280
    ds_read2st64_b32 v[74:75], v6 offset0:24 offset1:25
    v_mfma_f32_16x16x32_bf16 v[44:47], a[180:183], a[20:23], v[44:47]
    buffer_load_dwordx4 v5, s[20:23], s33 offen lds
    v_mfma_f32_16x16x32_bf16 v[44:47], a[184:187], a[24:27], v[44:47]
    ds_read2st64_b32 v[78:79], v6 offset0:26 offset1:27
    v_mfma_f32_16x16x32_bf16 v[44:47], a[188:191], a[28:31], v[44:47]
    ds_read2st64_b32 a[224:225], v7 offset0:8 offset1:9
    v_mfma_f32_16x16x32_bf16 v[48:51], a[188:191], a[60:63], v[28:31]
    ds_read2st64_b32 a[226:227], v6 offset0:8 offset1:9
    v_mfma_f32_16x16x32_bf16 v[48:51], a[184:187], a[56:59], v[48:51]
    ds_read_b64_tr_b16 a[204:205], v2 offset:16
    v_mfma_f32_16x16x32_bf16 v[48:51], a[180:183], a[52:55], v[48:51]
    ds_read_b64_tr_b16 a[206:207], v3 offset:16
    v_mfma_f32_16x16x32_bf16 v[48:51], a[176:179], a[48:51], v[48:51]
    ds_read_b64_tr_b16 a[212:213], v2 offset:32
    v_mfma_f32_16x16x32_bf16 v[48:51], a[172:175], a[44:47], v[48:51]
    ds_read_b64_tr_b16 a[214:215], v3 offset:32
    v_mfma_f32_16x16x32_bf16 v[48:51], a[168:171], a[40:43], v[48:51]
    s_add_u32 m0, s35, 34832
    ds_read_b64_tr_b16 a[220:221], v2 offset:48
    v_mfma_f32_16x16x32_bf16 v[48:51], a[164:167], a[36:39], v[48:51]
    buffer_load_dwordx4 v5, s[20:23], s33 offen offset:512 lds
    v_mfma_f32_16x16x32_bf16 v[48:51], a[160:163], a[32:35], v[48:51]
    ds_read_b64_tr_b16 a[222:223], v3 offset:48
    v_mfma_f32_16x16x32_bf16 v[52:55], a[160:163], a[64:67], v[32:35]
    v_exp_f32 v44, v44
    v_mfma_f32_16x16x32_bf16 v[52:55], a[164:167], a[68:71], v[52:55]
    v_exp_f32 v45, v45
    v_mfma_f32_16x16x32_bf16 v[52:55], a[168:171], a[72:75], v[52:55]
    v_cvt_pk_bf16_f32 v80, v44, v45
    v_add_f32 v8, v44, v8
    v_mfma_f32_16x16x32_bf16 v[52:55], a[172:175], a[76:79], v[52:55]
    v_exp_f32 v46, v46
    v_mfma_f32_16x16x32_bf16 v[52:55], a[176:179], a[80:83], v[52:55]
    s_mov_b32 m0, s36
    v_exp_f32 v47, v47
    v_mfma_f32_16x16x32_bf16 v[52:55], a[180:183], a[84:87], v[52:55]
    ds_write_addtid_b32 v80 offset:10240
    v_cvt_pk_bf16_f32 v81, v46, v47
    v_mfma_f32_16x16x32_bf16 v[52:55], a[184:187], a[88:91], v[52:55]
    s_add_u32 m0, s35, 36384
    v_exp_f32 v48, v48
    v_mfma_f32_16x16x32_bf16 v[52:55], a[188:191], a[92:95], v[52:55]
    buffer_load_dwordx4 v5, s[20:23], s33 offen offset:1024 lds
    v_mfma_f32_16x16x32_bf16 v[56:59], a[188:191], a[124:127], v[36:39]
    s_mov_b32 m0, s36
    v_exp_f32 v49, v49
    v_mfma_f32_16x16x32_bf16 v[56:59], a[184:187], a[120:123], v[56:59]
    ds_write_addtid_b32 v81 offset:10496
    v_cvt_pk_bf16_f32 v84, v48, v49
    v_mfma_f32_16x16x32_bf16 v[56:59], a[180:183], a[116:119], v[56:59]
    v_exp_f32 v50, v50
    v_mfma_f32_16x16x32_bf16 v[56:59], a[176:179], a[112:115], v[56:59]
    v_exp_f32 v51, v51
    v_mfma_f32_16x16x32_bf16 v[56:59], a[172:175], a[108:111], v[56:59]
    ds_write_addtid_b32 v84 offset:10752
    v_cvt_pk_bf16_f32 v85, v50, v51
    v_mfma_f32_16x16x32_bf16 v[56:59], a[168:171], a[104:107], v[56:59]
    v_exp_f32 v52, v52
    v_mfma_f32_16x16x32_bf16 v[56:59], a[164:167], a[100:103], v[56:59]
    v_exp_f32 v53, v53
    v_mfma_f32_16x16x32_bf16 v[56:59], a[160:163], a[96:99], v[56:59]
    s_waitcnt lgkmcnt(3)
    ds_write_addtid_b32 v85 offset:11008
    v_cvt_pk_bf16_f32 v88, v52, v53
    v_mfma_f32_16x16x32_bf16 v[128:131], v[112:115], a[192:195], v[128:131]
    s_add_u32 m0, s35, 37936
    v_add_f32 v9, v48, v9
    v_add_f32 v10, v52, v10
    v_mfma_f32_16x16x32_bf16 v[128:131], v[64:67], a[196:199], v[128:131]
    buffer_load_dwordx4 v5, s[20:23], s33 offen offset:1536 lds
    v_mfma_f32_16x16x32_bf16 v[160:163], v[116:119], a[192:195], v[160:163]
    s_add_u32 s33, s33, s49
    v_exp_f32 v54, v54
    v_mfma_f32_16x16x32_bf16 v[160:163], v[68:71], a[196:199], v[160:163]
    s_mov_b32 m0, s36
    v_exp_f32 v55, v55
    v_mfma_f32_16x16x32_bf16 v[192:195], v[120:123], a[192:195], v[192:195]
    ds_write_addtid_b32 v88 offset:11264
    v_cvt_pk_bf16_f32 v89, v54, v55
    v_mfma_f32_16x16x32_bf16 v[192:195], v[72:75], a[196:199], v[192:195]
    v_exp_f32 v56, v56
    v_mfma_f32_16x16x32_bf16 v[224:227], v[124:127], a[192:195], v[224:227]
    v_exp_f32 v57, v57
    v_mfma_f32_16x16x32_bf16 v[224:227], v[76:79], a[196:199], v[224:227]
    ds_write_addtid_b32 v89 offset:11520
    v_cvt_pk_bf16_f32 v92, v56, v57
    v_mfma_f32_16x16x32_bf16 a[128:131], a[236:239], a[192:195], a[128:131]
    v_exp_f32 v58, v58
    v_mfma_f32_16x16x32_bf16 a[128:131], a[224:227], a[196:199], a[128:131]
    s_add_u32 m0, s34, 4704
    v_add_f32 v11, v56, v11
    v_add_f32 v8, v45, v8
    v_mfma_f32_16x16x32_bf16 a[132:135], a[236:239], a[200:203], a[132:135]
    buffer_load_dwordx4 v4, s[16:19], s32 offen offset:1536 lds
    v_mfma_f32_16x16x32_bf16 a[132:135], a[224:227], a[204:207], a[132:135]
    s_mov_b32 m0, s36
    v_exp_f32 v59, v59
    v_mfma_f32_16x16x32_bf16 v[228:231], v[124:127], a[200:203], v[228:231]
    s_add_u32 s32, s32, s49
    ds_write_addtid_b32 v92 offset:11776
    v_cvt_pk_bf16_f32 v93, v58, v59
    v_mfma_f32_16x16x32_bf16 v[228:231], v[76:79], a[204:207], v[228:231]
    v_add_f32 v9, v49, v9
    v_add_f32 v10, v53, v10
    v_mfma_f32_16x16x32_bf16 v[196:199], v[120:123], a[200:203], v[196:199]
    ds_write_addtid_b32 v93 offset:12032
    v_add_f32 v11, v57, v11
    v_mfma_f32_16x16x32_bf16 v[196:199], v[72:75], a[204:207], v[196:199]
    s_add_u32 m0, s34, 16640
    v_add_f32 v8, v46, v8
    v_add_f32 v9, v50, v9
    v_mfma_f32_16x16x32_bf16 v[164:167], v[116:119], a[200:203], v[164:167]
    buffer_load_dwordx4 v4, s[16:19], s32 offen lds
    v_mfma_f32_16x16x32_bf16 v[164:167], v[68:71], a[204:207], v[164:167]
    s_add_u32 m0, s34, 18208
    v_add_f32 v10, v54, v10
    v_add_f32 v11, v58, v11
    v_mfma_f32_16x16x32_bf16 v[132:135], v[112:115], a[200:203], v[132:135]
    buffer_load_dwordx4 v4, s[16:19], s32 offen offset:512 lds
    v_mfma_f32_16x16x32_bf16 v[132:135], v[64:67], a[204:207], v[132:135]
    v_add_f32 v8, v47, v8
    v_add_f32 v9, v51, v9
    v_mfma_f32_16x16x32_bf16 v[136:139], v[112:115], a[208:211], v[136:139]
    v_add_f32 v10, v55, v10
    v_add_f32 v11, v59, v11
    v_mfma_f32_16x16x32_bf16 v[136:139], v[64:67], a[212:215], v[136:139]
    ds_read_b128 a[160:163], v1 offset:33280
    v_mfma_f32_16x16x32_bf16 v[168:171], v[116:119], a[208:211], v[168:171]
    ds_read_b128 a[164:167], v1 offset:33344
    v_mfma_f32_16x16x32_bf16 v[168:171], v[68:71], a[212:215], v[168:171]
    ds_read_b128 a[168:171], v1 offset:33408
    v_mfma_f32_16x16x32_bf16 v[200:203], v[120:123], a[208:211], v[200:203]
    ds_read_b128 a[172:175], v1 offset:33472
    v_mfma_f32_16x16x32_bf16 v[200:203], v[72:75], a[212:215], v[200:203]
    ds_read_b128 a[176:179], v1 offset:33536
    v_mfma_f32_16x16x32_bf16 v[232:235], v[124:127], a[208:211], v[232:235]
    s_add_u32 m0, s34, 19776
    ds_read_b128 a[180:183], v1 offset:33600
    v_mfma_f32_16x16x32_bf16 v[232:235], v[76:79], a[212:215], v[232:235]
    buffer_load_dwordx4 v4, s[16:19], s32 offen offset:1024 lds
    v_mfma_f32_16x16x32_bf16 a[136:139], a[236:239], a[208:211], a[136:139]
    ds_read_b128 a[184:187], v1 offset:33664
    v_mfma_f32_16x16x32_bf16 a[136:139], a[224:227], a[212:215], a[136:139]
    ds_read_b128 a[188:191], v1 offset:33728
    v_mfma_f32_16x16x32_bf16 a[140:143], a[236:239], a[216:219], a[140:143]
    ds_read_b64_tr_b16 a[192:193], v2 offset:128
    v_mfma_f32_16x16x32_bf16 a[140:143], a[224:227], a[220:223], a[140:143]
    ds_read_b64_tr_b16 a[194:195], v3 offset:128
    v_mfma_f32_16x16x32_bf16 v[236:239], v[124:127], a[216:219], v[236:239]
    ds_read_b64_tr_b16 a[200:201], v2 offset:144
    v_mfma_f32_16x16x32_bf16 v[236:239], v[76:79], a[220:223], v[236:239]
    v_mfma_f32_16x16x32_bf16 v[204:207], v[120:123], a[216:219], v[204:207]
    s_add_u32 m0, s34, 21344
    ds_read_b64_tr_b16 a[202:203], v3 offset:144
    v_mfma_f32_16x16x32_bf16 v[204:207], v[72:75], a[220:223], v[204:207]
    buffer_load_dwordx4 v4, s[16:19], s32 offen offset:1536 lds
    v_mfma_f32_16x16x32_bf16 v[172:175], v[116:119], a[216:219], v[172:175]
    s_add_u32 s32, s32, s49
    ds_read_b64_tr_b16 a[208:209], v2 offset:160
    v_mfma_f32_16x16x32_bf16 v[172:175], v[68:71], a[220:223], v[172:175]
    ds_read_b64_tr_b16 a[210:211], v3 offset:160
    v_mfma_f32_16x16x32_bf16 v[140:143], v[112:115], a[216:219], v[140:143]
    s_waitcnt vmcnt(12) lgkmcnt(6)
    ds_read_b64_tr_b16 a[216:217], v2 offset:176
    v_mfma_f32_16x16x32_bf16 v[140:143], v[64:67], a[220:223], v[140:143]
    s_barrier
    ds_read_b64_tr_b16 a[218:219], v3 offset:176
.p2align 3
L_loop1:
    v_mfma_f32_16x16x32_bf16 v[44:47], a[160:163], a[0:3], v[24:27]
    ds_read_b64_tr_b16 a[196:197], v2 offset:16768
    v_mfma_f32_16x16x32_bf16 v[44:47], a[164:167], a[4:7], v[44:47]
    ds_read2st64_b32 v[82:83], v6 offset0:60 offset1:61
    v_mfma_f32_16x16x32_bf16 v[44:47], a[168:171], a[8:11], v[44:47]
    ds_read_b64_tr_b16 a[198:199], v3 offset:16768
    v_mfma_f32_16x16x32_bf16 v[44:47], a[172:175], a[12:15], v[44:47]
    ds_read2st64_b32 v[86:87], v6 offset0:62 offset1:63
    v_mfma_f32_16x16x32_bf16 v[44:47], a[176:179], a[16:19], v[44:47]
    s_add_u32 m0, s35, 49920
    ds_read2st64_b32 v[90:91], v6 offset0:64 offset1:65
    v_mfma_f32_16x16x32_bf16 v[44:47], a[180:183], a[20:23], v[44:47]
    buffer_load_dwordx4 v5, s[20:23], s33 offen lds
    v_mfma_f32_16x16x32_bf16 v[44:47], a[184:187], a[24:27], v[44:47]
    ds_read2st64_b32 v[94:95], v6 offset0:66 offset1:67
    v_mfma_f32_16x16x32_bf16 v[44:47], a[188:191], a[28:31], v[44:47]
    ds_read2st64_b32 a[228:229], v7 offset0:48 offset1:49
    v_mfma_f32_16x16x32_bf16 v[48:51], a[188:191], a[60:63], v[28:31]
    ds_read2st64_b32 a[230:231], v6 offset0:48 offset1:49
    v_mfma_f32_16x16x32_bf16 v[48:51], a[184:187], a[56:59], v[48:51]
    ds_read_b64_tr_b16 a[204:205], v2 offset:16784
    v_mfma_f32_16x16x32_bf16 v[48:51], a[180:183], a[52:55], v[48:51]
    ds_read_b64_tr_b16 a[206:207], v3 offset:16784
    v_mfma_f32_16x16x32_bf16 v[48:51], a[176:179], a[48:51], v[48:51]
    ds_read_b64_tr_b16 a[212:213], v2 offset:16800
    v_mfma_f32_16x16x32_bf16 v[48:51], a[172:175], a[44:47], v[48:51]
    ds_read_b64_tr_b16 a[214:215], v3 offset:16800
    v_mfma_f32_16x16x32_bf16 v[48:51], a[168:171], a[40:43], v[48:51]
    ds_read_b64_tr_b16 a[220:221], v2 offset:16816
    v_mfma_f32_16x16x32_bf16 v[48:51], a[164:167], a[36:39], v[48:51]
    buffer_load_dword v20, v19, s[20:23], 0 offen
    v_mfma_f32_16x16x32_bf16 v[48:51], a[160:163], a[32:35], v[48:51]
    ds_read_b64_tr_b16 a[222:223], v3 offset:16816
    v_add_u32 v19, 0x1000000, v19
    v_mfma_f32_16x16x32_bf16 v[52:55], a[160:163], a[64:67], v[32:35]
    v_exp_f32 v44, v44
    v_mfma_f32_16x16x32_bf16 v[52:55], a[164:167], a[68:71], v[52:55]
    v_exp_f32 v45, v45
    v_mfma_f32_16x16x32_bf16 v[52:55], a[168:171], a[72:75], v[52:55]
    v_cvt_pk_bf16_f32 v96, v44, v45
    v_add_f32 v8, v44, v8
    v_mfma_f32_16x16x32_bf16 v[52:55], a[172:175], a[76:79], v[52:55]
    v_exp_f32 v46, v46
    v_mfma_f32_16x16x32_bf16 v[52:55], a[176:179], a[80:83], v[52:55]
    s_mov_b32 m0, s36
    v_exp_f32 v47, v47
    v_mfma_f32_16x16x32_bf16 v[52:55], a[180:183], a[84:87], v[52:55]
    ds_write_addtid_b32 v96 offset:0
    v_cvt_pk_bf16_f32 v97, v46, v47
    v_mfma_f32_16x16x32_bf16 v[52:55], a[184:187], a[88:91], v[52:55]
    s_add_u32 m0, s35, 51472
    v_exp_f32 v48, v48
    v_mfma_f32_16x16x32_bf16 v[52:55], a[188:191], a[92:95], v[52:55]
    buffer_load_dwordx4 v5, s[20:23], s33 offen offset:512 lds
    v_mfma_f32_16x16x32_bf16 v[56:59], a[188:191], a[124:127], v[36:39]
    s_mov_b32 m0, s36
    v_exp_f32 v49, v49
    v_mfma_f32_16x16x32_bf16 v[56:59], a[184:187], a[120:123], v[56:59]
    ds_write_addtid_b32 v97 offset:256
    v_cvt_pk_bf16_f32 v100, v48, v49
    v_mfma_f32_16x16x32_bf16 v[56:59], a[180:183], a[116:119], v[56:59]
    v_exp_f32 v50, v50
    v_mfma_f32_16x16x32_bf16 v[56:59], a[176:179], a[112:115], v[56:59]
    v_exp_f32 v51, v51
    v_mfma_f32_16x16x32_bf16 v[56:59], a[172:175], a[108:111], v[56:59]
    ds_write_addtid_b32 v100 offset:512
    v_cvt_pk_bf16_f32 v101, v50, v51
    v_mfma_f32_16x16x32_bf16 v[56:59], a[168:171], a[104:107], v[56:59]
    v_exp_f32 v52, v52
    v_mfma_f32_16x16x32_bf16 v[56:59], a[164:167], a[100:103], v[56:59]
    v_exp_f32 v53, v53
    v_mfma_f32_16x16x32_bf16 v[56:59], a[160:163], a[96:99], v[56:59]
    s_waitcnt lgkmcnt(3)
    ds_write_addtid_b32 v101 offset:768
    v_cvt_pk_bf16_f32 v104, v52, v53
    v_mfma_f32_16x16x32_bf16 v[144:147], v[64:67], a[192:195], v[144:147]
    s_add_u32 m0, s35, 53024
    v_add_f32 v9, v48, v9
    v_add_f32 v10, v52, v10
    v_mfma_f32_16x16x32_bf16 v[144:147], v[80:83], a[196:199], v[144:147]
    buffer_load_dwordx4 v5, s[20:23], s33 offen offset:1024 lds
    v_mfma_f32_16x16x32_bf16 v[176:179], v[68:71], a[192:195], v[176:179]
    v_exp_f32 v54, v54
    v_mfma_f32_16x16x32_bf16 v[176:179], v[84:87], a[196:199], v[176:179]
    s_mov_b32 m0, s36
    v_exp_f32 v55, v55
    v_mfma_f32_16x16x32_bf16 v[208:211], v[72:75], a[192:195], v[208:211]
    ds_write_addtid_b32 v104 offset:1024
    v_cvt_pk_bf16_f32 v105, v54, v55
    v_mfma_f32_16x16x32_bf16 v[208:211], v[88:91], a[196:199], v[208:211]
    v_exp_f32 v56, v56
    v_mfma_f32_16x16x32_bf16 v[240:243], v[76:79], a[192:195], v[240:243]
    v_exp_f32 v57, v57
    v_mfma_f32_16x16x32_bf16 v[240:243], v[92:95], a[196:199], v[240:243]
    ds_write_addtid_b32 v105 offset:1280
    v_cvt_pk_bf16_f32 v108, v56, v57
    v_mfma_f32_16x16x32_bf16 a[144:147], a[224:227], a[192:195], a[144:147]
    v_exp_f32 v58, v58
    v_mfma_f32_16x16x32_bf16 a[144:147], a[228:231], a[196:199], a[144:147]
    s_add_u32 m0, s35, 54576
    v_add_f32 v11, v56, v11
    v_add_f32 v8, v45, v8
    v_mfma_f32_16x16x32_bf16 a[148:151], a[224:227], a[200:203], a[148:151]
    buffer_load_dwordx4 v5, s[20:23], s33 offen offset:1536 lds
    v_mfma_f32_16x16x32_bf16 a[148:151], a[228:231], a[204:207], a[148:151]
    s_mov_b32 m0, s36
    v_exp_f32 v59, v59
    v_mfma_f32_16x16x32_bf16 v[244:247], v[76:79], a[200:203], v[244:247]
    s_add_u32 s33, s33, s49
    ds_write_addtid_b32 v108 offset:1536
    v_cvt_pk_bf16_f32 v109, v58, v59
    v_mfma_f32_16x16x32_bf16 v[244:247], v[92:95], a[204:207], v[244:247]
    v_add_f32 v9, v49, v9
    v_add_f32 v10, v53, v10
    v_mfma_f32_16x16x32_bf16 v[212:215], v[72:75], a[200:203], v[212:215]
    ds_write_addtid_b32 v109 offset:1792
    v_add_f32 v11, v57, v11
    v_mfma_f32_16x16x32_bf16 v[212:215], v[88:91], a[204:207], v[212:215]
    s_add_u32 m0, s34, 33280
    v_add_f32 v8, v46, v8
    v_add_f32 v9, v50, v9
    v_mfma_f32_16x16x32_bf16 v[180:183], v[68:71], a[200:203], v[180:183]
    buffer_load_dwordx4 v4, s[16:19], s32 offen lds
    v_mfma_f32_16x16x32_bf16 v[180:183], v[84:87], a[204:207], v[180:183]
    s_add_u32 m0, s34, 34848
    v_add_f32 v10, v54, v10
    v_add_f32 v11, v58, v11
    v_mfma_f32_16x16x32_bf16 v[148:151], v[64:67], a[200:203], v[148:151]
    buffer_load_dwordx4 v4, s[16:19], s32 offen offset:512 lds
    v_mfma_f32_16x16x32_bf16 v[148:151], v[80:83], a[204:207], v[148:151]
    v_add_f32 v8, v47, v8
    v_add_f32 v9, v51, v9
    v_mfma_f32_16x16x32_bf16 v[152:155], v[64:67], a[208:211], v[152:155]
    v_add_f32 v10, v55, v10
    v_add_f32 v11, v59, v11
    v_mfma_f32_16x16x32_bf16 v[152:155], v[80:83], a[212:215], v[152:155]
    ds_read_b128 a[160:163], v1 offset:49920
    v_mfma_f32_16x16x32_bf16 v[184:187], v[68:71], a[208:211], v[184:187]
    ds_read_b128 a[164:167], v1 offset:49984
    v_mfma_f32_16x16x32_bf16 v[184:187], v[84:87], a[212:215], v[184:187]
    ds_read_b128 a[168:171], v1 offset:50048
    v_mfma_f32_16x16x32_bf16 v[216:219], v[72:75], a[208:211], v[216:219]
    ds_read_b128 a[172:175], v1 offset:50112
    v_mfma_f32_16x16x32_bf16 v[216:219], v[88:91], a[212:215], v[216:219]
    ds_read_b128 a[176:179], v1 offset:50176
    v_mfma_f32_16x16x32_bf16 v[248:251], v[76:79], a[208:211], v[248:251]
    s_add_u32 m0, s34, 36416
    ds_read_b128 a[180:183], v1 offset:50240
    v_mfma_f32_16x16x32_bf16 v[248:251], v[92:95], a[212:215], v[248:251]
    buffer_load_dwordx4 v4, s[16:19], s32 offen offset:1024 lds
    v_mfma_f32_16x16x32_bf16 a[152:155], a[224:227], a[208:211], a[152:155]
    ds_read_b128 a[184:187], v1 offset:50304
    v_mfma_f32_16x16x32_bf16 a[152:155], a[228:231], a[212:215], a[152:155]
    ds_read_b128 a[188:191], v1 offset:50368
    v_mfma_f32_16x16x32_bf16 a[156:159], a[224:227], a[216:219], a[156:159]
    ds_read_b64_tr_b16 a[192:193], v2 offset:16640
    v_mfma_f32_16x16x32_bf16 a[156:159], a[228:231], a[220:223], a[156:159]
    ds_read_b64_tr_b16 a[194:195], v3 offset:16640
    v_mfma_f32_16x16x32_bf16 v[252:255], v[76:79], a[216:219], v[252:255]
    ds_read_b64_tr_b16 a[200:201], v2 offset:16656
    v_mfma_f32_16x16x32_bf16 v[252:255], v[92:95], a[220:223], v[252:255]
    v_mfma_f32_16x16x32_bf16 v[220:223], v[72:75], a[216:219], v[220:223]
    s_add_u32 m0, s34, 37984
    ds_read_b64_tr_b16 a[202:203], v3 offset:16656
    v_mfma_f32_16x16x32_bf16 v[220:223], v[88:91], a[220:223], v[220:223]
    buffer_load_dwordx4 v4, s[16:19], s32 offen offset:1536 lds
    v_mfma_f32_16x16x32_bf16 v[188:191], v[68:71], a[216:219], v[188:191]
    s_add_u32 s32, s32, s49
    ds_read_b64_tr_b16 a[208:209], v2 offset:16672
    v_mfma_f32_16x16x32_bf16 v[188:191], v[84:87], a[220:223], v[188:191]
    ds_read_b64_tr_b16 a[210:211], v3 offset:16672
    v_mfma_f32_16x16x32_bf16 v[156:159], v[64:67], a[216:219], v[156:159]
    s_waitcnt vmcnt(13) lgkmcnt(6)
    ds_read_b64_tr_b16 a[216:217], v2 offset:16688
    v_mfma_f32_16x16x32_bf16 v[156:159], v[80:83], a[220:223], v[156:159]
    s_barrier
    ds_read_b64_tr_b16 a[218:219], v3 offset:16688
    v_mfma_f32_16x16x32_bf16 v[44:47], a[160:163], a[0:3], v[24:27]
    ds_read_b64_tr_b16 a[196:197], v2 offset:33280
    v_mfma_f32_16x16x32_bf16 v[44:47], a[164:167], a[4:7], v[44:47]
    ds_read2st64_b32 v[98:99], v6 offset0:20 offset1:21
    v_mfma_f32_16x16x32_bf16 v[44:47], a[168:171], a[8:11], v[44:47]
    ds_read_b64_tr_b16 a[198:199], v3 offset:33280
    v_mfma_f32_16x16x32_bf16 v[44:47], a[172:175], a[12:15], v[44:47]
    ds_read2st64_b32 v[102:103], v6 offset0:22 offset1:23
    v_mfma_f32_16x16x32_bf16 v[44:47], a[176:179], a[16:19], v[44:47]
    s_add_u32 m0, s35, 0
    ds_read2st64_b32 v[106:107], v6 offset0:24 offset1:25
    v_mfma_f32_16x16x32_bf16 v[44:47], a[180:183], a[20:23], v[44:47]
    buffer_load_dwordx4 v5, s[20:23], s33 offen lds
    v_mfma_f32_16x16x32_bf16 v[44:47], a[184:187], a[24:27], v[44:47]
    ds_read2st64_b32 v[110:111], v6 offset0:26 offset1:27
    v_mfma_f32_16x16x32_bf16 v[44:47], a[188:191], a[28:31], v[44:47]
    ds_read2st64_b32 a[232:233], v7 offset0:8 offset1:9
    v_mfma_f32_16x16x32_bf16 v[48:51], a[188:191], a[60:63], v[28:31]
    ds_read2st64_b32 a[234:235], v6 offset0:8 offset1:9
    v_mfma_f32_16x16x32_bf16 v[48:51], a[184:187], a[56:59], v[48:51]
    ds_read_b64_tr_b16 a[204:205], v2 offset:33296
    v_mfma_f32_16x16x32_bf16 v[48:51], a[180:183], a[52:55], v[48:51]
    ds_read_b64_tr_b16 a[206:207], v3 offset:33296
    v_mfma_f32_16x16x32_bf16 v[48:51], a[176:179], a[48:51], v[48:51]
    ds_read_b64_tr_b16 a[212:213], v2 offset:33312
    v_mfma_f32_16x16x32_bf16 v[48:51], a[172:175], a[44:47], v[48:51]
    ds_read_b64_tr_b16 a[214:215], v3 offset:33312
    v_mfma_f32_16x16x32_bf16 v[48:51], a[168:171], a[40:43], v[48:51]
    s_add_u32 m0, s35, 1552
    ds_read_b64_tr_b16 a[220:221], v2 offset:33328
    v_mfma_f32_16x16x32_bf16 v[48:51], a[164:167], a[36:39], v[48:51]
    buffer_load_dwordx4 v5, s[20:23], s33 offen offset:512 lds
    v_mfma_f32_16x16x32_bf16 v[48:51], a[160:163], a[32:35], v[48:51]
    ds_read_b64_tr_b16 a[222:223], v3 offset:33328
    v_mfma_f32_16x16x32_bf16 v[52:55], a[160:163], a[64:67], v[32:35]
    v_exp_f32 v44, v44
    v_mfma_f32_16x16x32_bf16 v[52:55], a[164:167], a[68:71], v[52:55]
    v_exp_f32 v45, v45
    v_mfma_f32_16x16x32_bf16 v[52:55], a[168:171], a[72:75], v[52:55]
    v_cvt_pk_bf16_f32 v112, v44, v45
    v_add_f32 v8, v44, v8
    v_mfma_f32_16x16x32_bf16 v[52:55], a[172:175], a[76:79], v[52:55]
    v_exp_f32 v46, v46
    v_mfma_f32_16x16x32_bf16 v[52:55], a[176:179], a[80:83], v[52:55]
    s_mov_b32 m0, s36
    v_exp_f32 v47, v47
    v_mfma_f32_16x16x32_bf16 v[52:55], a[180:183], a[84:87], v[52:55]
    ds_write_addtid_b32 v112 offset:10240
    v_cvt_pk_bf16_f32 v113, v46, v47
    v_mfma_f32_16x16x32_bf16 v[52:55], a[184:187], a[88:91], v[52:55]
    s_add_u32 m0, s35, 3104
    v_exp_f32 v48, v48
    v_mfma_f32_16x16x32_bf16 v[52:55], a[188:191], a[92:95], v[52:55]
    buffer_load_dwordx4 v5, s[20:23], s33 offen offset:1024 lds
    v_mfma_f32_16x16x32_bf16 v[56:59], a[188:191], a[124:127], v[36:39]
    s_mov_b32 m0, s36
    v_exp_f32 v49, v49
    v_mfma_f32_16x16x32_bf16 v[56:59], a[184:187], a[120:123], v[56:59]
    ds_write_addtid_b32 v113 offset:10496
    v_cvt_pk_bf16_f32 v116, v48, v49
    v_mfma_f32_16x16x32_bf16 v[56:59], a[180:183], a[116:119], v[56:59]
    v_exp_f32 v50, v50
    v_mfma_f32_16x16x32_bf16 v[56:59], a[176:179], a[112:115], v[56:59]
    v_exp_f32 v51, v51
    v_mfma_f32_16x16x32_bf16 v[56:59], a[172:175], a[108:111], v[56:59]
    ds_write_addtid_b32 v116 offset:10752
    v_cvt_pk_bf16_f32 v117, v50, v51
    v_mfma_f32_16x16x32_bf16 v[56:59], a[168:171], a[104:107], v[56:59]
    v_exp_f32 v52, v52
    v_mfma_f32_16x16x32_bf16 v[56:59], a[164:167], a[100:103], v[56:59]
    v_exp_f32 v53, v53
    v_mfma_f32_16x16x32_bf16 v[56:59], a[160:163], a[96:99], v[56:59]
    s_waitcnt lgkmcnt(3)
    ds_write_addtid_b32 v117 offset:11008
    v_cvt_pk_bf16_f32 v120, v52, v53
    v_mfma_f32_16x16x32_bf16 v[128:131], v[80:83], a[192:195], v[128:131]
    s_add_u32 m0, s35, 4656
    v_add_f32 v9, v48, v9
    v_add_f32 v10, v52, v10
    v_mfma_f32_16x16x32_bf16 v[128:131], v[96:99], a[196:199], v[128:131]
    buffer_load_dwordx4 v5, s[20:23], s33 offen offset:1536 lds
    v_mfma_f32_16x16x32_bf16 v[160:163], v[84:87], a[192:195], v[160:163]
    s_add_u32 s33, s33, s49
    v_exp_f32 v54, v54
    v_mfma_f32_16x16x32_bf16 v[160:163], v[100:103], a[196:199], v[160:163]
    s_mov_b32 m0, s36
    v_exp_f32 v55, v55
    v_mfma_f32_16x16x32_bf16 v[192:195], v[88:91], a[192:195], v[192:195]
    ds_write_addtid_b32 v120 offset:11264
    v_cvt_pk_bf16_f32 v121, v54, v55
    v_mfma_f32_16x16x32_bf16 v[192:195], v[104:107], a[196:199], v[192:195]
    v_exp_f32 v56, v56
    v_mfma_f32_16x16x32_bf16 v[224:227], v[92:95], a[192:195], v[224:227]
    v_exp_f32 v57, v57
    v_mfma_f32_16x16x32_bf16 v[224:227], v[108:111], a[196:199], v[224:227]
    ds_write_addtid_b32 v121 offset:11520
    v_cvt_pk_bf16_f32 v124, v56, v57
    v_mfma_f32_16x16x32_bf16 a[128:131], a[228:231], a[192:195], a[128:131]
    v_exp_f32 v58, v58
    v_mfma_f32_16x16x32_bf16 a[128:131], a[232:235], a[196:199], a[128:131]
    s_add_u32 m0, s34, 49920
    v_add_f32 v11, v56, v11
    v_add_f32 v8, v45, v8
    v_mfma_f32_16x16x32_bf16 a[132:135], a[228:231], a[200:203], a[132:135]
    buffer_load_dwordx4 v4, s[16:19], s32 offen lds
    v_mfma_f32_16x16x32_bf16 a[132:135], a[232:235], a[204:207], a[132:135]
    s_mov_b32 m0, s36
    v_exp_f32 v59, v59
    v_mfma_f32_16x16x32_bf16 v[228:231], v[92:95], a[200:203], v[228:231]
    ds_write_addtid_b32 v124 offset:11776
    v_cvt_pk_bf16_f32 v125, v58, v59
    v_mfma_f32_16x16x32_bf16 v[228:231], v[108:111], a[204:207], v[228:231]
    v_add_f32 v9, v49, v9
    v_add_f32 v10, v53, v10
    v_mfma_f32_16x16x32_bf16 v[196:199], v[88:91], a[200:203], v[196:199]
    ds_write_addtid_b32 v125 offset:12032
    v_add_f32 v11, v57, v11
    v_mfma_f32_16x16x32_bf16 v[196:199], v[104:107], a[204:207], v[196:199]
    v_add_f32 v8, v46, v8
    v_add_f32 v9, v50, v9
    v_mfma_f32_16x16x32_bf16 v[164:167], v[84:87], a[200:203], v[164:167]
    v_add_f32 v10, v54, v10
    v_add_f32 v11, v58, v11
    v_mfma_f32_16x16x32_bf16 v[164:167], v[100:103], a[204:207], v[164:167]
    s_add_u32 m0, s34, 51488
    v_add_f32 v8, v47, v8
    v_add_f32 v9, v51, v9
    v_mfma_f32_16x16x32_bf16 v[132:135], v[80:83], a[200:203], v[132:135]
    buffer_load_dwordx4 v4, s[16:19], s32 offen offset:512 lds
    v_mfma_f32_16x16x32_bf16 v[132:135], v[96:99], a[204:207], v[132:135]
    v_add_f32 v10, v55, v10
    v_add_f32 v11, v59, v11
    v_mfma_f32_16x16x32_bf16 v[136:139], v[80:83], a[208:211], v[136:139]
    v_mfma_f32_16x16x32_bf16 v[136:139], v[96:99], a[212:215], v[136:139]
    ds_read_b128 a[160:163], v1 offset:0
    v_mfma_f32_16x16x32_bf16 v[168:171], v[84:87], a[208:211], v[168:171]
    ds_read_b128 a[164:167], v1 offset:64
    v_mfma_f32_16x16x32_bf16 v[168:171], v[100:103], a[212:215], v[168:171]
    ds_read_b128 a[168:171], v1 offset:128
    v_mfma_f32_16x16x32_bf16 v[200:203], v[88:91], a[208:211], v[200:203]
    ds_read_b128 a[172:175], v1 offset:192
    v_mfma_f32_16x16x32_bf16 v[200:203], v[104:107], a[212:215], v[200:203]
    ds_read_b128 a[176:179], v1 offset:256
    v_mfma_f32_16x16x32_bf16 v[232:235], v[92:95], a[208:211], v[232:235]
    s_add_u32 m0, s34, 53056
    ds_read_b128 a[180:183], v1 offset:320
    v_mfma_f32_16x16x32_bf16 v[232:235], v[108:111], a[212:215], v[232:235]
    buffer_load_dwordx4 v4, s[16:19], s32 offen offset:1024 lds
    v_mfma_f32_16x16x32_bf16 a[136:139], a[228:231], a[208:211], a[136:139]
    ds_read_b128 a[184:187], v1 offset:384
    v_mfma_f32_16x16x32_bf16 a[136:139], a[232:235], a[212:215], a[136:139]
    ds_read_b128 a[188:191], v1 offset:448
    v_mfma_f32_16x16x32_bf16 a[140:143], a[228:231], a[216:219], a[140:143]
    ds_read_b64_tr_b16 a[192:193], v2 offset:33408
    v_mfma_f32_16x16x32_bf16 a[140:143], a[232:235], a[220:223], a[140:143]
    ds_read_b64_tr_b16 a[194:195], v3 offset:33408
    v_mfma_f32_16x16x32_bf16 v[236:239], v[92:95], a[216:219], v[236:239]
    ds_read_b64_tr_b16 a[200:201], v2 offset:33424
    v_mfma_f32_16x16x32_bf16 v[236:239], v[108:111], a[220:223], v[236:239]
    v_mfma_f32_16x16x32_bf16 v[204:207], v[88:91], a[216:219], v[204:207]
    s_add_u32 m0, s34, 54624
    ds_read_b64_tr_b16 a[202:203], v3 offset:33424
    v_mfma_f32_16x16x32_bf16 v[204:207], v[104:107], a[220:223], v[204:207]
    buffer_load_dwordx4 v4, s[16:19], s32 offen offset:1536 lds
    v_mfma_f32_16x16x32_bf16 v[172:175], v[84:87], a[216:219], v[172:175]
    s_add_u32 s32, s32, s49
    ds_read_b64_tr_b16 a[208:209], v2 offset:33440
    v_mfma_f32_16x16x32_bf16 v[172:175], v[100:103], a[220:223], v[172:175]
    ds_read_b64_tr_b16 a[210:211], v3 offset:33440
    v_mfma_f32_16x16x32_bf16 v[140:143], v[80:83], a[216:219], v[140:143]
    s_waitcnt vmcnt(12) lgkmcnt(6)
    ds_read_b64_tr_b16 a[216:217], v2 offset:33456
    v_mfma_f32_16x16x32_bf16 v[140:143], v[96:99], a[220:223], v[140:143]
    s_barrier
    ds_read_b64_tr_b16 a[218:219], v3 offset:33456
    v_mfma_f32_16x16x32_bf16 v[44:47], a[160:163], a[0:3], v[24:27]
    ds_read_b64_tr_b16 a[196:197], v2 offset:50048
    v_mfma_f32_16x16x32_bf16 v[44:47], a[164:167], a[4:7], v[44:47]
    ds_read2st64_b32 v[114:115], v6 offset0:60 offset1:61
    v_mfma_f32_16x16x32_bf16 v[44:47], a[168:171], a[8:11], v[44:47]
    ds_read_b64_tr_b16 a[198:199], v3 offset:50048
    v_mfma_f32_16x16x32_bf16 v[44:47], a[172:175], a[12:15], v[44:47]
    ds_read2st64_b32 v[118:119], v6 offset0:62 offset1:63
    v_mfma_f32_16x16x32_bf16 v[44:47], a[176:179], a[16:19], v[44:47]
    s_add_u32 m0, s35, 16640
    ds_read2st64_b32 v[122:123], v6 offset0:64 offset1:65
    v_mfma_f32_16x16x32_bf16 v[44:47], a[180:183], a[20:23], v[44:47]
    buffer_load_dwordx4 v5, s[20:23], s33 offen lds
    v_mfma_f32_16x16x32_bf16 v[44:47], a[184:187], a[24:27], v[44:47]
    ds_read2st64_b32 v[126:127], v6 offset0:66 offset1:67
    v_mfma_f32_16x16x32_bf16 v[44:47], a[188:191], a[28:31], v[44:47]
    ds_read2st64_b32 a[236:237], v7 offset0:48 offset1:49
    v_mfma_f32_16x16x32_bf16 v[48:51], a[188:191], a[60:63], v[28:31]
    ds_read2st64_b32 a[238:239], v6 offset0:48 offset1:49
    v_mfma_f32_16x16x32_bf16 v[48:51], a[184:187], a[56:59], v[48:51]
    ds_read_b64_tr_b16 a[204:205], v2 offset:50064
    v_mfma_f32_16x16x32_bf16 v[48:51], a[180:183], a[52:55], v[48:51]
L_pad1_2:
    s_cbranch_vccnz L_walked1
    ds_read_b64_tr_b16 a[206:207], v3 offset:50064
    v_mfma_f32_16x16x32_bf16 v[48:51], a[176:179], a[48:51], v[48:51]
    ds_read_b64_tr_b16 a[212:213], v2 offset:50080
    v_mfma_f32_16x16x32_bf16 v[48:51], a[172:175], a[44:47], v[48:51]
    ds_read_b64_tr_b16 a[214:215], v3 offset:50080
    v_mfma_f32_16x16x32_bf16 v[48:51], a[168:171], a[40:43], v[48:51]
    s_add_u32 m0, s35, 18192
    ds_read_b64_tr_b16 a[220:221], v2 offset:50096
    v_mfma_f32_16x16x32_bf16 v[48:51], a[164:167], a[36:39], v[48:51]
    buffer_load_dwordx4 v5, s[20:23], s33 offen offset:512 lds
    v_mfma_f32_16x16x32_bf16 v[48:51], a[160:163], a[32:35], v[48:51]
    ds_read_b64_tr_b16 a[222:223], v3 offset:50096
    v_mfma_f32_16x16x32_bf16 v[52:55], a[160:163], a[64:67], v[32:35]
    v_exp_f32 v44, v44
    v_mfma_f32_16x16x32_bf16 v[52:55], a[164:167], a[68:71], v[52:55]
    v_exp_f32 v45, v45
    v_mfma_f32_16x16x32_bf16 v[52:55], a[168:171], a[72:75], v[52:55]
    v_cvt_pk_bf16_f32 v64, v44, v45
    v_add_f32 v8, v44, v8
    v_mfma_f32_16x16x32_bf16 v[52:55], a[172:175], a[76:79], v[52:55]
    v_exp_f32 v46, v46
    v_mfma_f32_16x16x32_bf16 v[52:55], a[176:179], a[80:83], v[52:55]
    s_mov_b32 m0, s36
    v_exp_f32 v47, v47
    v_mfma_f32_16x16x32_bf16 v[52:55], a[180:183], a[84:87], v[52:55]
    ds_write_addtid_b32 v64 offset:0
    v_cvt_pk_bf16_f32 v65, v46, v47
    v_mfma_f32_16x16x32_bf16 v[52:55], a[184:187], a[88:91], v[52:55]
    s_add_u32 m0, s35, 19744
    v_exp_f32 v48, v48
    v_mfma_f32_16x16x32_bf16 v[52:55], a[188:191], a[92:95], v[52:55]
    buffer_load_dwordx4 v5, s[20:23], s33 offen offset:1024 lds
    v_mfma_f32_16x16x32_bf16 v[56:59], a[188:191], a[124:127], v[36:39]
    s_mov_b32 m0, s36
    v_exp_f32 v49, v49
    v_mfma_f32_16x16x32_bf16 v[56:59], a[184:187], a[120:123], v[56:59]
    s_cmp_eq_u32 s31, 1
    s_cselect_b32 s18, 0, s18
    ds_write_addtid_b32 v65 offset:256
    v_cvt_pk_bf16_f32 v68, v48, v49
    v_mfma_f32_16x16x32_bf16 v[56:59], a[180:183], a[116:119], v[56:59]
    v_exp_f32 v50, v50
    v_mfma_f32_16x16x32_bf16 v[56:59], a[176:179], a[112:115], v[56:59]
    v_exp_f32 v51, v51
    v_mfma_f32_16x16x32_bf16 v[56:59], a[172:175], a[108:111], v[56:59]
    ds_write_addtid_b32 v68 offset:512
    v_cvt_pk_bf16_f32 v69, v50, v51
    v_mfma_f32_16x16x32_bf16 v[56:59], a[168:171], a[104:107], v[56:59]
    v_exp_f32 v52, v52
    v_mfma_f32_16x16x32_bf16 v[56:59], a[164:167], a[100:103], v[56:59]
    v_exp_f32 v53, v53
    v_mfma_f32_16x16x32_bf16 v[56:59], a[160:163], a[96:99], v[56:59]
    s_waitcnt lgkmcnt(3)
    ds_write_addtid_b32 v69 offset:768
    v_cvt_pk_bf16_f32 v72, v52, v53
    v_mfma_f32_16x16x32_bf16 v[144:147], v[96:99], a[192:195], v[144:147]
    s_add_u32 m0, s35, 21296
    v_add_f32 v9, v48, v9
    v_add_f32 v10, v52, v10
    v_mfma_f32_16x16x32_bf16 v[144:147], v[112:115], a[196:199], v[144:147]
    buffer_load_dwordx4 v5, s[20:23], s33 offen offset:1536 lds
    v_mfma_f32_16x16x32_bf16 v[176:179], v[100:103], a[192:195], v[176:179]
    s_add_u32 s33, s33, s49
    v_exp_f32 v54, v54
    v_mfma_f32_16x16x32_bf16 v[176:179], v[116:119], a[196:199], v[176:179]
    s_mov_b32 m0, s36
    v_exp_f32 v55, v55
    v_mfma_f32_16x16x32_bf16 v[208:211], v[104:107], a[192:195], v[208:211]
    ds_write_addtid_b32 v72 offset:1024
    v_cvt_pk_bf16_f32 v73, v54, v55
    v_mfma_f32_16x16x32_bf16 v[208:211], v[120:123], a[196:199], v[208:211]
    v_exp_f32 v56, v56
    v_mfma_f32_16x16x32_bf16 v[240:243], v[108:111], a[192:195], v[240:243]
    v_exp_f32 v57, v57
    v_mfma_f32_16x16x32_bf16 v[240:243], v[124:127], a[196:199], v[240:243]
    ds_write_addtid_b32 v73 offset:1280
    v_cvt_pk_bf16_f32 v76, v56, v57
    v_mfma_f32_16x16x32_bf16 a[144:147], a[232:235], a[192:195], a[144:147]
    v_exp_f32 v58, v58
    v_mfma_f32_16x16x32_bf16 a[144:147], a[236:239], a[196:199], a[144:147]
    s_add_u32 m0, s34, 0
    v_add_f32 v11, v56, v11
    v_add_f32 v8, v45, v8
    v_mfma_f32_16x16x32_bf16 a[148:151], a[232:235], a[200:203], a[148:151]
    buffer_load_dwordx4 v4, s[16:19], s32 offen lds
    v_mfma_f32_16x16x32_bf16 a[148:151], a[236:239], a[204:207], a[148:151]
    s_mov_b32 m0, s36
    v_exp_f32 v59, v59
    v_mfma_f32_16x16x32_bf16 v[244:247], v[108:111], a[200:203], v[244:247]
    ds_write_addtid_b32 v76 offset:1536
    v_cvt_pk_bf16_f32 v77, v58, v59
    v_mfma_f32_16x16x32_bf16 v[244:247], v[124:127], a[204:207], v[244:247]
    v_add_f32 v9, v49, v9
    v_add_f32 v10, v53, v10
    v_mfma_f32_16x16x32_bf16 v[212:215], v[104:107], a[200:203], v[212:215]
    ds_write_addtid_b32 v77 offset:1792
    v_add_f32 v11, v57, v11
    v_mfma_f32_16x16x32_bf16 v[212:215], v[120:123], a[204:207], v[212:215]
    v_add_f32 v8, v46, v8
    v_add_f32 v9, v50, v9
    v_mfma_f32_16x16x32_bf16 v[180:183], v[100:103], a[200:203], v[180:183]
    v_add_f32 v10, v54, v10
    v_add_f32 v11, v58, v11
    v_mfma_f32_16x16x32_bf16 v[180:183], v[116:119], a[204:207], v[180:183]
    s_add_u32 m0, s34, 1568
    v_add_f32 v8, v47, v8
    v_add_f32 v9, v51, v9
    v_mfma_f32_16x16x32_bf16 v[148:151], v[96:99], a[200:203], v[148:151]
    buffer_load_dwordx4 v4, s[16:19], s32 offen offset:512 lds
    v_mfma_f32_16x16x32_bf16 v[148:151], v[112:115], a[204:207], v[148:151]
    v_add_f32 v10, v55, v10
    v_add_f32 v11, v59, v11
    v_mfma_f32_16x16x32_bf16 v[152:155], v[96:99], a[208:211], v[152:155]
    v_mfma_f32_16x16x32_bf16 v[152:155], v[112:115], a[212:215], v[152:155]
    ds_read_b128 a[160:163], v1 offset:16640
    v_mfma_f32_16x16x32_bf16 v[184:187], v[100:103], a[208:211], v[184:187]
    ds_read_b128 a[164:167], v1 offset:16704
    v_mfma_f32_16x16x32_bf16 v[184:187], v[116:119], a[212:215], v[184:187]
    ds_read_b128 a[168:171], v1 offset:16768
    v_mfma_f32_16x16x32_bf16 v[216:219], v[104:107], a[208:211], v[216:219]
    ds_read_b128 a[172:175], v1 offset:16832
    v_mfma_f32_16x16x32_bf16 v[216:219], v[120:123], a[212:215], v[216:219]
    ds_read_b128 a[176:179], v1 offset:16896
    v_mfma_f32_16x16x32_bf16 v[248:251], v[108:111], a[208:211], v[248:251]
    s_add_u32 m0, s34, 3136
    ds_read_b128 a[180:183], v1 offset:16960
    v_mfma_f32_16x16x32_bf16 v[248:251], v[124:127], a[212:215], v[248:251]
    buffer_load_dwordx4 v4, s[16:19], s32 offen offset:1024 lds
    v_mfma_f32_16x16x32_bf16 a[152:155], a[232:235], a[208:211], a[152:155]
    ds_read_b128 a[184:187], v1 offset:17024
    v_mfma_f32_16x16x32_bf16 a[152:155], a[236:239], a[212:215], a[152:155]
    ds_read_b128 a[188:191], v1 offset:17088
    v_mfma_f32_16x16x32_bf16 a[156:159], a[232:235], a[216:219], a[156:159]
    ds_read_b64_tr_b16 a[192:193], v2 offset:49920
    v_mfma_f32_16x16x32_bf16 a[156:159], a[236:239], a[220:223], a[156:159]
    ds_read_b64_tr_b16 a[194:195], v3 offset:49920
    v_mfma_f32_16x16x32_bf16 v[252:255], v[108:111], a[216:219], v[252:255]
    ds_read_b64_tr_b16 a[200:201], v2 offset:49936
    v_mfma_f32_16x16x32_bf16 v[252:255], v[124:127], a[220:223], v[252:255]
    v_mfma_f32_16x16x32_bf16 v[220:223], v[104:107], a[216:219], v[220:223]
    s_add_u32 m0, s34, 4704
    ds_read_b64_tr_b16 a[202:203], v3 offset:49936
    v_mfma_f32_16x16x32_bf16 v[220:223], v[120:123], a[220:223], v[220:223]
    buffer_load_dwordx4 v4, s[16:19], s32 offen offset:1536 lds
    v_mfma_f32_16x16x32_bf16 v[188:191], v[100:103], a[216:219], v[188:191]
    s_add_u32 s32, s32, s49
    ds_read_b64_tr_b16 a[208:209], v2 offset:49952
    v_mfma_f32_16x16x32_bf16 v[188:191], v[116:119], a[220:223], v[188:191]
    ds_read_b64_tr_b16 a[210:211], v3 offset:49952
    v_mfma_f32_16x16x32_bf16 v[156:159], v[96:99], a[216:219], v[156:159]
    s_waitcnt vmcnt(12) lgkmcnt(6)
    ds_read_b64_tr_b16 a[216:217], v2 offset:49968
    v_mfma_f32_16x16x32_bf16 v[156:159], v[112:115], a[220:223], v[156:159]
    s_barrier
    ds_read_b64_tr_b16 a[218:219], v3 offset:49968
    v_mfma_f32_16x16x32_bf16 v[44:47], a[160:163], a[0:3], v[24:27]
    ds_read_b64_tr_b16 a[196:197], v2 offset:0
    v_mfma_f32_16x16x32_bf16 v[44:47], a[164:167], a[4:7], v[44:47]
    ds_read2st64_b32 v[66:67], v6 offset0:20 offset1:21
    v_mfma_f32_16x16x32_bf16 v[44:47], a[168:171], a[8:11], v[44:47]
    ds_read_b64_tr_b16 a[198:199], v3 offset:0
    v_mfma_f32_16x16x32_bf16 v[44:47], a[172:175], a[12:15], v[44:47]
    ds_read2st64_b32 v[70:71], v6 offset0:22 offset1:23
    v_mfma_f32_16x16x32_bf16 v[44:47], a[176:179], a[16:19], v[44:47]
    s_add_u32 m0, s35, 33280
    ds_read2st64_b32 v[74:75], v6 offset0:24 offset1:25
    v_mfma_f32_16x16x32_bf16 v[44:47], a[180:183], a[20:23], v[44:47]
    buffer_load_dwordx4 v5, s[20:23], s33 offen lds
    v_mfma_f32_16x16x32_bf16 v[44:47], a[184:187], a[24:27], v[44:47]
    ds_read2st64_b32 v[78:79], v6 offset0:26 offset1:27
    v_mfma_f32_16x16x32_bf16 v[44:47], a[188:191], a[28:31], v[44:47]
    ds_read2st64_b32 a[224:225], v7 offset0:8 offset1:9
    v_mfma_f32_16x16x32_bf16 v[48:51], a[188:191], a[60:63], v[28:31]
    ds_read2st64_b32 a[226:227], v6 offset0:8 offset1:9
    v_mfma_f32_16x16x32_bf16 v[48:51], a[184:187], a[56:59], v[48:51]
    ds_read_b64_tr_b16 a[204:205], v2 offset:16
    v_mfma_f32_16x16x32_bf16 v[48:51], a[180:183], a[52:55], v[48:51]
    ds_read_b64_tr_b16 a[206:207], v3 offset:16
    v_mfma_f32_16x16x32_bf16 v[48:51], a[176:179], a[48:51], v[48:51]
    ds_read_b64_tr_b16 a[212:213], v2 offset:32
    v_mfma_f32_16x16x32_bf16 v[48:51], a[172:175], a[44:47], v[48:51]
    ds_read_b64_tr_b16 a[214:215], v3 offset:32
    v_mfma_f32_16x16x32_bf16 v[48:51], a[168:171], a[40:43], v[48:51]
    s_add_u32 m0, s35, 34832
    ds_read_b64_tr_b16 a[220:221], v2 offset:48
    v_mfma_f32_16x16x32_bf16 v[48:51], a[164:167], a[36:39], v[48:51]
    buffer_load_dwordx4 v5, s[20:23], s33 offen offset:512 lds
    v_mfma_f32_16x16x32_bf16 v[48:51], a[160:163], a[32:35], v[48:51]
    ds_read_b64_tr_b16 a[222:223], v3 offset:48
    v_mfma_f32_16x16x32_bf16 v[52:55], a[160:163], a[64:67], v[32:35]
    v_exp_f32 v44, v44
    v_mfma_f32_16x16x32_bf16 v[52:55], a[164:167], a[68:71], v[52:55]
    v_exp_f32 v45, v45
    v_mfma_f32_16x16x32_bf16 v[52:55], a[168:171], a[72:75], v[52:55]
    v_cvt_pk_bf16_f32 v80, v44, v45
    v_add_f32 v8, v44, v8
    v_mfma_f32_16x16x32_bf16 v[52:55], a[172:175], a[76:79], v[52:55]
    v_exp_f32 v46, v46
    v_mfma_f32_16x16x32_bf16 v[52:55], a[176:179], a[80:83], v[52:55]
    s_mov_b32 m0, s36
    v_exp_f32 v47, v47
    v_mfma_f32_16x16x32_bf16 v[52:55], a[180:183], a[84:87], v[52:55]
    ds_write_addtid_b32 v80 offset:10240
    v_cvt_pk_bf16_f32 v81, v46, v47
    v_mfma_f32_16x16x32_bf16 v[52:55], a[184:187], a[88:91], v[52:55]
    s_add_u32 m0, s35, 36384
    v_exp_f32 v48, v48
    v_mfma_f32_16x16x32_bf16 v[52:55], a[188:191], a[92:95], v[52:55]
    buffer_load_dwordx4 v5, s[20:23], s33 offen offset:1024 lds
    v_mfma_f32_16x16x32_bf16 v[56:59], a[188:191], a[124:127], v[36:39]
    s_mov_b32 m0, s36
    v_exp_f32 v49, v49
    v_mfma_f32_16x16x32_bf16 v[56:59], a[184:187], a[120:123], v[56:59]
    ds_write_addtid_b32 v81 offset:10496
    v_cvt_pk_bf16_f32 v84, v48, v49
    v_mfma_f32_16x16x32_bf16 v[56:59], a[180:183], a[116:119], v[56:59]
    v_exp_f32 v50, v50
    v_mfma_f32_16x16x32_bf16 v[56:59], a[176:179], a[112:115], v[56:59]
    v_exp_f32 v51, v51
    v_mfma_f32_16x16x32_bf16 v[56:59], a[172:175], a[108:111], v[56:59]
    ds_write_addtid_b32 v84 offset:10752
    v_cvt_pk_bf16_f32 v85, v50, v51
    v_mfma_f32_16x16x32_bf16 v[56:59], a[168:171], a[104:107], v[56:59]
    v_exp_f32 v52, v52
    v_mfma_f32_16x16x32_bf16 v[56:59], a[164:167], a[100:103], v[56:59]
    v_exp_f32 v53, v53
    v_mfma_f32_16x16x32_bf16 v[56:59], a[160:163], a[96:99], v[56:59]
    s_waitcnt lgkmcnt(3)
    ds_write_addtid_b32 v85 offset:11008
    v_cvt_pk_bf16_f32 v88, v52, v53
    v_mfma_f32_16x16x32_bf16 v[128:131], v[112:115], a[192:195], v[128:131]
    s_add_u32 m0, s35, 37936
    v_add_f32 v9, v48, v9
    v_add_f32 v10, v52, v10
    v_mfma_f32_16x16x32_bf16 v[128:131], v[64:67], a[196:199], v[128:131]
    buffer_load_dwordx4 v5, s[20:23], s33 offen offset:1536 lds
    v_mfma_f32_16x16x32_bf16 v[160:163], v[116:119], a[192:195], v[160:163]
    s_add_u32 s33, s33, s49
    v_exp_f32 v54, v54
    v_mfma_f32_16x16x32_bf16 v[160:163], v[68:71], a[196:199], v[160:163]
    s_mov_b32 m0, s36
    v_exp_f32 v55, v55
    v_mfma_f32_16x16x32_bf16 v[192:195], v[120:123], a[192:195], v[192:195]
    ds_write_addtid_b32 v88 offset:11264
    v_cvt_pk_bf16_f32 v89, v54, v55
    v_mfma_f32_16x16x32_bf16 v[192:195], v[72:75], a[196:199], v[192:195]
    v_exp_f32 v56, v56
    v_mfma_f32_16x16x32_bf16 v[224:227], v[124:127], a[192:195], v[224:227]
    v_exp_f32 v57, v57
    v_mfma_f32_16x16x32_bf16 v[224:227], v[76:79], a[196:199], v[224:227]
    ds_write_addtid_b32 v89 offset:11520
    v_cvt_pk_bf16_f32 v92, v56, v57
    v_mfma_f32_16x16x32_bf16 a[128:131], a[236:239], a[192:195], a[128:131]
    v_exp_f32 v58, v58
    v_mfma_f32_16x16x32_bf16 a[128:131], a[224:227], a[196:199], a[128:131]
    s_add_u32 m0, s34, 16640
    v_add_f32 v11, v56, v11
    v_add_f32 v8, v45, v8
    v_mfma_f32_16x16x32_bf16 a[132:135], a[236:239], a[200:203], a[132:135]
    buffer_load_dwordx4 v4, s[16:19], s32 offen lds
    v_mfma_f32_16x16x32_bf16 a[132:135], a[224:227], a[204:207], a[132:135]
    s_mov_b32 m0, s36
    v_exp_f32 v59, v59
    v_mfma_f32_16x16x32_bf16 v[228:231], v[124:127], a[200:203], v[228:231]
    ds_write_addtid_b32 v92 offset:11776
    v_cvt_pk_bf16_f32 v93, v58, v59
    v_mfma_f32_16x16x32_bf16 v[228:231], v[76:79], a[204:207], v[228:231]
    v_add_f32 v9, v49, v9
    v_add_f32 v10, v53, v10
    v_mfma_f32_16x16x32_bf16 v[196:199], v[120:123], a[200:203], v[196:199]
    ds_write_addtid_b32 v93 offset:12032
    v_add_f32 v11, v57, v11
    v_mfma_f32_16x16x32_bf16 v[196:199], v[72:75], a[204:207], v[196:199]
    v_add_f32 v8, v46, v8
    v_add_f32 v9, v50, v9
    v_mfma_f32_16x16x32_bf16 v[164:167], v[116:119], a[200:203], v[164:167]
    v_add_f32 v10, v54, v10
    v_add_f32 v11, v58, v11
    v_mfma_f32_16x16x32_bf16 v[164:167], v[68:71], a[204:207], v[164:167]
    s_add_u32 m0, s34, 18208
    v_add_f32 v8, v47, v8
    v_add_f32 v9, v51, v9
    v_mfma_f32_16x16x32_bf16 v[132:135], v[112:115], a[200:203], v[132:135]
    buffer_load_dwordx4 v4, s[16:19], s32 offen offset:512 lds
    v_mfma_f32_16x16x32_bf16 v[132:135], v[64:67], a[204:207], v[132:135]
    s_sub_u32 s31, s31, 1
    v_add_f32 v10, v55, v10
    v_add_f32 v11, v59, v11
    v_mfma_f32_16x16x32_bf16 v[136:139], v[112:115], a[208:211], v[136:139]
    v_mfma_f32_16x16x32_bf16 v[136:139], v[64:67], a[212:215], v[136:139]
    ds_read_b128 a[160:163], v1 offset:33280
    v_mfma_f32_16x16x32_bf16 v[168:171], v[116:119], a[208:211], v[168:171]
    ds_read_b128 a[164:167], v1 offset:33344
    v_mfma_f32_16x16x32_bf16 v[168:171], v[68:71], a[212:215], v[168:171]
    ds_read_b128 a[168:171], v1 offset:33408
    v_mfma_f32_16x16x32_bf16 v[200:203], v[120:123], a[208:211], v[200:203]
    ds_read_b128 a[172:175], v1 offset:33472
    v_mfma_f32_16x16x32_bf16 v[200:203], v[72:75], a[212:215], v[200:203]
    ds_read_b128 a[176:179], v1 offset:33536
    v_mfma_f32_16x16x32_bf16 v[232:235], v[124:127], a[208:211], v[232:235]
    s_add_u32 m0, s34, 19776
    ds_read_b128 a[180:183], v1 offset:33600
    v_mfma_f32_16x16x32_bf16 v[232:235], v[76:79], a[212:215], v[232:235]
    buffer_load_dwordx4 v4, s[16:19], s32 offen offset:1024 lds
    v_mfma_f32_16x16x32_bf16 a[136:139], a[236:239], a[208:211], a[136:139]
    ds_read_b128 a[184:187], v1 offset:33664
    v_mfma_f32_16x16x32_bf16 a[136:139], a[224:227], a[212:215], a[136:139]
    ds_read_b128 a[188:191], v1 offset:33728
    v_mfma_f32_16x16x32_bf16 a[140:143], a[236:239], a[216:219], a[140:143]
    ds_read_b64_tr_b16 a[192:193], v2 offset:128
    v_mfma_f32_16x16x32_bf16 a[140:143], a[224:227], a[220:223], a[140:143]
    ds_read_b64_tr_b16 a[194:195], v3 offset:128
    v_mfma_f32_16x16x32_bf16 v[236:239], v[124:127], a[216:219], v[236:239]
    ds_read_b64_tr_b16 a[200:201], v2 offset:144
    v_mfma_f32_16x16x32_bf16 v[236:239], v[76:79], a[220:223], v[236:239]
    v_mfma_f32_16x16x32_bf16 v[204:207], v[120:123], a[216:219], v[204:207]
    s_add_u32 m0, s34, 21344
    ds_read_b64_tr_b16 a[202:203], v3 offset:144
    v_mfma_f32_16x16x32_bf16 v[204:207], v[72:75], a[220:223], v[204:207]
    buffer_load_dwordx4 v4, s[16:19], s32 offen offset:1536 lds
    v_mfma_f32_16x16x32_bf16 v[172:175], v[116:119], a[216:219], v[172:175]
    s_add_u32 s32, s32, s49
    ds_read_b64_tr_b16 a[208:209], v2 offset:160
    v_mfma_f32_16x16x32_bf16 v[172:175], v[68:71], a[220:223], v[172:175]
    s_cmp_lg_u32 s31, 0
    ds_read_b64_tr_b16 a[210:211], v3 offset:160
    v_mfma_f32_16x16x32_bf16 v[140:143], v[112:115], a[216:219], v[140:143]
    s_waitcnt vmcnt(12) lgkmcnt(6)
    ds_read_b64_tr_b16 a[216:217], v2 offset:176
    v_mfma_f32_16x16x32_bf16 v[140:143], v[64:67], a[220:223], v[140:143]
    s_barrier
    ds_read_b64_tr_b16 a[218:219], v3 offset:176
    s_cbranch_scc1 L_loop1
    v_mfma_f32_16x16x32_bf16 v[44:47], a[160:163], a[0:3], v[24:27]
    ds_read_b64_tr_b16 a[196:197], v2 offset:16640
    v_mfma_f32_16x16x32_bf16 v[44:47], a[164:167], a[4:7], v[44:47]
    ds_read2st64_b32 v[82:83], v6 offset0:60 offset1:61
    v_mfma_f32_16x16x32_bf16 v[44:47], a[168:171], a[8:11], v[44:47]
    s_add_u32 m0, s35, 49920
    ds_read_b64_tr_b16 a[198:199], v3 offset:16640
    v_mfma_f32_16x16x32_bf16 v[44:47], a[172:175], a[12:15], v[44:47]
    buffer_load_dwordx4 v5, s[20:23], s33 offen lds
    v_mfma_f32_16x16x32_bf16 v[44:47], a[176:179], a[16:19], v[44:47]
    ds_read2st64_b32 v[86:87], v6 offset0:62 offset1:63
    v_mfma_f32_16x16x32_bf16 v[44:47], a[180:183], a[20:23], v[44:47]
    ds_read2st64_b32 v[90:91], v6 offset0:64 offset1:65
    v_mfma_f32_16x16x32_bf16 v[44:47], a[184:187], a[24:27], v[44:47]
    s_add_u32 m0, s35, 51472
    ds_read2st64_b32 v[94:95], v6 offset0:66 offset1:67
    v_mfma_f32_16x16x32_bf16 v[44:47], a[188:191], a[28:31], v[44:47]
    buffer_load_dwordx4 v5, s[20:23], s33 offen offset:512 lds
    v_mfma_f32_16x16x32_bf16 v[48:51], a[188:191], a[60:63], v[28:31]
    ds_read2st64_b32 a[228:229], v7 offset0:48 offset1:49
    v_mfma_f32_16x16x32_bf16 v[48:51], a[184:187], a[56:59], v[48:51]
    ds_read2st64_b32 a[230:231], v6 offset0:48 offset1:49
    v_mfma_f32_16x16x32_bf16 v[48:51], a[180:183], a[52:55], v[48:51]
    s_add_u32 m0, s35, 53024
    ds_read_b64_tr_b16 a[204:205], v2 offset:16656
    v_mfma_f32_16x16x32_bf16 v[48:51], a[176:179], a[48:51], v[48:51]
    buffer_load_dwordx4 v5, s[20:23], s33 offen offset:1024 lds
    v_mfma_f32_16x16x32_bf16 v[48:51], a[172:175], a[44:47], v[48:51]
    v_exp_f32 v44, v44
    v_mfma_f32_16x16x32_bf16 v[48:51], a[168:171], a[40:43], v[48:51]
    v_exp_f32 v45, v45
    v_mfma_f32_16x16x32_bf16 v[48:51], a[164:167], a[36:39], v[48:51]
    s_add_u32 m0, s35, 54576
    v_exp_f32 v46, v46
    v_mfma_f32_16x16x32_bf16 v[48:51], a[160:163], a[32:35], v[48:51]
    buffer_load_dwordx4 v5, s[20:23], s33 offen offset:1536 lds
    v_mfma_f32_16x16x32_bf16 v[52:55], a[160:163], a[64:67], v[32:35]
    s_add_u32 s33, s33, s49
    v_exp_f32 v47, v47
    v_mfma_f32_16x16x32_bf16 v[52:55], a[164:167], a[68:71], v[52:55]
    s_mov_b32 m0, s36
    ds_read_b64_tr_b16 a[206:207], v3 offset:16656
    v_cvt_pk_bf16_f32 v96, v44, v45
    v_mfma_f32_16x16x32_bf16 v[52:55], a[168:171], a[72:75], v[52:55]
    ds_write_addtid_b32 v96 offset:0
    v_cvt_pk_bf16_f32 v97, v46, v47
    v_mfma_f32_16x16x32_bf16 v[52:55], a[172:175], a[76:79], v[52:55]
    v_exp_f32 v48, v48
    v_mfma_f32_16x16x32_bf16 v[52:55], a[176:179], a[80:83], v[52:55]
    v_exp_f32 v49, v49
    v_mfma_f32_16x16x32_bf16 v[52:55], a[180:183], a[84:87], v[52:55]
    v_exp_f32 v50, v50
    v_mfma_f32_16x16x32_bf16 v[52:55], a[184:187], a[88:91], v[52:55]
    ds_write_addtid_b32 v97 offset:256
    v_cvt_pk_bf16_f32 v100, v48, v49
    v_mfma_f32_16x16x32_bf16 v[52:55], a[188:191], a[92:95], v[52:55]
    v_exp_f32 v51, v51
    v_mfma_f32_16x16x32_bf16 v[56:59], a[188:191], a[124:127], v[36:39]
    ds_read_b64_tr_b16 a[212:213], v2 offset:16672
    v_cvt_pk_bf16_f32 v101, v50, v51
    v_mfma_f32_16x16x32_bf16 v[56:59], a[184:187], a[120:123], v[56:59]
    ds_read_b64_tr_b16 a[214:215], v3 offset:16672
    v_add_f32 v8, v44, v8
    v_mfma_f32_16x16x32_bf16 v[56:59], a[180:183], a[116:119], v[56:59]
    ds_write_addtid_b32 v100 offset:512
    v_add_f32 v9, v48, v9
    v_mfma_f32_16x16x32_bf16 v[56:59], a[176:179], a[112:115], v[56:59]
    v_exp_f32 v52, v52
    v_mfma_f32_16x16x32_bf16 v[56:59], a[172:175], a[108:111], v[56:59]
    v_exp_f32 v53, v53
    v_mfma_f32_16x16x32_bf16 v[56:59], a[168:171], a[104:107], v[56:59]
    v_exp_f32 v54, v54
    v_mfma_f32_16x16x32_bf16 v[56:59], a[164:167], a[100:103], v[56:59]
    ds_write_addtid_b32 v101 offset:768
    v_cvt_pk_bf16_f32 v104, v52, v53
    v_mfma_f32_16x16x32_bf16 v[56:59], a[160:163], a[96:99], v[56:59]
    s_waitcnt lgkmcnt(6)
    ds_read_b128 a[160:163], v1 offset:49920
    v_add_f32 v8, v45, v8
    v_mfma_f32_16x16x32_bf16 v[128:131], v[80:83], a[196:199], v[128:131]
    v_exp_f32 v55, v55
    v_mfma_f32_16x16x32_bf16 v[160:163], v[84:87], a[196:199], v[160:163]
    ds_read_b128 a[164:167], v1 offset:49984
    v_cvt_pk_bf16_f32 v105, v54, v55
    v_mfma_f32_16x16x32_bf16 v[192:195], v[88:91], a[196:199], v[192:195]
    ds_read_b128 a[168:171], v1 offset:50048
    v_add_f32 v9, v49, v9
    v_mfma_f32_16x16x32_bf16 v[224:227], v[92:95], a[196:199], v[224:227]
    v_exp_f32 v56, v56
    v_mfma_f32_16x16x32_bf16 a[128:131], a[228:231], a[196:199], a[128:131]
    ds_read_b64_tr_b16 a[220:221], v2 offset:16688
    v_add_f32 v8, v46, v8
    v_mfma_f32_16x16x32_bf16 a[132:135], a[228:231], a[204:207], a[132:135]
    ds_read_b128 a[172:175], v1 offset:50112
    v_add_f32 v9, v50, v9
    v_mfma_f32_16x16x32_bf16 v[228:231], v[92:95], a[204:207], v[228:231]
    v_exp_f32 v57, v57
    v_mfma_f32_16x16x32_bf16 v[196:199], v[88:91], a[204:207], v[196:199]
    ds_read_b64_tr_b16 a[222:223], v3 offset:16688
    v_cvt_pk_bf16_f32 v108, v56, v57
    v_mfma_f32_16x16x32_bf16 v[164:167], v[84:87], a[204:207], v[164:167]
    ds_read_b128 a[176:179], v1 offset:50176
    v_add_f32 v8, v47, v8
    v_mfma_f32_16x16x32_bf16 v[132:135], v[80:83], a[204:207], v[132:135]
    s_waitcnt lgkmcnt(6)
    ds_write_addtid_b32 v104 offset:1024
    v_add_f32 v9, v51, v9
    v_mfma_f32_16x16x32_bf16 v[136:139], v[80:83], a[212:215], v[136:139]
    v_exp_f32 v58, v58
    v_mfma_f32_16x16x32_bf16 v[168:171], v[84:87], a[212:215], v[168:171]
    ds_read_b128 a[180:183], v1 offset:50240
    v_mfma_f32_16x16x32_bf16 v[200:203], v[88:91], a[212:215], v[200:203]
    ds_write_addtid_b32 v105 offset:1280
    v_mfma_f32_16x16x32_bf16 v[232:235], v[92:95], a[212:215], v[232:235]
    v_exp_f32 v59, v59
    v_mfma_f32_16x16x32_bf16 a[136:139], a[228:231], a[212:215], a[136:139]
    s_waitcnt lgkmcnt(4)
    ds_read_b128 a[184:187], v1 offset:50304
    v_cvt_pk_bf16_f32 v109, v58, v59
    v_mfma_f32_16x16x32_bf16 a[140:143], a[228:231], a[220:223], a[140:143]
    ds_read_b128 a[188:191], v1 offset:50368
    v_mfma_f32_16x16x32_bf16 v[236:239], v[92:95], a[220:223], v[236:239]
    ds_write_addtid_b32 v108 offset:1536
    ds_write_addtid_b32 v109 offset:1792
    v_mfma_f32_16x16x32_bf16 v[204:207], v[88:91], a[220:223], v[204:207]
    v_mfma_f32_16x16x32_bf16 v[172:175], v[84:87], a[220:223], v[172:175]
    s_waitcnt vmcnt(0) lgkmcnt(0)
    v_mfma_f32_16x16x32_bf16 v[140:143], v[80:83], a[220:223], v[140:143]
    s_barrier
    v_mfma_f32_16x16x32_bf16 v[44:47], a[160:163], a[0:3], v[24:27]
    ds_read_b64_tr_b16 a[192:193], v2 offset:33280
    v_add_f32 v10, v52, v10
    v_mfma_f32_16x16x32_bf16 v[44:47], a[164:167], a[4:7], v[44:47]
    ds_read2st64_b32 v[98:99], v6 offset0:20 offset1:21
    v_add_f32 v10, v53, v10
    v_mfma_f32_16x16x32_bf16 v[44:47], a[168:171], a[8:11], v[44:47]
    ds_read_b64_tr_b16 a[194:195], v3 offset:33280
    v_add_f32 v10, v54, v10
    v_mfma_f32_16x16x32_bf16 v[44:47], a[172:175], a[12:15], v[44:47]
    ds_read2st64_b32 v[102:103], v6 offset0:22 offset1:23
    v_add_f32 v10, v55, v10
    v_mfma_f32_16x16x32_bf16 v[44:47], a[176:179], a[16:19], v[44:47]
    ds_read_b64_tr_b16 a[196:197], v2 offset:33296
    v_add_f32 v11, v56, v11
    v_mfma_f32_16x16x32_bf16 v[44:47], a[180:183], a[20:23], v[44:47]
    ds_read_b64_tr_b16 a[198:199], v3 offset:33296
    v_add_f32 v11, v57, v11
    v_mfma_f32_16x16x32_bf16 v[44:47], a[184:187], a[24:27], v[44:47]
    ds_read_b64_tr_b16 a[200:201], v2 offset:33312
    v_add_f32 v11, v58, v11
    v_mfma_f32_16x16x32_bf16 v[44:47], a[188:191], a[28:31], v[44:47]
    ds_read_b64_tr_b16 a[202:203], v3 offset:33312
    v_add_f32 v11, v59, v11
    v_mfma_f32_16x16x32_bf16 v[48:51], a[160:163], a[32:35], v[28:31]
    ds_read_b64_tr_b16 a[204:205], v2 offset:33328
    v_mfma_f32_16x16x32_bf16 v[48:51], a[164:167], a[36:39], v[48:51]
    ds_read_b64_tr_b16 a[206:207], v3 offset:33328
    v_mfma_f32_16x16x32_bf16 v[48:51], a[168:171], a[40:43], v[48:51]
    ds_read_b64_tr_b16 a[208:209], v2 offset:49920
    v_mfma_f32_16x16x32_bf16 v[48:51], a[172:175], a[44:47], v[48:51]
    v_exp_f32 v44, v44
    v_mfma_f32_16x16x32_bf16 v[48:51], a[176:179], a[48:51], v[48:51]
    v_exp_f32 v45, v45
    v_mfma_f32_16x16x32_bf16 v[48:51], a[180:183], a[52:55], v[48:51]
    v_exp_f32 v46, v46
    v_mfma_f32_16x16x32_bf16 v[48:51], a[184:187], a[56:59], v[48:51]
    v_exp_f32 v47, v47
    v_mfma_f32_16x16x32_bf16 v[48:51], a[188:191], a[60:63], v[48:51]
    s_mov_b32 m0, s36
    ds_read_b64_tr_b16 a[210:211], v3 offset:49920
    v_cvt_pk_bf16_f32 v112, v44, v45
    v_mfma_f32_16x16x32_bf16 v[52:55], a[160:163], a[64:67], v[32:35]
    ds_write_addtid_b32 v112 offset:10240
    v_cvt_pk_bf16_f32 v113, v46, v47
    v_mfma_f32_16x16x32_bf16 v[52:55], a[164:167], a[68:71], v[52:55]
    ds_write_addtid_b32 v113 offset:10496
    v_add_f32 v8, v44, v8
    v_mfma_f32_16x16x32_bf16 v[52:55], a[168:171], a[72:75], v[52:55]
    ds_read_b64_tr_b16 a[212:213], v2 offset:49936
    v_add_f32 v8, v45, v8
    v_mfma_f32_16x16x32_bf16 v[52:55], a[172:175], a[76:79], v[52:55]
    v_exp_f32 v48, v48
    v_mfma_f32_16x16x32_bf16 v[52:55], a[176:179], a[80:83], v[52:55]
    v_exp_f32 v49, v49
    v_mfma_f32_16x16x32_bf16 v[52:55], a[180:183], a[84:87], v[52:55]
    v_exp_f32 v50, v50
    v_mfma_f32_16x16x32_bf16 v[52:55], a[184:187], a[88:91], v[52:55]
    v_exp_f32 v51, v51
    v_mfma_f32_16x16x32_bf16 v[52:55], a[188:191], a[92:95], v[52:55]
    s_waitcnt lgkmcnt(4)
    ds_read_b64_tr_b16 a[214:215], v3 offset:49936
    v_cvt_pk_bf16_f32 v116, v48, v49
    v_mfma_f32_16x16x32_bf16 v[128:131], v[96:99], a[192:195], v[128:131]
    ds_write_addtid_b32 v116 offset:10752
    v_cvt_pk_bf16_f32 v117, v50, v51
    v_mfma_f32_16x16x32_bf16 v[160:163], v[100:103], a[192:195], v[160:163]
    ds_write_addtid_b32 v117 offset:11008
    v_add_f32 v8, v46, v8
    v_mfma_f32_16x16x32_bf16 v[164:167], v[100:103], a[196:199], v[164:167]
    ds_read_b64_tr_b16 a[216:217], v2 offset:49952
    v_add_f32 v8, v47, v8
    v_add_f32 v9, v48, v9
    v_add_f32 v9, v49, v9
    v_add_f32 v9, v50, v9
    v_add_f32 v9, v51, v9
    v_mfma_f32_16x16x32_bf16 v[132:135], v[96:99], a[196:199], v[132:135]
    ds_write_addtid_b32 v8 offset:20480
    ds_write_addtid_b32 v9 offset:20736
    v_mfma_f32_16x16x32_bf16 v[136:139], v[96:99], a[200:203], v[136:139]
    ds_read_b64_tr_b16 a[218:219], v3 offset:49952
    v_mfma_f32_16x16x32_bf16 v[168:171], v[100:103], a[200:203], v[168:171]
    s_waitcnt lgkmcnt(1)
    ds_read_b64_tr_b16 a[220:221], v2 offset:49968
    v_mfma_f32_16x16x32_bf16 v[172:175], v[100:103], a[204:207], v[172:175]
    s_barrier
    ds_read2st64_b32 v[24:25], v6 offset0:100 offset1:101
    v_mfma_f32_16x16x32_bf16 v[140:143], v[96:99], a[204:207], v[140:143]
    ds_read2st64_b32 v[114:115], v6 offset0:60 offset1:61
    v_mfma_f32_16x16x32_bf16 v[56:59], a[160:163], a[96:99], v[36:39]
    ds_read2st64_b32 v[118:119], v6 offset0:62 offset1:63
    v_mfma_f32_16x16x32_bf16 v[56:59], a[164:167], a[100:103], v[56:59]
    ds_read_b64_tr_b16 a[222:223], v3 offset:49968
    v_mfma_f32_16x16x32_bf16 v[56:59], a[168:171], a[104:107], v[56:59]
    v_exp_f32 v52, v52
    v_mfma_f32_16x16x32_bf16 v[56:59], a[172:175], a[108:111], v[56:59]
    ds_read2st64_b32 v[106:107], v6 offset0:24 offset1:25
    v_add_f32 v10, v52, v10
    v_mfma_f32_16x16x32_bf16 v[56:59], a[176:179], a[112:115], v[56:59]
    s_waitcnt lgkmcnt(4)
    v_add_f32 v44, v8, v24
    v_add_f32 v45, v8, v24
    v_mfma_f32_16x16x32_bf16 v[56:59], a[180:183], a[116:119], v[56:59]
    s_nop 0
    v_permlane32_swap_b32 v44, v45
    v_add_f32 v24, v44, v45
    v_mfma_f32_16x16x32_bf16 v[56:59], a[184:187], a[120:123], v[56:59]
    v_add_f32 v45, v44, v45
    v_add_f32 v48, v9, v25
    v_mfma_f32_16x16x32_bf16 v[56:59], a[188:191], a[124:127], v[56:59]
    s_waitcnt lgkmcnt(3)
    ds_read2st64_b32 v[110:111], v6 offset0:26 offset1:27
    v_permlane16_swap_b32 v24, v45
    v_mfma_f32_16x16x32_bf16 v[128:131], v[112:115], a[208:211], v[128:131]
    ds_read2st64_b32 a[232:233], v7 offset0:8 offset1:9
    v_add_f32 v44, v24, v45
    v_mfma_f32_16x16x32_bf16 v[132:135], v[112:115], a[212:215], v[132:135]
    v_rcp_f32 v44, v44
    v_mfma_f32_16x16x32_bf16 v[136:139], v[112:115], a[216:219], v[136:139]
    s_waitcnt lgkmcnt(3)
    ds_write_addtid_b32 v44 offset:22016
    v_add_f32 v49, v9, v25
    v_mfma_f32_16x16x32_bf16 v[140:143], v[112:115], a[220:223], v[140:143]
    ds_read_b128 v[44:47], v21 offset:22016
    v_permlane32_swap_b32 v48, v49
    v_mfma_f32_16x16x32_bf16 v[160:163], v[116:119], a[208:211], v[160:163]
    ds_read2st64_b32 a[234:235], v6 offset0:8 offset1:9
    v_add_f32 v25, v48, v49
    v_mfma_f32_16x16x32_bf16 v[164:167], v[116:119], a[212:215], v[164:167]
    ds_read_b64_tr_b16 a[160:161], v2 offset:128
    v_add_f32 v49, v48, v49
    v_mfma_f32_16x16x32_bf16 v[168:171], v[116:119], a[216:219], v[168:171]
    s_nop 0
    v_permlane16_swap_b32 v25, v49
    v_add_f32 v48, v25, v49
    v_mfma_f32_16x16x32_bf16 v[172:175], v[116:119], a[220:223], v[172:175]
    s_waitcnt lgkmcnt(6)
    v_rcp_f32 v48, v48
    s_nop 0
    ds_write_addtid_b32 v48 offset:22272
L_pad1_3:
    s_cbranch_vccnz L_walked1
    ds_read_b128 v[48:51], v21 offset:22272
    s_waitcnt lgkmcnt(4)
    v_pk_mul_f32 v[128:129], v[128:129], v[44:45]
    v_pk_mul_f32 v[132:133], v[132:133], v[44:45]
    v_pk_mul_f32 v[136:137], v[136:137], v[44:45]
    v_pk_mul_f32 v[140:141], v[140:141], v[44:45]
    v_pk_mul_f32 v[130:131], v[130:131], v[46:47]
    v_pk_mul_f32 v[134:135], v[134:135], v[46:47]
    v_pk_mul_f32 v[138:139], v[138:139], v[46:47]
    v_pk_mul_f32 v[142:143], v[142:143], v[46:47]
    v_cvt_pk_bf16_f32 v128, v128, v132
    v_cvt_pk_bf16_f32 v129, v129, v133
    v_cvt_pk_bf16_f32 v130, v130, v134
    v_cvt_pk_bf16_f32 v131, v131, v135
    v_cvt_pk_bf16_f32 v136, v136, v140
    v_cvt_pk_bf16_f32 v137, v137, v141
    v_cvt_pk_bf16_f32 v138, v138, v142
    v_cvt_pk_bf16_f32 v139, v139, v143
    ds_write2_b32 v22, v128, v136 offset0:0 offset1:1
    ds_write2_b32 v22, v129, v137 offset0:36 offset1:37
    ds_write2_b32 v22, v130, v138 offset0:72 offset1:73
    ds_write2_b32 v22, v131, v139 offset0:108 offset1:109
    ds_read_b64_tr_b16 a[240:241], v23 offset:0
    ds_read_b64_tr_b16 a[242:243], v23 offset:32
    ds_read_b64_tr_b16 a[244:245], v23 offset:1152
    ds_read_b64_tr_b16 a[246:247], v23 offset:1184
    s_waitcnt lgkmcnt(8)
    v_pk_mul_f32 v[160:161], v[160:161], v[48:49]
    v_pk_mul_f32 v[164:165], v[164:165], v[48:49]
    v_pk_mul_f32 v[168:169], v[168:169], v[48:49]
    v_pk_mul_f32 v[172:173], v[172:173], v[48:49]
    v_pk_mul_f32 v[162:163], v[162:163], v[50:51]
    v_pk_mul_f32 v[166:167], v[166:167], v[50:51]
    v_pk_mul_f32 v[170:171], v[170:171], v[50:51]
    v_pk_mul_f32 v[174:175], v[174:175], v[50:51]
    v_cvt_pk_bf16_f32 v160, v160, v164
    v_cvt_pk_bf16_f32 v161, v161, v165
    v_cvt_pk_bf16_f32 v162, v162, v166
    v_cvt_pk_bf16_f32 v163, v163, v167
    v_cvt_pk_bf16_f32 v168, v168, v172
    v_cvt_pk_bf16_f32 v169, v169, v173
    v_cvt_pk_bf16_f32 v170, v170, v174
    v_cvt_pk_bf16_f32 v171, v171, v175
    s_waitcnt lgkmcnt(2)
    buffer_store_dwordx4 a[240:243], v13, s[24:27], 0 offen sc0 sc1
    s_waitcnt lgkmcnt(0)
    buffer_store_dwordx4 a[244:247], v13, s[24:27], s4 offen sc0 sc1
    ds_write2_b32 v22, v160, v168 offset0:0 offset1:1
    ds_write2_b32 v22, v161, v169 offset0:36 offset1:37
    ds_write2_b32 v22, v162, v170 offset0:72 offset1:73
    ds_write2_b32 v22, v163, v171 offset0:108 offset1:109
    ds_read_b64_tr_b16 a[248:249], v23 offset:0
    ds_read_b64_tr_b16 a[250:251], v23 offset:32
    ds_read_b64_tr_b16 a[252:253], v23 offset:1152
    ds_read_b64_tr_b16 a[254:255], v23 offset:1184
    v_mfma_f32_16x16x32_bf16 v[192:195], v[104:107], a[192:195], v[192:195]
    v_exp_f32 v53, v53
    v_mfma_f32_16x16x32_bf16 v[224:227], v[108:111], a[192:195], v[224:227]
    v_exp_f32 v54, v54
    v_mfma_f32_16x16x32_bf16 a[128:131], a[232:235], a[192:195], a[128:131]
    v_exp_f32 v55, v55
    v_mfma_f32_16x16x32_bf16 a[132:135], a[232:235], a[196:199], a[132:135]
    ds_read_b64_tr_b16 a[162:163], v3 offset:128
    v_add_f32 v10, v53, v10
    v_mfma_f32_16x16x32_bf16 v[228:231], v[108:111], a[196:199], v[228:231]
    ds_read_b64_tr_b16 a[164:165], v2 offset:144
    v_add_f32 v10, v54, v10
    v_mfma_f32_16x16x32_bf16 v[196:199], v[104:107], a[196:199], v[196:199]
    s_waitcnt lgkmcnt(4)
    buffer_store_dwordx4 a[248:251], v13, s[24:27], s48 offen sc0 sc1
    v_mfma_f32_16x16x32_bf16 v[200:203], v[104:107], a[200:203], v[200:203]
    s_waitcnt lgkmcnt(2)
    buffer_store_dwordx4 a[252:255], v13, s[24:27], s5 offen sc0 sc1
    v_mfma_f32_16x16x32_bf16 v[232:235], v[108:111], a[200:203], v[232:235]
    ds_read_b64_tr_b16 a[166:167], v3 offset:144
    v_add_f32 v10, v55, v10
    v_mfma_f32_16x16x32_bf16 a[136:139], a[232:235], a[200:203], a[136:139]
    v_exp_f32 v56, v56
    v_mfma_f32_16x16x32_bf16 a[140:143], a[232:235], a[204:207], a[140:143]
    ds_read_b64_tr_b16 a[168:169], v2 offset:160
    v_cvt_pk_bf16_f32 v120, v52, v53
    v_mfma_f32_16x16x32_bf16 v[236:239], v[108:111], a[204:207], v[236:239]
    v_exp_f32 v57, v57
    v_mfma_f32_16x16x32_bf16 v[204:207], v[104:107], a[204:207], v[204:207]
    s_waitcnt lgkmcnt(3)
    ds_write_addtid_b32 v120 offset:11264
    v_cvt_pk_bf16_f32 v121, v54, v55
    v_mfma_f32_16x16x32_bf16 v[144:147], v[64:67], a[160:163], v[144:147]
    v_exp_f32 v58, v58
    v_mfma_f32_16x16x32_bf16 v[176:179], v[68:71], a[160:163], v[176:179]
    ds_write_addtid_b32 v121 offset:11520
    v_add_f32 v11, v56, v11
    v_mfma_f32_16x16x32_bf16 v[208:211], v[72:75], a[160:163], v[208:211]
    v_exp_f32 v59, v59
    v_mfma_f32_16x16x32_bf16 v[240:243], v[76:79], a[160:163], v[240:243]
    ds_read_b64_tr_b16 a[170:171], v3 offset:160
    v_add_f32 v11, v57, v11
    v_add_f32 v11, v58, v11
    v_add_f32 v11, v59, v11
    v_mfma_f32_16x16x32_bf16 a[144:147], a[224:227], a[160:163], a[144:147]
    s_waitcnt lgkmcnt(4)
    ds_write_addtid_b32 v10 offset:20992
    v_max3_u32 v16, v8, v9, v10
    v_mfma_f32_16x16x32_bf16 a[148:151], a[224:227], a[164:167], a[148:151]
    ds_write_addtid_b32 v11 offset:21248
    v_max3_u32 v16, v16, v11, v11
    v_cvt_pk_bf16_f32 v124, v56, v57
    v_cvt_pk_bf16_f32 v125, v58, v59
    v_mfma_f32_16x16x32_bf16 v[244:247], v[76:79], a[164:167], v[244:247]
    ds_write_addtid_b32 v16 offset:21760
    ds_write_addtid_b32 v124 offset:11776
    ds_write_addtid_b32 v125 offset:12032
    v_mfma_f32_16x16x32_bf16 v[212:215], v[72:75], a[164:167], v[212:215]
    s_waitcnt lgkmcnt(5)
    ds_read_b64_tr_b16 a[172:173], v2 offset:176
    v_mfma_f32_16x16x32_bf16 v[180:183], v[68:71], a[164:167], v[180:183]
    s_waitcnt lgkmcnt(1)
    ds_read_b64_tr_b16 a[174:175], v3 offset:176
    v_mfma_f32_16x16x32_bf16 v[148:151], v[64:67], a[164:167], v[148:151]
    s_barrier
    ds_read2st64_b32 v[26:27], v6 offset0:102 offset1:103
    v_mfma_f32_16x16x32_bf16 v[152:155], v[64:67], a[168:171], v[152:155]
    ds_read2st64_b32 v[122:123], v6 offset0:64 offset1:65
    v_mfma_f32_16x16x32_bf16 v[184:187], v[68:71], a[168:171], v[184:187]
    ds_read2st64_b32 v[126:127], v6 offset0:66 offset1:67
    v_mfma_f32_16x16x32_bf16 v[216:219], v[72:75], a[168:171], v[216:219]
    ds_read_b32 v28, v6 offset:21504
    v_mfma_f32_16x16x32_bf16 v[248:251], v[76:79], a[168:171], v[248:251]
    ds_read_b32 v12, v7 offset:21504
    v_mfma_f32_16x16x32_bf16 a[152:155], a[224:227], a[168:171], a[152:155]
    s_waitcnt lgkmcnt(5)
    ds_read2st64_b32 a[236:237], v7 offset0:48 offset1:49
    v_mfma_f32_16x16x32_bf16 a[156:159], a[224:227], a[172:175], a[156:159]
    s_waitcnt lgkmcnt(5)
    v_add_f32 v52, v10, v26
    v_add_f32 v53, v10, v26
    v_mfma_f32_16x16x32_bf16 v[252:255], v[76:79], a[172:175], v[252:255]
    ds_read2st64_b32 a[238:239], v6 offset0:48 offset1:49
    v_permlane32_swap_b32 v52, v53
    v_mfma_f32_16x16x32_bf16 v[220:223], v[72:75], a[172:175], v[220:223]
    ds_read2st64_b32 v[30:31], v6 offset0:85 offset1:105
    v_add_f32 v26, v52, v53
    v_mfma_f32_16x16x32_bf16 v[188:191], v[68:71], a[172:175], v[188:191]
    ds_read2st64_b32 v[32:33], v7 offset0:85 offset1:105
    v_add_f32 v53, v52, v53
    v_mfma_f32_16x16x32_bf16 v[156:159], v[64:67], a[172:175], v[156:159]
    s_waitcnt lgkmcnt(7)
    v_permlane16_swap_b32 v26, v53
    v_add_f32 v52, v26, v53
    v_mfma_f32_16x16x32_bf16 v[192:195], v[120:123], a[208:211], v[192:195]
    v_rcp_f32 v52, v52
    v_mfma_f32_16x16x32_bf16 v[196:199], v[120:123], a[212:215], v[196:199]
    ds_write_addtid_b32 v52 offset:22528
    v_add_f32 v56, v11, v27
    v_mfma_f32_16x16x32_bf16 v[200:203], v[120:123], a[216:219], v[200:203]
    ds_read_b128 v[52:55], v21 offset:22528
    v_add_f32 v57, v11, v27
    v_mfma_f32_16x16x32_bf16 v[204:207], v[120:123], a[220:223], v[204:207]
    s_waitcnt lgkmcnt(5)
    ds_read_b64_tr_b16 a[176:177], v2 offset:16768
    v_permlane32_swap_b32 v56, v57
    v_mfma_f32_16x16x32_bf16 v[224:227], v[124:127], a[208:211], v[224:227]
    ds_read_b64_tr_b16 a[178:179], v3 offset:16768
    v_add_f32 v27, v56, v57
    v_mfma_f32_16x16x32_bf16 v[228:231], v[124:127], a[212:215], v[228:231]
    ds_read_b64_tr_b16 a[180:181], v2 offset:33408
    v_add_f32 v57, v56, v57
    v_mfma_f32_16x16x32_bf16 v[232:235], v[124:127], a[216:219], v[232:235]
    ds_read_b64_tr_b16 a[182:183], v3 offset:33408
    v_permlane16_swap_b32 v27, v57
    v_mfma_f32_16x16x32_bf16 v[236:239], v[124:127], a[220:223], v[236:239]
    s_waitcnt lgkmcnt(6)
    ds_read_b64_tr_b16 a[184:185], v2 offset:50048
    v_add_f32 v56, v27, v57
    v_mfma_f32_16x16x32_bf16 a[128:131], a[236:239], a[208:211], a[128:131]
    v_rcp_f32 v56, v56
    v_mfma_f32_16x16x32_bf16 a[132:135], a[236:239], a[212:215], a[132:135]
    ds_write_addtid_b32 v56 offset:22784
    v_add_f32 v60, v12, v28
    v_mfma_f32_16x16x32_bf16 a[136:139], a[236:239], a[216:219], a[136:139]
    ds_read_b128 v[56:59], v21 offset:22784
    v_add_f32 v61, v12, v28
    v_mfma_f32_16x16x32_bf16 a[140:143], a[236:239], a[220:223], a[140:143]
    s_waitcnt lgkmcnt(5)
    ds_read_b64_tr_b16 a[186:187], v3 offset:50048
    v_permlane32_swap_b32 v60, v61
    v_add_f32 v28, v60, v61
    v_add_f32 v61, v60, v61
    s_nop 1
    v_permlane16_swap_b32 v28, v61
    v_add_f32 v60, v28, v61
    v_rcp_f32 v60, v60
    s_nop 0
    ds_write_addtid_b32 v60 offset:22016
    ds_read_b128 v[60:63], v21 offset:22016
    v_pk_mul_f32 v[192:193], v[192:193], v[52:53]
    v_pk_mul_f32 v[196:197], v[196:197], v[52:53]
    v_pk_mul_f32 v[200:201], v[200:201], v[52:53]
    v_pk_mul_f32 v[204:205], v[204:205], v[52:53]
    v_pk_mul_f32 v[194:195], v[194:195], v[54:55]
    v_pk_mul_f32 v[198:199], v[198:199], v[54:55]
    v_pk_mul_f32 v[202:203], v[202:203], v[54:55]
    v_pk_mul_f32 v[206:207], v[206:207], v[54:55]
    v_cvt_pk_bf16_f32 v192, v192, v196
    v_cvt_pk_bf16_f32 v193, v193, v197
    v_cvt_pk_bf16_f32 v194, v194, v198
    v_cvt_pk_bf16_f32 v195, v195, v199
    v_cvt_pk_bf16_f32 v200, v200, v204
    v_cvt_pk_bf16_f32 v201, v201, v205
    v_cvt_pk_bf16_f32 v202, v202, v206
    v_cvt_pk_bf16_f32 v203, v203, v207
    ds_write2_b32 v22, v192, v200 offset0:0 offset1:1
    ds_write2_b32 v22, v193, v201 offset0:36 offset1:37
    ds_write2_b32 v22, v194, v202 offset0:72 offset1:73
    ds_write2_b32 v22, v195, v203 offset0:108 offset1:109
    ds_read_b64_tr_b16 a[240:241], v23 offset:0
    ds_read_b64_tr_b16 a[242:243], v23 offset:32
    ds_read_b64_tr_b16 a[244:245], v23 offset:1152
    ds_read_b64_tr_b16 a[246:247], v23 offset:1184
    s_waitcnt lgkmcnt(11)
    v_pk_mul_f32 v[224:225], v[224:225], v[56:57]
    v_pk_mul_f32 v[228:229], v[228:229], v[56:57]
    v_pk_mul_f32 v[232:233], v[232:233], v[56:57]
    v_pk_mul_f32 v[236:237], v[236:237], v[56:57]
    v_pk_mul_f32 v[226:227], v[226:227], v[58:59]
    v_pk_mul_f32 v[230:231], v[230:231], v[58:59]
    v_pk_mul_f32 v[234:235], v[234:235], v[58:59]
    v_pk_mul_f32 v[238:239], v[238:239], v[58:59]
    v_cvt_pk_bf16_f32 v224, v224, v228
    v_cvt_pk_bf16_f32 v225, v225, v229
    v_cvt_pk_bf16_f32 v226, v226, v230
    v_cvt_pk_bf16_f32 v227, v227, v231
    v_cvt_pk_bf16_f32 v232, v232, v236
    v_cvt_pk_bf16_f32 v233, v233, v237
    v_cvt_pk_bf16_f32 v234, v234, v238
    v_cvt_pk_bf16_f32 v235, v235, v239
    s_waitcnt lgkmcnt(2)
    buffer_store_dwordx4 a[240:243], v13, s[24:27], s49 offen sc0 sc1
    s_waitcnt lgkmcnt(0)
    buffer_store_dwordx4 a[244:247], v13, s[24:27], s6 offen sc0 sc1
    ds_write2_b32 v22, v224, v232 offset0:0 offset1:1
    ds_write2_b32 v22, v225, v233 offset0:36 offset1:37
    ds_write2_b32 v22, v226, v234 offset0:72 offset1:73
    ds_write2_b32 v22, v227, v235 offset0:108 offset1:109
    ds_read_b64_tr_b16 a[248:249], v23 offset:0
    ds_read_b64_tr_b16 a[250:251], v23 offset:32
    ds_read_b64_tr_b16 a[252:253], v23 offset:1152
    ds_read_b64_tr_b16 a[254:255], v23 offset:1184
    v_accvgpr_read_b32 v128, a128
    v_accvgpr_read_b32 v132, a132
    v_accvgpr_read_b32 v136, a136
    v_accvgpr_read_b32 v140, a140
    v_accvgpr_read_b32 v129, a129
    v_accvgpr_read_b32 v133, a133
    v_accvgpr_read_b32 v137, a137
    v_accvgpr_read_b32 v141, a141
    v_accvgpr_read_b32 v130, a130
    v_accvgpr_read_b32 v134, a134
    v_accvgpr_read_b32 v138, a138
    v_accvgpr_read_b32 v142, a142
    v_accvgpr_read_b32 v131, a131
    v_accvgpr_read_b32 v135, a135
    v_accvgpr_read_b32 v139, a139
    v_accvgpr_read_b32 v143, a143
    v_pk_mul_f32 v[128:129], v[128:129], v[60:61]
    v_pk_mul_f32 v[132:133], v[132:133], v[60:61]
    v_pk_mul_f32 v[136:137], v[136:137], v[60:61]
    v_pk_mul_f32 v[140:141], v[140:141], v[60:61]
    v_pk_mul_f32 v[130:131], v[130:131], v[62:63]
    v_pk_mul_f32 v[134:135], v[134:135], v[62:63]
    v_pk_mul_f32 v[138:139], v[138:139], v[62:63]
    v_pk_mul_f32 v[142:143], v[142:143], v[62:63]
    v_cvt_pk_bf16_f32 v128, v128, v132
    v_cvt_pk_bf16_f32 v129, v129, v133
    v_cvt_pk_bf16_f32 v130, v130, v134
    v_cvt_pk_bf16_f32 v131, v131, v135
    v_cvt_pk_bf16_f32 v136, v136, v140
    v_cvt_pk_bf16_f32 v137, v137, v141
    v_cvt_pk_bf16_f32 v138, v138, v142
    v_cvt_pk_bf16_f32 v139, v139, v143
    s_waitcnt lgkmcnt(2)
    buffer_store_dwordx4 a[248:251], v13, s[24:27], s50 offen sc0 sc1
    s_waitcnt lgkmcnt(0)
    buffer_store_dwordx4 a[252:255], v13, s[24:27], s7 offen sc0 sc1
    ds_write2_b32 v22, v128, v136 offset0:0 offset1:1
    ds_write2_b32 v22, v129, v137 offset0:36 offset1:37
    ds_write2_b32 v22, v130, v138 offset0:72 offset1:73
    ds_write2_b32 v22, v131, v139 offset0:108 offset1:109
    ds_read_b64_tr_b16 a[240:241], v23 offset:0
    ds_read_b64_tr_b16 a[242:243], v23 offset:32
    ds_read_b64_tr_b16 a[244:245], v23 offset:1152
    ds_read_b64_tr_b16 a[246:247], v23 offset:1184
    v_mfma_f32_16x16x32_bf16 v[144:147], v[80:83], a[176:179], v[144:147]
    ds_read_b64_tr_b16 a[188:189], v2 offset:16784
    v_max3_u32 v30, v30, v31, v32
    ds_read_b64_tr_b16 a[190:191], v3 offset:16784
    v_mfma_f32_16x16x32_bf16 v[144:147], v[96:99], a[180:183], v[144:147]
    ds_read_b64_tr_b16 a[192:193], v2 offset:33424
    v_max_u32 v30, v30, v33
    ds_read_b64_tr_b16 a[194:195], v3 offset:33424
    v_mfma_f32_16x16x32_bf16 v[144:147], v[112:115], a[184:187], v[144:147]
    s_waitcnt lgkmcnt(2)
    ds_read_b64_tr_b16 a[196:197], v2 offset:50064
    v_cmp_lt_u32 vcc, s52, v30
    ds_read_b64_tr_b16 a[198:199], v3 offset:50064
    v_mfma_f32_16x16x32_bf16 v[148:151], v[80:83], a[188:191], v[148:151]
    s_cbranch_vccnz L_fallback1
    ds_read_b64_tr_b16 a[200:201], v2 offset:16800
    ds_read_b64_tr_b16 a[202:203], v3 offset:16800
    s_waitcnt lgkmcnt(4)
    v_mfma_f32_16x16x32_bf16 v[148:151], v[96:99], a[192:195], v[148:151]
    s_waitcnt lgkmcnt(2)
    ds_read_b64_tr_b16 a[204:205], v2 offset:33440
    ds_read_b64_tr_b16 a[206:207], v3 offset:33440
    v_mfma_f32_16x16x32_bf16 v[148:151], v[112:115], a[196:199], v[148:151]
    s_waitcnt lgkmcnt(2)
    ds_read_b64_tr_b16 a[160:161], v2 offset:50080
    ds_read_b64_tr_b16 a[162:163], v3 offset:50080
    v_mfma_f32_16x16x32_bf16 v[152:155], v[80:83], a[200:203], v[152:155]
    s_waitcnt lgkmcnt(2)
    ds_read_b64_tr_b16 a[164:165], v2 offset:16816
    v_mul_f32 v144, v144, v44
    ds_read_b64_tr_b16 a[166:167], v3 offset:16816
    v_mfma_f32_16x16x32_bf16 v[152:155], v[96:99], a[204:207], v[152:155]
    buffer_store_dwordx4 a[240:243], v13, s[24:27], s51 offen sc0 sc1
    ds_read_b64_tr_b16 a[168:169], v2 offset:33456
    ds_read_b64_tr_b16 a[170:171], v3 offset:33456
    s_waitcnt lgkmcnt(4)
    v_mfma_f32_16x16x32_bf16 v[152:155], v[112:115], a[160:163], v[152:155]
    buffer_store_dwordx4 a[244:247], v13, s[24:27], s8 offen sc0 sc1
    ds_read_b64_tr_b16 a[172:173], v2 offset:50096
    ds_read_b64_tr_b16 a[174:175], v3 offset:50096
    s_waitcnt lgkmcnt(4)
    v_mfma_f32_16x16x32_bf16 v[156:159], v[80:83], a[164:167], v[156:159]
    s_waitcnt lgkmcnt(2)
    v_mul_f32 v145, v145, v45
    v_mul_f32 v146, v146, v46
    v_mfma_f32_16x16x32_bf16 v[156:159], v[96:99], a[168:171], v[156:159]
    s_waitcnt lgkmcnt(0)
    v_mul_f32 v147, v147, v47
    v_mul_f32 v148, v148, v44
    v_mfma_f32_16x16x32_bf16 v[156:159], v[112:115], a[172:175], v[156:159]
    v_mul_f32 v149, v149, v45
    v_mul_f32 v150, v150, v46
    v_mfma_f32_16x16x32_bf16 v[176:179], v[84:87], a[176:179], v[176:179]
    v_mul_f32 v151, v151, v47
    v_cvt_pk_bf16_f32 v144, v144, v148
    v_mfma_f32_16x16x32_bf16 v[176:179], v[100:103], a[180:183], v[176:179]
    v_cvt_pk_bf16_f32 v145, v145, v149
    v_cvt_pk_bf16_f32 v146, v146, v150
    v_mfma_f32_16x16x32_bf16 v[176:179], v[116:119], a[184:187], v[176:179]
    v_cvt_pk_bf16_f32 v147, v147, v151
    v_mul_f32 v152, v152, v44
    v_mfma_f32_16x16x32_bf16 v[180:183], v[84:87], a[188:191], v[180:183]
    v_mul_f32 v153, v153, v45
    v_mul_f32 v154, v154, v46
    v_mfma_f32_16x16x32_bf16 v[180:183], v[100:103], a[192:195], v[180:183]
    v_mul_f32 v155, v155, v47
    v_mul_f32 v156, v156, v44
    v_mfma_f32_16x16x32_bf16 v[180:183], v[116:119], a[196:199], v[180:183]
    v_mul_f32 v157, v157, v45
    v_mul_f32 v158, v158, v46
    v_mfma_f32_16x16x32_bf16 v[184:187], v[84:87], a[200:203], v[184:187]
    v_mul_f32 v159, v159, v47
    v_cvt_pk_bf16_f32 v152, v152, v156
    v_mfma_f32_16x16x32_bf16 v[184:187], v[100:103], a[204:207], v[184:187]
    v_cvt_pk_bf16_f32 v153, v153, v157
    v_cvt_pk_bf16_f32 v154, v154, v158
    v_mfma_f32_16x16x32_bf16 v[184:187], v[116:119], a[160:163], v[184:187]
    v_cvt_pk_bf16_f32 v155, v155, v159
    v_mul_f32 v176, v176, v48
    v_mfma_f32_16x16x32_bf16 v[188:191], v[84:87], a[164:167], v[188:191]
    v_mul_f32 v177, v177, v49
    v_mul_f32 v178, v178, v50
    v_mfma_f32_16x16x32_bf16 v[188:191], v[100:103], a[168:171], v[188:191]
    v_mul_f32 v179, v179, v51
    v_mul_f32 v180, v180, v48
    ds_write2_b32 v22, v144, v152 offset0:0 offset1:1
    ds_write2_b32 v22, v145, v153 offset0:36 offset1:37
    ds_write2_b32 v22, v146, v154 offset0:72 offset1:73
    ds_write2_b32 v22, v147, v155 offset0:108 offset1:109
    ds_read_b64_tr_b16 a[248:249], v23 offset:0
    ds_read_b64_tr_b16 a[250:251], v23 offset:32
    ds_read_b64_tr_b16 a[252:253], v23 offset:1152
    ds_read_b64_tr_b16 a[254:255], v23 offset:1184
    v_mfma_f32_16x16x32_bf16 v[188:191], v[116:119], a[172:175], v[188:191]
    v_mul_f32 v181, v181, v49
    v_mul_f32 v182, v182, v50
    v_mfma_f32_16x16x32_bf16 v[208:211], v[88:91], a[176:179], v[208:211]
    v_mul_f32 v183, v183, v51
    v_cvt_pk_bf16_f32 v176, v176, v180
    v_mfma_f32_16x16x32_bf16 v[208:211], v[104:107], a[180:183], v[208:211]
    v_cvt_pk_bf16_f32 v177, v177, v181
    v_cvt_pk_bf16_f32 v178, v178, v182
    v_mfma_f32_16x16x32_bf16 v[208:211], v[120:123], a[184:187], v[208:211]
    v_cvt_pk_bf16_f32 v179, v179, v183
    v_mul_f32 v184, v184, v48
    v_mfma_f32_16x16x32_bf16 v[212:215], v[88:91], a[188:191], v[212:215]
    v_mul_f32 v185, v185, v49
    v_mul_f32 v186, v186, v50
    v_mfma_f32_16x16x32_bf16 v[212:215], v[104:107], a[192:195], v[212:215]
    s_waitcnt lgkmcnt(2)
    buffer_store_dwordx4 a[248:251], v13, s[24:27], 0 offen offset:128 sc0 sc1
    v_mfma_f32_16x16x32_bf16 v[212:215], v[120:123], a[196:199], v[212:215]
    s_waitcnt lgkmcnt(0)
    buffer_store_dwordx4 a[252:255], v13, s[24:27], s4 offen offset:128 sc0 sc1
    v_mfma_f32_16x16x32_bf16 v[216:219], v[88:91], a[200:203], v[216:219]
    v_mul_f32 v187, v187, v51
    v_mul_f32 v188, v188, v48
    v_mfma_f32_16x16x32_bf16 v[216:219], v[104:107], a[204:207], v[216:219]
    v_mul_f32 v189, v189, v49
    v_mul_f32 v190, v190, v50
    v_mfma_f32_16x16x32_bf16 v[216:219], v[120:123], a[160:163], v[216:219]
    v_mul_f32 v191, v191, v51
    v_cvt_pk_bf16_f32 v184, v184, v188
    v_mfma_f32_16x16x32_bf16 v[220:223], v[88:91], a[164:167], v[220:223]
    v_cvt_pk_bf16_f32 v185, v185, v189
    v_cvt_pk_bf16_f32 v186, v186, v190
    v_mfma_f32_16x16x32_bf16 v[220:223], v[104:107], a[168:171], v[220:223]
    v_cvt_pk_bf16_f32 v187, v187, v191
    v_mul_f32 v208, v208, v52
    ds_write2_b32 v22, v176, v184 offset0:0 offset1:1
    ds_write2_b32 v22, v177, v185 offset0:36 offset1:37
    ds_write2_b32 v22, v178, v186 offset0:72 offset1:73
    ds_write2_b32 v22, v179, v187 offset0:108 offset1:109
    ds_read_b64_tr_b16 a[240:241], v23 offset:0
    ds_read_b64_tr_b16 a[242:243], v23 offset:32
    ds_read_b64_tr_b16 a[244:245], v23 offset:1152
    ds_read_b64_tr_b16 a[246:247], v23 offset:1184
    v_mfma_f32_16x16x32_bf16 v[220:223], v[120:123], a[172:175], v[220:223]
    v_mul_f32 v209, v209, v53
    v_mul_f32 v210, v210, v54
    v_mfma_f32_16x16x32_bf16 v[240:243], v[92:95], a[176:179], v[240:243]
    v_mul_f32 v211, v211, v55
    v_mul_f32 v212, v212, v52
    v_mfma_f32_16x16x32_bf16 v[240:243], v[108:111], a[180:183], v[240:243]
    v_mul_f32 v213, v213, v53
    v_mul_f32 v214, v214, v54
    v_mfma_f32_16x16x32_bf16 v[240:243], v[124:127], a[184:187], v[240:243]
    v_mul_f32 v215, v215, v55
    v_cvt_pk_bf16_f32 v208, v208, v212
    v_mfma_f32_16x16x32_bf16 v[244:247], v[92:95], a[188:191], v[244:247]
    v_cvt_pk_bf16_f32 v209, v209, v213
    v_cvt_pk_bf16_f32 v210, v210, v214
    v_mfma_f32_16x16x32_bf16 v[244:247], v[108:111], a[192:195], v[244:247]
    s_waitcnt lgkmcnt(2)
    buffer_store_dwordx4 a[240:243], v13, s[24:27], s48 offen offset:128 sc0 sc1
    v_mfma_f32_16x16x32_bf16 v[244:247], v[124:127], a[196:199], v[244:247]
    s_waitcnt lgkmcnt(0)
    buffer_store_dwordx4 a[244:247], v13, s[24:27], s5 offen offset:128 sc0 sc1
    v_mfma_f32_16x16x32_bf16 v[248:251], v[92:95], a[200:203], v[248:251]
    v_cvt_pk_bf16_f32 v211, v211, v215
    v_mul_f32 v216, v216, v52
    v_mfma_f32_16x16x32_bf16 v[248:251], v[108:111], a[204:207], v[248:251]
    v_mul_f32 v217, v217, v53
    v_mul_f32 v218, v218, v54
    v_mfma_f32_16x16x32_bf16 v[248:251], v[124:127], a[160:163], v[248:251]
    v_mul_f32 v219, v219, v55
    v_mul_f32 v220, v220, v52
    v_mfma_f32_16x16x32_bf16 v[252:255], v[92:95], a[164:167], v[252:255]
    v_mul_f32 v221, v221, v53
    v_mul_f32 v222, v222, v54
    v_mfma_f32_16x16x32_bf16 v[252:255], v[108:111], a[168:171], v[252:255]
    v_mul_f32 v223, v223, v55
    v_cvt_pk_bf16_f32 v216, v216, v220
    v_cvt_pk_bf16_f32 v217, v217, v221
    v_cvt_pk_bf16_f32 v218, v218, v222
    v_cvt_pk_bf16_f32 v219, v219, v223
    ds_write2_b32 v22, v208, v216 offset0:0 offset1:1
    ds_write2_b32 v22, v209, v217 offset0:36 offset1:37
    ds_write2_b32 v22, v210, v218 offset0:72 offset1:73
    ds_write2_b32 v22, v211, v219 offset0:108 offset1:109
    ds_read_b64_tr_b16 a[248:249], v23 offset:0
    ds_read_b64_tr_b16 a[250:251], v23 offset:32
    ds_read_b64_tr_b16 a[252:253], v23 offset:1152
    ds_read_b64_tr_b16 a[254:255], v23 offset:1184
    v_mfma_f32_16x16x32_bf16 v[252:255], v[124:127], a[172:175], v[252:255]
    v_mul_f32 v240, v240, v56
    v_mul_f32 v241, v241, v57
    v_mfma_f32_16x16x32_bf16 a[144:147], a[228:231], a[176:179], a[144:147]
    v_mul_f32 v242, v242, v58
    v_mul_f32 v243, v243, v59
    v_mfma_f32_16x16x32_bf16 a[144:147], a[232:235], a[180:183], a[144:147]
    v_mul_f32 v244, v244, v56
    v_mul_f32 v245, v245, v57
    v_mfma_f32_16x16x32_bf16 a[144:147], a[236:239], a[184:187], a[144:147]
    v_mul_f32 v246, v246, v58
    v_mul_f32 v247, v247, v59
    v_mfma_f32_16x16x32_bf16 a[148:151], a[228:231], a[188:191], a[148:151]
    v_cvt_pk_bf16_f32 v240, v240, v244
    v_cvt_pk_bf16_f32 v241, v241, v245
    v_mfma_f32_16x16x32_bf16 a[148:151], a[232:235], a[192:195], a[148:151]
    s_waitcnt lgkmcnt(2)
    buffer_store_dwordx4 a[248:251], v13, s[24:27], s49 offen offset:128 sc0 sc1
    v_mfma_f32_16x16x32_bf16 a[148:151], a[236:239], a[196:199], a[148:151]
    s_waitcnt lgkmcnt(0)
    buffer_store_dwordx4 a[252:255], v13, s[24:27], s6 offen offset:128 sc0 sc1
    v_mfma_f32_16x16x32_bf16 a[152:155], a[228:231], a[200:203], a[152:155]
    v_cvt_pk_bf16_f32 v242, v242, v246
    v_cvt_pk_bf16_f32 v243, v243, v247
    v_mfma_f32_16x16x32_bf16 a[152:155], a[232:235], a[204:207], a[152:155]
    v_mul_f32 v248, v248, v56
    v_mul_f32 v249, v249, v57
    v_mfma_f32_16x16x32_bf16 a[152:155], a[236:239], a[160:163], a[152:155]
    v_mul_f32 v250, v250, v58
    v_mul_f32 v251, v251, v59
    v_mfma_f32_16x16x32_bf16 a[156:159], a[228:231], a[164:167], a[156:159]
    v_mul_f32 v252, v252, v56
    v_mul_f32 v253, v253, v57
    v_mfma_f32_16x16x32_bf16 a[156:159], a[232:235], a[168:171], a[156:159]
    v_mul_f32 v254, v254, v58
    v_mul_f32 v255, v255, v59
    v_cvt_pk_bf16_f32 v248, v248, v252
    v_cvt_pk_bf16_f32 v249, v249, v253
    v_cvt_pk_bf16_f32 v250, v250, v254
    v_cvt_pk_bf16_f32 v251, v251, v255
    ds_write2_b32 v22, v240, v248 offset0:0 offset1:1
    ds_write2_b32 v22, v241, v249 offset0:36 offset1:37
    ds_write2_b32 v22, v242, v250 offset0:72 offset1:73
    ds_write2_b32 v22, v243, v251 offset0:108 offset1:109
    ds_read_b64_tr_b16 a[240:241], v23 offset:0
    ds_read_b64_tr_b16 a[242:243], v23 offset:32
    ds_read_b64_tr_b16 a[244:245], v23 offset:1152
    ds_read_b64_tr_b16 a[246:247], v23 offset:1184
    v_mfma_f32_16x16x32_bf16 a[156:159], a[236:239], a[172:175], a[156:159]
    v_accvgpr_read_b32 v128, a144
    v_accvgpr_read_b32 v132, a148
    v_accvgpr_read_b32 v136, a152
    s_nop 4
    v_accvgpr_read_b32 v140, a156
    v_accvgpr_read_b32 v129, a145
    v_accvgpr_read_b32 v133, a149
    v_accvgpr_read_b32 v137, a153
    v_accvgpr_read_b32 v141, a157
    v_accvgpr_read_b32 v130, a146
    v_accvgpr_read_b32 v134, a150
    v_accvgpr_read_b32 v138, a154
    v_accvgpr_read_b32 v142, a158
    v_accvgpr_read_b32 v131, a147
    v_accvgpr_read_b32 v135, a151
    v_accvgpr_read_b32 v139, a155
    v_accvgpr_read_b32 v143, a159
    v_pk_mul_f32 v[128:129], v[128:129], v[60:61]
    v_pk_mul_f32 v[132:133], v[132:133], v[60:61]
    v_pk_mul_f32 v[136:137], v[136:137], v[60:61]
    v_pk_mul_f32 v[140:141], v[140:141], v[60:61]
    v_pk_mul_f32 v[130:131], v[130:131], v[62:63]
    v_pk_mul_f32 v[134:135], v[134:135], v[62:63]
    v_pk_mul_f32 v[138:139], v[138:139], v[62:63]
    v_pk_mul_f32 v[142:143], v[142:143], v[62:63]
    v_cvt_pk_bf16_f32 v128, v128, v132
    v_cvt_pk_bf16_f32 v129, v129, v133
    v_cvt_pk_bf16_f32 v130, v130, v134
    v_cvt_pk_bf16_f32 v131, v131, v135
    v_cvt_pk_bf16_f32 v136, v136, v140
    v_cvt_pk_bf16_f32 v137, v137, v141
    v_cvt_pk_bf16_f32 v138, v138, v142
    v_cvt_pk_bf16_f32 v139, v139, v143
    s_waitcnt lgkmcnt(2)
    buffer_store_dwordx4 a[240:243], v13, s[24:27], s50 offen offset:128 sc0 sc1
    s_waitcnt lgkmcnt(0)
    buffer_store_dwordx4 a[244:247], v13, s[24:27], s7 offen offset:128 sc0 sc1
    ds_write2_b32 v22, v128, v136 offset0:0 offset1:1
    ds_write2_b32 v22, v129, v137 offset0:36 offset1:37
    ds_write2_b32 v22, v130, v138 offset0:72 offset1:73
    ds_write2_b32 v22, v131, v139 offset0:108 offset1:109
    ds_read_b64_tr_b16 a[248:249], v23 offset:0
    ds_read_b64_tr_b16 a[250:251], v23 offset:32
    ds_read_b64_tr_b16 a[252:253], v23 offset:1152
    ds_read_b64_tr_b16 a[254:255], v23 offset:1184
    s_waitcnt lgkmcnt(2)
    buffer_store_dwordx4 a[248:251], v13, s[24:27], s51 offen offset:128 sc0 sc1
    s_waitcnt lgkmcnt(0)
    buffer_store_dwordx4 a[252:255], v13, s[24:27], s8 offen offset:128 sc0 sc1
    s_endpgm
L_end:
    s_endpgm
.fill 256, 4, 0xbf810000
.section .rodata,"a"
.p2align 6
.amdhsa_kernel standalone__gqa_softmax__near_ridge_kernel
  .amdhsa_next_free_vgpr 512
  .amdhsa_next_free_sgpr 102
  .amdhsa_accum_offset 256
  .amdhsa_group_segment_fixed_size 0
  .amdhsa_kernarg_size 48
  .amdhsa_user_sgpr_count 2
  .amdhsa_user_sgpr_kernarg_segment_ptr 1
  .amdhsa_system_sgpr_workgroup_id_x 1
.end_amdhsa_kernel
```
